```python
import torch

def _softmax(x, axis=-1):
    return torch.softmax(x, dim=axis)
def _gelu(x):
    return torch.nn.functional.gelu(x, approximate="tanh")
def _silu(x):
    return torch.nn.functional.silu(x)
def _sigmoid(x):
    return torch.sigmoid(x)
def _layernorm(x, axis=-1, eps=1e-5):
    m = x.mean(dim=axis, keepdim=True)
    v = x.var(dim=axis, keepdim=True, unbiased=False)
    return (x - m) / torch.sqrt(v + eps)
def _scatter_add(tgt, idx, src, axis=0):
    return tgt.clone().index_add_(axis, idx, src)
def _segment_sum(src, seg, n):
    out = torch.zeros((n,) + src.shape[1:], dtype=src.dtype)
    return out.index_add_(0, seg, src)
def _pad(x, pw):
    flat = tuple(v for pair in reversed(pw) for v in pair)
    return torch.nn.functional.pad(x, flat)

kernel_name = 'recurrent_scan__ssm_conv_h3__dense_activation_squared_relu__prompt'

def setup_inputs():

    _w = (lambda a: (lambda t: t.to(torch.bfloat16) if t.is_floating_point() else t)(torch.as_tensor(a)))
    def _A_setup():
        B, S, D = 1, 2048, 640
        ks = 4
        return {
            "q": _w((lambda *s: torch.randn(*s, dtype=torch.bfloat16) * 0.05)(B, S, D)),
            "k": _w((lambda *s: torch.randn(*s, dtype=torch.bfloat16) * 0.2)(B, S, D)),
            "v": _w((lambda *s: torch.randn(*s, dtype=torch.bfloat16) * 0.2)(B, S, D)),
            "shift_k": _w((lambda *s: torch.randn(*s, dtype=torch.bfloat16) * 0.2)(D, ks) * 0.5),
            "ssm_k": _w((lambda *s: torch.randn(*s, dtype=torch.bfloat16) * 0.2)(D, S) * (1.0 / S ** 0.5)),
            "ssm_D": _w((lambda *s: torch.randn(*s, dtype=torch.bfloat16) * 0.2)(D)),
        }
    _A_in = _A_setup()

    def _B_setup():
        B, S, D, F = 1, 2048, 640, 1536
        return {
            "x": _w((lambda *s: torch.randn(*s, dtype=torch.bfloat16) * 0.05)(B, S, D)),
            "w1": _w((lambda *s: torch.randn(*s, dtype=torch.bfloat16) * 0.1)(D, F)),
            "b1": _w((lambda *s: torch.randn(*s, dtype=torch.bfloat16) * 0.8)(F)),
            "w2": _w((lambda *s: torch.randn(*s, dtype=torch.bfloat16) * 0.1)(F, D)),
            "b2": _w((lambda *s: torch.randn(*s, dtype=torch.bfloat16) * 6.4)(D)),
        }
    _B_in = _B_setup()

    return {
        "A_q": _A_in["q"],
        "A_k": _A_in["k"],
        "A_v": _A_in["v"],
        "A_shift_k": _A_in["shift_k"],
        "A_ssm_k": _A_in["ssm_k"],
        "A_ssm_D": _A_in["ssm_D"],
        "B_x": _B_in["x"],
        "B_w1": _B_in["w1"],
        "B_b1": _B_in["b1"],
        "B_w2": _B_in["w2"],
        "B_b2": _B_in["b2"],
    }

def reference(A_q, A_k, A_v, A_shift_k, A_ssm_k, A_ssm_D, B_x, B_w1, B_b1, B_w2, B_b2):
    def _A_ref(q, k, v, shift_k, ssm_k, ssm_D):
        B, S, D = q.shape
        ks = shift_k.shape[-1]
        k_pad = _pad(k, ((0, 0), (ks - 1, 0), (0, 0)))
        k_shift = torch.zeros_like(k)
        for t in range(ks):
            k_shift = k_shift + k_pad[:, t:t + S, :] * shift_k[:, ks - 1 - t][None, None, :]
        kv = k_shift * v
        L = 2 * S
        kv_pad = _pad(kv, ((0, 0), (0, S), (0, 0)))
        kf_pad = _pad(ssm_k, ((0, 0), (0, S)))
        kv_f = (lambda x, axes=(-2,-1): torch.fft.rfft2(x.float(), dim=axes))(kv_pad[:, None, :, :], axes=(1, 2))
        kf_f = (lambda x, axes=(-2,-1): torch.fft.rfft2(x.float(), dim=axes))(kf_pad[:, None, :], axes=(1, 2))
        kf_f = (lambda x, *d: x.permute(*d))(kf_f, 1, 2, 0)
        y_f = kv_f * kf_f[None, :, :, :]
        y = (lambda x, s, axes=(-2,-1): torch.fft.irfft2(x, s=s, dim=axes).to(torch.bfloat16))(y_f, (1, L), axes=(1, 2))[:, 0, :S, :]
        y = y + kv * ssm_D[None, None, :]
        return q * y

    def _B_ref(x, w1, b1, w2, b2):
        h = torch.einsum("bsd,df->bsf", x, w1) + b1
        zero = torch.zeros_like(h)
        r = torch.where(h > zero, h, zero)
        h = r * r
        out = torch.einsum("bsf,fd->bsd", h, w2) + b2
        return out

    x = A_q
    xn = _layernorm(x, axis=-1)
    s = _A_ref(xn, A_k, A_v, A_shift_k, A_ssm_k, A_ssm_D)
    g = _silu(_B_ref(xn, B_w1, B_b1, B_w2, B_b2))
    return x + s * g
```

```asm
; @launch grid=(256,1,1) block=(256,1,1) lds=163840
.amdgcn_target "amdgcn-amd-amdhsa--gfx950"
.text
.globl recurrent_scan__ssm_conv_h3__dense_activation_squared_relu__prompt_kernel
.p2align 8
.type recurrent_scan__ssm_conv_h3__dense_activation_squared_relu__prompt_kernel,@function
recurrent_scan__ssm_conv_h3__dense_activation_squared_relu__prompt_kernel:
    s_cmp_ge_u32 s2, 256
    s_cbranch_scc1 L_exit
    s_cmp_ge_u32 s2, 160
    s_cbranch_scc1 L_roleB
    s_getpc_b64 s[6:7]
Lpc_A:
    s_mov_b32 s8, Lend_A-Lpc_A-4
    v_and_b32 v3, 63, v0
    v_lshlrev_b32 v3, 7, v3
    v_lshrrev_b32 v4, 6, v0
    v_lshl_add_u32 v3, v4, 13, v3
    v_min_u32 v3, s8, v3
    global_load_dword a203, v3, s[6:7]
    s_load_dwordx16 s[40:55], s[0:1], 0
    s_load_dwordx8 s[56:63], s[0:1], 64
    s_load_dwordx4 s[64:67], s[0:1], 96
    v_and_b32 v1, 63, v0
    v_lshrrev_b32 v2, 6, v0
    s_and_b32 s80, s2, 7
    s_lshr_b32 s81, s2, 3
    v_readfirstlane_b32 s4, v2
    s_lshr_b32 s82, s80, 1
    s_lshl_b32 s82, s82, 2
    s_lshr_b32 s83, s81, 3
    s_add_u32 s68, s82, s83
    s_and_b32 s82, s80, 1
    s_lshl_b32 s82, s82, 3
    s_and_b32 s71, s81, 7
    s_add_u32 s69, s82, s71
    s_lshl_b32 s70, s80, 2
    s_add_u32 s70, s70, s83
    s_mov_b32 s86, 0x3f803f80
    s_waitcnt lgkmcnt(0)
    s_mov_b32 s12, s42
    s_mov_b32 s13, s43
    s_mov_b32 s14, 2621440
    s_mov_b32 s15, 0x20000
    s_mov_b32 s16, s44
    s_mov_b32 s17, s45
    s_mov_b32 s18, 2621440
    s_mov_b32 s19, 0x20000
    s_mov_b32 s28, s46
    s_mov_b32 s29, s47
    s_mov_b32 s30, 5120
    s_mov_b32 s31, 0x20000
    s_mov_b32 s8, s40
    s_mov_b32 s9, s41
    s_mov_b32 s10, 2621440
    s_mov_b32 s11, 0x20000
    s_mov_b32 s36, s66
    s_mov_b32 s37, s67
    s_mov_b32 s38, 20971520
    s_mov_b32 s39, 0x20000
    s_mov_b32 s20, s54
    s_mov_b32 s21, s55
    s_mov_b32 s22, 1966080
    s_mov_b32 s23, 0x20000
    s_load_dword s87, s[66:67], 0
    s_lshl_b32 s80, s2, 2
    s_add_u32 s80, s80, s4
    s_lshl_b32 s81, s80, 1
    s_and_b32 s81, s81, -4
    s_load_dword s90, s[50:51], s81
    v_lshrrev_b32 v20, 3, v1
    v_and_b32 v21, 7, v1
    v_lshrrev_b32 v22, 4, v1
    s_lshl_b32 s80, s4, 5
    v_add_u32 v20, s80, v20
    v_mul_u32_u24 v20, 1280, v20
    v_xor_b32 v23, v21, v22
    v_add_u32 v24, 4, v22
    v_xor_b32 v24, v21, v24
    v_lshl_add_u32 v2, v23, 4, v20
    v_lshl_add_u32 v24, v24, 4, v20
    v_add_u32 v3, 9216, v24
    v_add_u32 v4, 18432, v2
    v_add_u32 v5, 27648, v24
    s_mul_i32 s73, s68, 163840
    s_lshl_b32 s75, s4, 12
    s_mul_i32 s74, s69, 192
    s_mul_i32 s76, s4, 3072
    s_add_u32 s76, s76, 65536
    s_mul_i32 s80, s4, 192
    s_mov_b32 s81, 0x15555556
    v_add_u32 v20, s80, v1
    v_add_u32 v20, 0, v20
    v_mul_hi_u32 v21, v20, s81
    v_mul_u32_u24 v22, 12, v21
    v_sub_u32 v22, v20, v22
    v_mul_u32_u24 v21, 3072, v21
    v_lshl_add_u32 v21, v22, 4, v21
    v_subrev_u32 v6, 0, v21
    v_add_u32 v20, s80, v1
    v_add_u32 v20, 64, v20
    v_mul_hi_u32 v21, v20, s81
    v_mul_u32_u24 v22, 12, v21
    v_sub_u32 v22, v20, v22
    v_mul_u32_u24 v21, 3072, v21
    v_lshl_add_u32 v21, v22, 4, v21
    v_subrev_u32 v7, 1024, v21
    v_add_u32 v20, s80, v1
    v_add_u32 v20, 128, v20
    v_mul_hi_u32 v21, v20, s81
    v_mul_u32_u24 v22, 12, v21
    v_sub_u32 v22, v20, v22
    v_mul_u32_u24 v21, 3072, v21
    v_lshl_add_u32 v21, v22, 4, v21
    v_subrev_u32 v8, 2048, v21
    s_add_u32 m0, s75, 0
    s_nop 0
    buffer_load_dwordx4 v2, s[8:11], s73 offen offset:0 lds
    buffer_load_dwordx4 v3, s[8:11], s73 offen offset:1024 lds
    buffer_load_dwordx4 v4, s[8:11], s73 offen offset:2048 lds
    buffer_load_dwordx4 v5, s[8:11], s73 offen offset:3072 lds
    s_add_u32 s73, s73, 128
    s_add_u32 m0, s76, 0
    s_nop 0
    buffer_load_dwordx4 v6, s[20:23], s74 offen offset:0 lds
    buffer_load_dwordx4 v7, s[20:23], s74 offen offset:1024 lds
    buffer_load_dwordx4 v8, s[20:23], s74 offen offset:2048 lds
    s_add_u32 s74, s74, 196608
    s_lshl_b32 s80, s70, 6
    s_sub_u32 s81, s80, 3
    s_mul_i32 s81, s81, 1280
    s_mul_i32 s80, s80, 1280
    s_mul_i32 s82, s71, 160
    s_mov_b32 s83, 0x1999999a
    s_lshl_b32 s84, s4, 6
    s_lshl_b32 s85, s4, 10
    v_add_u32 v204, s84, v1
    v_add_u32 v204, 0, v204
    v_mul_hi_u32 v205, v204, s83
    v_mul_u32_u24 v206, 10, v205
    v_sub_u32 v206, v204, v206
    v_mul_u32_u24 v205, 1280, v205
    v_lshl_add_u32 v205, v206, 4, v205
    v_add_u32 v205, s82, v205
    v_add_u32 v207, s81, v205
    v_add_u32 v208, s80, v205
    v_mov_b32 v209, 2147483648
    v_cmp_gt_u32 vcc, 670, v204
    s_nop 1
    v_cndmask_b32 v207, v209, v207, vcc
    v_cmp_gt_u32 vcc, 640, v204
    s_nop 1
    v_cndmask_b32 v208, v209, v208, vcc
    s_add_u32 m0, s85, 114688
    s_nop 0
    buffer_load_dwordx4 v207, s[12:15], 0 offen nt lds
    s_add_u32 m0, s85, 126976
    s_nop 0
    buffer_load_dwordx4 v208, s[16:19], 0 offen nt lds
    v_add_u32 v204, s84, v1
    v_add_u32 v204, 256, v204
    v_mul_hi_u32 v205, v204, s83
    v_mul_u32_u24 v206, 10, v205
    v_sub_u32 v206, v204, v206
    v_mul_u32_u24 v205, 1280, v205
    v_lshl_add_u32 v205, v206, 4, v205
    v_add_u32 v205, s82, v205
    v_add_u32 v207, s81, v205
    v_add_u32 v208, s80, v205
    v_mov_b32 v209, 2147483648
    v_cmp_gt_u32 vcc, 670, v204
    s_nop 1
    v_cndmask_b32 v207, v209, v207, vcc
    v_cmp_gt_u32 vcc, 640, v204
    s_nop 1
    v_cndmask_b32 v208, v209, v208, vcc
    s_add_u32 m0, s85, 118784
    s_nop 0
    buffer_load_dwordx4 v207, s[12:15], 0 offen nt lds
    s_add_u32 m0, s85, 131072
    s_nop 0
    buffer_load_dwordx4 v208, s[16:19], 0 offen nt lds
    v_add_u32 v204, s84, v1
    v_add_u32 v204, 512, v204
    v_mul_hi_u32 v205, v204, s83
    v_mul_u32_u24 v206, 10, v205
    v_sub_u32 v206, v204, v206
    v_mul_u32_u24 v205, 1280, v205
    v_lshl_add_u32 v205, v206, 4, v205
    v_add_u32 v205, s82, v205
    v_add_u32 v207, s81, v205
    v_add_u32 v208, s80, v205
    v_mov_b32 v209, 2147483648
    v_cmp_gt_u32 vcc, 670, v204
    s_nop 1
    v_cndmask_b32 v207, v209, v207, vcc
    v_cmp_gt_u32 vcc, 640, v204
    s_nop 1
    v_cndmask_b32 v208, v209, v208, vcc
    s_add_u32 m0, s85, 122880
    s_nop 0
    buffer_load_dwordx4 v207, s[12:15], 0 offen nt lds
    s_add_u32 m0, s85, 135168
    s_nop 0
    buffer_load_dwordx4 v208, s[16:19], 0 offen nt lds
    s_mul_i32 s82, s71, 640
    v_lshl_add_u32 v204, v1, 4, s82
    v_mov_b32 v209, 2147483648
    v_cmp_gt_u32 vcc, 40, v1
    s_nop 1
    v_cndmask_b32 v204, v209, v204, vcc
    s_mov_b32 m0, 139264
    s_nop 0
    buffer_load_dwordx4 v204, s[28:31], 0 offen lds
    s_and_b32 s80, s2, 7
    s_lshl_b32 s80, s80, 8
    s_and_b32 s81, s2, -8
    s_add_u32 s80, s80, s81
    s_lshl_b32 s81, s4, 1
    s_add_u32 s80, s80, s81
    v_lshrrev_b32 v226, 5, v1
    v_add_u32 v226, s80, v226
    v_and_b32 v227, 31, v1
    v_mul_u32_u24 v224, 1280, v226
    v_lshl_add_u32 v225, v227, 3, v224
    v_lshl_add_u32 v224, v227, 4, v224
    buffer_load_dwordx4 v[214:217], v224, s[8:11], 0 offen
    buffer_load_dwordx4 v[218:221], v224, s[8:11], 0 offen offset:512
    buffer_load_dwordx2 v[222:223], v225, s[8:11], 0 offen offset:1024
    s_add_u32 m0, s75, 16384
    s_nop 0
    buffer_load_dwordx4 v2, s[8:11], s73 offen offset:0 lds
    s_mov_b32 s32, s62
    s_mov_b32 s33, s63
    s_mov_b32 s34, 2621440
    s_mov_b32 s35, 0x20000
    s_mov_b32 s28, s48
    s_mov_b32 s29, s49
    s_mov_b32 s30, 2621440
    buffer_load_dwordx4 v3, s[8:11], s73 offen offset:1024 lds
    s_mov_b32 s31, 0x20000
    v_and_b32 v20, 31, v1
    v_lshrrev_b32 v21, 5, v1
    v_bfe_u32 v22, v1, 1, 3
    v_lshlrev_b32 v20, 7, v20
    v_add_u32 v20, s75, v20
    v_add_u32 v23, 0, v21
    buffer_load_dwordx4 v4, s[8:11], s73 offen offset:2048 lds
    v_xor_b32 v23, v23, v22
    v_lshl_add_u32 v9, v23, 4, v20
    v_add_u32 v23, 2, v21
    v_xor_b32 v23, v23, v22
    v_lshl_add_u32 v10, v23, 4, v20
    v_add_u32 v23, 4, v21
    buffer_load_dwordx4 v5, s[8:11], s73 offen offset:3072 lds
    v_xor_b32 v23, v23, v22
    v_lshl_add_u32 v11, v23, 4, v20
    v_add_u32 v23, 6, v21
    v_xor_b32 v23, v23, v22
    v_lshl_add_u32 v12, v23, 4, v20
    v_lshrrev_b32 v20, 5, v1
    v_lshlrev_b32 v20, 3, v20
    s_add_u32 s73, s73, 128
    s_add_u32 m0, s76, 12288
    s_nop 0
    buffer_load_dwordx4 v6, s[20:23], s74 offen offset:0 lds
    v_bfe_u32 v21, v1, 2, 2
    v_add_u32 v20, v20, v21
    v_mul_u32_u24 v20, 192, v20
    v_bfe_u32 v21, v1, 4, 1
    v_lshl_add_u32 v20, v21, 5, v20
    v_and_b32 v21, 3, v1
    buffer_load_dwordx4 v7, s[20:23], s74 offen offset:1024 lds
    v_lshl_add_u32 v20, v21, 3, v20
    v_add_u32 v17, 65536, v20
    s_mul_i32 s80, s4, 3072
    v_add_u32 v18, s80, v17
    v_mov_b32 v20, 0
    v_mov_b32 v21, 0
    v_mov_b32 v22, 0
    buffer_load_dwordx4 v8, s[20:23], s74 offen offset:2048 lds
    v_mov_b32 v23, 0
    v_mov_b32 v24, 0
    v_mov_b32 v25, 0
    v_mov_b32 v26, 0
    v_mov_b32 v27, 0
    v_mov_b32 v28, 0
    s_add_u32 s74, s74, 196608
    s_add_u32 m0, s75, 32768
    s_nop 0
    buffer_load_dwordx4 v2, s[8:11], s73 offen offset:0 lds
    v_mov_b32 v29, 0
    v_mov_b32 v30, 0
    v_mov_b32 v31, 0
    v_mov_b32 v32, 0
    v_mov_b32 v33, 0
    v_mov_b32 v34, 0
    v_mov_b32 v35, 0
    buffer_load_dwordx4 v3, s[8:11], s73 offen offset:1024 lds
    v_mov_b32 v36, 0
    v_mov_b32 v37, 0
    v_mov_b32 v38, 0
    v_mov_b32 v39, 0
    v_mov_b32 v40, 0
    v_mov_b32 v41, 0
    v_mov_b32 v42, 0
    buffer_load_dwordx4 v4, s[8:11], s73 offen offset:2048 lds
    v_mov_b32 v43, 0
    v_mov_b32 v44, 0
    v_mov_b32 v45, 0
    v_mov_b32 v46, 0
    v_mov_b32 v47, 0
    v_mov_b32 v48, 0
    buffer_load_dwordx4 v5, s[8:11], s73 offen offset:3072 lds
    v_mov_b32 v49, 0
    v_mov_b32 v50, 0
    v_mov_b32 v51, 0
    v_mov_b32 v52, 0
    v_mov_b32 v53, 0
    v_mov_b32 v54, 0
    v_mov_b32 v55, 0
    s_add_u32 s73, s73, 128
    s_add_u32 m0, s76, 24576
    s_nop 0
    buffer_load_dwordx4 v6, s[20:23], s74 offen offset:0 lds
    v_mov_b32 v56, 0
    v_mov_b32 v57, 0
    v_mov_b32 v58, 0
    v_mov_b32 v59, 0
    v_mov_b32 v60, 0
    v_mov_b32 v61, 0
    buffer_load_dwordx4 v7, s[20:23], s74 offen offset:1024 lds
    v_mov_b32 v62, 0
    v_mov_b32 v63, 0
    v_mov_b32 v64, 0
    v_mov_b32 v65, 0
    v_mov_b32 v66, 0
    v_mov_b32 v67, 0
    v_mov_b32 v121, s86
    buffer_load_dwordx4 v8, s[20:23], s74 offen offset:2048 lds
    s_add_u32 s74, s74, 196608
    v_accvgpr_write_b32 a196, v121
    v_accvgpr_write_b32 a197, v121
    v_accvgpr_write_b32 a198, v121
    v_accvgpr_write_b32 a199, v121
    s_waitcnt lgkmcnt(0)
    s_mul_i32 s5, s87, 0x9e3779b1
    s_add_u32 s5, s5, 0x7f4a7c15
    s_waitcnt vmcnt(24)
    s_barrier
    ds_read_b128 v[68:71], v9 offset:0
    ds_read_b64_tr_b16 v[76:77], v17 offset:0
    ds_read_b64_tr_b16 v[78:79], v17 offset:768
    ds_read_b64_tr_b16 v[80:81], v17 offset:64
    ds_read_b64_tr_b16 v[82:83], v17 offset:832
    ds_read_b64_tr_b16 v[84:85], v17 offset:128
    ds_read_b64_tr_b16 v[86:87], v17 offset:896
    s_waitcnt lgkmcnt(4)
    v_mfma_f32_32x32x16_bf16 v[20:35], v[76:79], v[68:71], v[20:35]
    v_mov_b32 v228, 0
    v_mov_b32 v229, 0
    s_waitcnt vmcnt(16)
    v_dot2c_f32_bf16 v228, s86, v214
    v_dot2c_f32_bf16 v229, v214, v214
    v_dot2c_f32_bf16 v228, s86, v215
    v_dot2c_f32_bf16 v229, v215, v215
    ds_read_b128 v[72:75], v10 offset:0
    ds_read_b64_tr_b16 v[88:89], v17 offset:3072
    ds_read_b64_tr_b16 v[90:91], v17 offset:3840
    s_waitcnt lgkmcnt(5)
    v_mfma_f32_32x32x16_bf16 v[36:51], v[80:83], v[68:71], v[36:51]
    v_dot2c_f32_bf16 v228, s86, v216
    v_dot2c_f32_bf16 v229, v216, v216
    v_dot2c_f32_bf16 v228, s86, v217
    v_dot2c_f32_bf16 v229, v217, v217
    s_waitcnt vmcnt(15)
    v_dot2c_f32_bf16 v228, s86, v218
    ds_read_b64_tr_b16 v[92:93], v17 offset:3136
    ds_read_b64_tr_b16 v[94:95], v17 offset:3904
    ds_read_b64_tr_b16 v[100:101], v18 offset:0
    s_waitcnt lgkmcnt(6)
    v_mfma_f32_32x32x16_bf16 v[52:67], v[84:87], v[68:71], v[52:67]
    v_dot2c_f32_bf16 v229, v218, v218
    v_dot2c_f32_bf16 v228, s86, v219
    v_dot2c_f32_bf16 v229, v219, v219
    v_dot2c_f32_bf16 v228, s86, v220
    v_dot2c_f32_bf16 v229, v220, v220
    ds_read_b64_tr_b16 v[96:97], v17 offset:3200
    ds_read_b64_tr_b16 v[98:99], v17 offset:3968
    ds_read_b64_tr_b16 v[102:103], v18 offset:768
    s_waitcnt lgkmcnt(6)
    v_mfma_f32_32x32x16_bf16 v[20:35], v[88:91], v[72:75], v[20:35]
    v_dot2c_f32_bf16 v228, s86, v221
    v_dot2c_f32_bf16 v229, v221, v221
    s_waitcnt vmcnt(14)
    v_dot2c_f32_bf16 v228, s86, v222
    v_dot2c_f32_bf16 v229, v222, v222
    v_dot2c_f32_bf16 v228, s86, v223
    ds_read_b128 v[68:71], v11 offset:0
    ds_read_b64_tr_b16 v[76:77], v17 offset:6144
    ds_read_b64_tr_b16 v[78:79], v17 offset:6912
    s_waitcnt lgkmcnt(7)
    v_mfma_f32_32x32x16_bf16 v[36:51], v[92:95], v[72:75], v[36:51]
    v_dot2c_f32_bf16 v229, v223, v223
    v_add_f32_dpp v228, v228, v228 row_ror:8 row_mask:0xf bank_mask:0xf
    s_nop 1
    v_add_f32_dpp v229, v229, v229 row_ror:8 row_mask:0xf bank_mask:0xf
    v_add_f32_dpp v228, v228, v228 row_ror:4 row_mask:0xf bank_mask:0xf
    s_nop 0
    v_add_f32_dpp v229, v229, v229 row_ror:4 row_mask:0xf bank_mask:0xf
    ds_read_b64_tr_b16 v[80:81], v17 offset:6208
    ds_read_b64_tr_b16 v[82:83], v17 offset:6976
    s_waitcnt lgkmcnt(6)
    v_mfma_f32_32x32x16_bf16 v[52:67], v[96:99], v[72:75], v[52:67]
    v_add_f32_dpp v228, v228, v228 row_ror:2 row_mask:0xf bank_mask:0xf
    v_add_f32_dpp v229, v229, v229 row_ror:2 row_mask:0xf bank_mask:0xf
    s_nop 0
    v_add_f32_dpp v228, v228, v228 row_ror:1 row_mask:0xf bank_mask:0xf
    v_add_f32_dpp v229, v229, v229 row_ror:1 row_mask:0xf bank_mask:0xf
    v_mov_b32 v230, v228
    v_mov_b32 v231, v229
    s_add_u32 m0, s75, 49152
    s_nop 0
    buffer_load_dwordx4 v2, s[8:11], s73 offen offset:0 lds
    ds_read_b64_tr_b16 v[84:85], v17 offset:6272
    ds_read_b64_tr_b16 v[86:87], v17 offset:7040
    s_waitcnt lgkmcnt(7)
    v_mfma_f32_32x32x16_bf16 a[208:223], a[196:199], v[100:103], 0
    v_permlane16_swap_b32 v228, v230
    v_permlane16_swap_b32 v229, v231
    v_add_f32 v228, v228, v230
    v_add_f32 v229, v229, v231
    buffer_load_dwordx4 v3, s[8:11], s73 offen offset:1024 lds
    v_mul_f32 v228, 0x3acccccd, v228
    ds_read_b64_tr_b16 v[104:105], v18 offset:64
    ds_read_b64_tr_b16 v[106:107], v18 offset:832
    s_waitcnt lgkmcnt(6)
    v_mfma_f32_32x32x16_bf16 v[20:35], v[76:79], v[68:71], v[20:35]
    v_mul_f32 v229, 0x3acccccd, v229
    v_fma_f32 v229, -v228, v228, v229
    v_max_f32 v229, 0, v229
    buffer_load_dwordx4 v4, s[8:11], s73 offen offset:2048 lds
    v_cvt_pk_bf16_f32 v228, v228, v229
    v_and_b32 v229, 0xffff0000, v228
    ds_read_b128 v[72:75], v12 offset:0
    ds_read_b64_tr_b16 v[88:89], v17 offset:9216
    ds_read_b64_tr_b16 v[90:91], v17 offset:9984
    s_waitcnt lgkmcnt(7)
    v_mfma_f32_32x32x16_bf16 v[36:51], v[80:83], v[68:71], v[36:51]
    v_lshlrev_b32 v228, 16, v228
    buffer_load_dwordx4 v5, s[8:11], s73 offen offset:3072 lds
    v_add_f32 v229, 0x3727c5ac, v229
    v_cvt_pk_bf16_f32 v229, v229, v229
    v_lshlrev_b32 v229, 16, v229
    v_sqrt_f32 v229, v229
    ds_read_b64_tr_b16 v[92:93], v17 offset:9280
    ds_read_b64_tr_b16 v[94:95], v17 offset:10048
    s_waitcnt lgkmcnt(7)
    v_mfma_f32_32x32x16_bf16 v[52:67], v[84:87], v[68:71], v[52:67]
    s_add_u32 s73, s73, 128
    s_add_u32 m0, s76, 36864
    s_nop 0
    buffer_load_dwordx4 v6, s[20:23], s74 offen offset:0 lds
    v_cvt_pk_bf16_f32 v229, v229, v229
    v_lshlrev_b32 v229, 16, v229
    v_lshlrev_b32 v230, 3, v226
    v_add_u32 v230, 65536, v230
    v_mov_b32 v231, 2147483648
    ds_read_b64_tr_b16 v[96:97], v17 offset:9344
    buffer_load_dwordx4 v7, s[20:23], s74 offen offset:1024 lds
    ds_read_b64_tr_b16 v[98:99], v17 offset:10112
    s_waitcnt lgkmcnt(7)
    v_mfma_f32_32x32x16_bf16 a[224:239], a[196:199], v[104:107], 0
    v_cmp_eq_u32 vcc, 0, v227
    s_nop 1
    v_cndmask_b32 v230, v231, v230, vcc
    v_mov_b32 v116, v228
    v_mov_b32 v117, v229
    v_mov_b32 v122, v230
    buffer_load_dwordx4 v8, s[20:23], s74 offen offset:2048 lds
    s_add_u32 s74, s74, 196608
    ds_read_b64_tr_b16 v[108:109], v18 offset:128
    ds_read_b64_tr_b16 v[110:111], v18 offset:896
    s_waitcnt lgkmcnt(6)
    v_mfma_f32_32x32x16_bf16 v[20:35], v[88:91], v[72:75], v[20:35]
    s_waitcnt vmcnt(14)
    s_waitcnt lgkmcnt(0)
    s_barrier
    ds_read_b128 v[68:71], v9 offset:16384
    ds_read_b64_tr_b16 v[76:77], v17 offset:12288
    ds_read_b64_tr_b16 v[78:79], v17 offset:13056
    v_mfma_f32_32x32x16_bf16 a[240:255], a[196:199], v[108:111], 0
    ds_read_b64_tr_b16 v[80:81], v17 offset:12352
    ds_read_b64_tr_b16 v[82:83], v17 offset:13120
    v_mfma_f32_32x32x16_bf16 v[36:51], v[92:95], v[72:75], v[36:51]
    ds_read_b64_tr_b16 v[84:85], v17 offset:12416
    ds_read_b64_tr_b16 v[86:87], v17 offset:13184
    v_mfma_f32_32x32x16_bf16 v[52:67], v[96:99], v[72:75], v[52:67]
    s_waitcnt lgkmcnt(4)
    v_mfma_f32_32x32x16_bf16 v[20:35], v[76:79], v[68:71], v[20:35]
    v_mul_u32_u24 v213, 6554, v0
    v_lshrrev_b32 v213, 16, v213
    v_mul_u32_u24 v212, 10, v213
    s_add_u32 m0, s75, 0
    s_nop 0
    buffer_load_dwordx4 v2, s[8:11], s73 offen offset:0 lds
    v_sub_u32 v212, v0, v212
    v_min_u32 v204, 15, v213
    v_mul_u32_u24 v204, 640, v204
    v_lshl_add_u32 v204, v212, 4, v204
    v_add_u32 v205, 126976, v204
    v_add_u32 v204, 114688, v204
    v_lshlrev_b32 v206, 6, v212
    v_add_u32 v206, 139264, v206
    ds_read_b128 v[144:147], v204 offset:0
    ds_read_b128 v[148:151], v204 offset:160
    ds_read_b128 v[152:155], v204 offset:320
    ds_read_b128 v[156:159], v204 offset:480
    ds_read_b128 v[160:163], v204 offset:640
    ds_read_b128 v[164:167], v204 offset:800
    ds_read_b128 v[72:75], v10 offset:16384
    ds_read_b64_tr_b16 v[88:89], v17 offset:15360
    ds_read_b64_tr_b16 v[90:91], v17 offset:16128
    s_waitcnt lgkmcnt(11)
    v_mfma_f32_32x32x16_bf16 v[36:51], v[80:83], v[68:71], v[36:51]
    ds_read_b128 v[168:171], v204 offset:960
    ds_read_b128 v[188:191], v206 offset:0
    ds_read_b128 v[192:195], v206 offset:16
    ds_read_b128 v[196:199], v206 offset:32
    ds_read_b128 v[200:203], v206 offset:48
    ds_read_b128 v[172:175], v205 offset:0
    ds_read_b128 v[176:179], v205 offset:160
    ds_read_b128 v[180:183], v205 offset:320
    ds_read_b128 v[184:187], v205 offset:480
    s_waitcnt lgkmcnt(15)
    v_lshlrev_b32 v214, 16, v144
    v_and_b32 v215, 0xffff0000, v144
    v_lshlrev_b32 v216, 16, v148
    v_and_b32 v217, 0xffff0000, v148
    v_lshlrev_b32 v218, 16, v152
    buffer_load_dwordx4 v3, s[8:11], s73 offen offset:1024 lds
    v_and_b32 v219, 0xffff0000, v152
    s_waitcnt lgkmcnt(14)
    v_lshlrev_b32 v220, 16, v156
    v_and_b32 v221, 0xffff0000, v156
    ds_read_b64_tr_b16 v[92:93], v17 offset:15424
    ds_read_b64_tr_b16 v[94:95], v17 offset:16192
    ds_read_b64_tr_b16 v[100:101], v18 offset:12288
    v_mfma_f32_32x32x16_bf16 v[52:67], v[84:87], v[68:71], v[52:67]
    s_waitcnt lgkmcnt(15)
    v_lshlrev_b32 v222, 16, v160
    v_and_b32 v223, 0xffff0000, v160
    v_lshlrev_b32 v224, 16, v164
    v_and_b32 v225, 0xffff0000, v164
    s_waitcnt lgkmcnt(11)
    v_lshlrev_b32 v226, 16, v168
    v_and_b32 v227, 0xffff0000, v168
    s_waitcnt lgkmcnt(10)
    v_lshlrev_b32 v236, 16, v188
    v_lshlrev_b32 v237, 16, v190
    v_and_b32 v238, 0xffff0000, v188
    v_and_b32 v239, 0xffff0000, v190
    v_lshlrev_b32 v240, 16, v189
    v_lshlrev_b32 v241, 16, v191
    v_and_b32 v242, 0xffff0000, v189
    v_and_b32 v243, 0xffff0000, v191
    s_waitcnt lgkmcnt(6)
    v_lshlrev_b32 v228, 16, v172
    v_and_b32 v229, 0xffff0000, v172
    ds_read_b64_tr_b16 v[96:97], v17 offset:15488
    ds_read_b64_tr_b16 v[98:99], v17 offset:16256
    ds_read_b64_tr_b16 v[102:103], v18 offset:13056
    v_mfma_f32_32x32x16_bf16 v[20:35], v[88:91], v[72:75], v[20:35]
    s_waitcnt lgkmcnt(8)
    v_lshlrev_b32 v230, 16, v176
    v_and_b32 v231, 0xffff0000, v176
    s_waitcnt lgkmcnt(7)
    v_lshlrev_b32 v232, 16, v180
    v_and_b32 v233, 0xffff0000, v180
    buffer_load_dwordx4 v4, s[8:11], s73 offen offset:2048 lds
    s_waitcnt lgkmcnt(6)
    v_lshlrev_b32 v234, 16, v184
    v_and_b32 v235, 0xffff0000, v184
    v_mul_f32 v244, v214, v242
    v_mul_f32 v245, v215, v243
    v_mul_f32 v246, v216, v242
    v_mul_f32 v247, v217, v243
    v_mul_f32 v248, v218, v242
    v_mul_f32 v249, v219, v243
    v_mul_f32 v250, v220, v242
    v_mul_f32 v251, v221, v243
    v_fmac_f32 v244, v216, v240
    v_fmac_f32 v245, v217, v241
    v_fmac_f32 v246, v218, v240
    ds_read_b128 v[68:71], v11 offset:16384
    ds_read_b64_tr_b16 v[76:77], v17 offset:18432
    ds_read_b64_tr_b16 v[78:79], v17 offset:19200
    s_waitcnt lgkmcnt(7)
    v_mfma_f32_32x32x16_bf16 v[36:51], v[92:95], v[72:75], v[36:51]
    v_fmac_f32 v247, v219, v241
    v_fmac_f32 v248, v220, v240
    v_fmac_f32 v249, v221, v241
    v_fmac_f32 v250, v222, v240
    v_fmac_f32 v251, v223, v241
    v_fmac_f32 v244, v218, v238
    v_fmac_f32 v245, v219, v239
    v_fmac_f32 v246, v220, v238
    v_fmac_f32 v247, v221, v239
    v_fmac_f32 v248, v222, v238
    v_fmac_f32 v249, v223, v239
    v_fmac_f32 v250, v224, v238
    v_fmac_f32 v251, v225, v239
    v_fmac_f32 v244, v220, v236
    v_fmac_f32 v245, v221, v237
    buffer_load_dwordx4 v5, s[8:11], s73 offen offset:3072 lds
    v_fmac_f32 v246, v222, v236
    ds_read_b64_tr_b16 v[80:81], v17 offset:18496
    ds_read_b64_tr_b16 v[82:83], v17 offset:19264
    s_waitcnt lgkmcnt(6)
    v_mfma_f32_32x32x16_bf16 v[52:67], v[96:99], v[72:75], v[52:67]
    v_fmac_f32 v247, v223, v237
    v_fmac_f32 v248, v224, v236
    v_fmac_f32 v249, v225, v237
    v_fmac_f32 v250, v226, v236
    v_fmac_f32 v251, v227, v237
    v_mul_f32 v244, v244, v228
    v_mul_f32 v245, v245, v229
    v_mul_f32 v246, v246, v230
    v_mul_f32 v247, v247, v231
    v_mul_f32 v248, v248, v232
    v_mul_f32 v249, v249, v233
    v_mul_f32 v250, v250, v234
    v_mul_f32 v251, v251, v235
    v_cvt_pk_bf16_f32 v128, v244, v246
    v_cvt_pk_bf16_f32 v129, v248, v250
    v_cvt_pk_bf16_f32 v130, v245, v247
    v_cvt_pk_bf16_f32 v131, v249, v251
    ds_read_b64_tr_b16 v[84:85], v17 offset:18560
    ds_read_b64_tr_b16 v[86:87], v17 offset:19328
    s_waitcnt lgkmcnt(7)
    v_mfma_f32_32x32x16_bf16 a[208:223], a[196:199], v[100:103], a[208:223]
    v_lshlrev_b32 v214, 16, v145
    v_and_b32 v215, 0xffff0000, v145
    v_lshlrev_b32 v216, 16, v149
    v_and_b32 v217, 0xffff0000, v149
    v_lshlrev_b32 v218, 16, v153
    v_and_b32 v219, 0xffff0000, v153
    s_add_u32 s73, s73, 128
    s_add_u32 m0, s76, 0
    s_nop 0
    buffer_load_dwordx4 v6, s[20:23], s74 offen offset:0 lds
    v_lshlrev_b32 v220, 16, v157
    v_and_b32 v221, 0xffff0000, v157
    v_lshlrev_b32 v222, 16, v161
    v_and_b32 v223, 0xffff0000, v161
    v_lshlrev_b32 v224, 16, v165
    v_and_b32 v225, 0xffff0000, v165
    v_lshlrev_b32 v226, 16, v169
    v_and_b32 v227, 0xffff0000, v169
    v_lshlrev_b32 v236, 16, v192
    v_lshlrev_b32 v237, 16, v194
    ds_read_b64_tr_b16 v[104:105], v18 offset:12352
    ds_read_b64_tr_b16 v[106:107], v18 offset:13120
    s_waitcnt lgkmcnt(6)
    v_mfma_f32_32x32x16_bf16 v[20:35], v[76:79], v[68:71], v[20:35]
    v_and_b32 v238, 0xffff0000, v192
    v_and_b32 v239, 0xffff0000, v194
    v_lshlrev_b32 v240, 16, v193
    v_lshlrev_b32 v241, 16, v195
    v_and_b32 v242, 0xffff0000, v193
    v_and_b32 v243, 0xffff0000, v195
    v_lshlrev_b32 v228, 16, v173
    v_and_b32 v229, 0xffff0000, v173
    v_lshlrev_b32 v230, 16, v177
    v_and_b32 v231, 0xffff0000, v177
    v_lshlrev_b32 v232, 16, v181
    v_and_b32 v233, 0xffff0000, v181
    v_lshlrev_b32 v234, 16, v185
    v_and_b32 v235, 0xffff0000, v185
    v_mul_f32 v244, v214, v242
    v_mul_f32 v245, v215, v243
    v_mul_f32 v246, v216, v242
    ds_read_b128 v[72:75], v12 offset:16384
    ds_read_b64_tr_b16 v[88:89], v17 offset:21504
    buffer_load_dwordx4 v7, s[20:23], s74 offen offset:1024 lds
    ds_read_b64_tr_b16 v[90:91], v17 offset:22272
    s_waitcnt lgkmcnt(7)
    v_mfma_f32_32x32x16_bf16 v[36:51], v[80:83], v[68:71], v[36:51]
    v_mul_f32 v247, v217, v243
    v_mul_f32 v248, v218, v242
    v_mul_f32 v249, v219, v243
    v_mul_f32 v250, v220, v242
    v_mul_f32 v251, v221, v243
    v_fmac_f32 v244, v216, v240
    v_fmac_f32 v245, v217, v241
    v_fmac_f32 v246, v218, v240
    v_fmac_f32 v247, v219, v241
    v_fmac_f32 v248, v220, v240
    v_fmac_f32 v249, v221, v241
    v_fmac_f32 v250, v222, v240
    v_fmac_f32 v251, v223, v241
    v_fmac_f32 v244, v218, v238
    v_fmac_f32 v245, v219, v239
    v_fmac_f32 v246, v220, v238
    ds_read_b64_tr_b16 v[92:93], v17 offset:21568
    ds_read_b64_tr_b16 v[94:95], v17 offset:22336
    s_waitcnt lgkmcnt(7)
    v_mfma_f32_32x32x16_bf16 v[52:67], v[84:87], v[68:71], v[52:67]
    v_fmac_f32 v247, v221, v239
    v_fmac_f32 v248, v222, v238
    v_fmac_f32 v249, v223, v239
    v_fmac_f32 v250, v224, v238
    v_fmac_f32 v251, v225, v239
    v_fmac_f32 v244, v220, v236
    v_fmac_f32 v245, v221, v237
    v_fmac_f32 v246, v222, v236
    v_fmac_f32 v247, v223, v237
    v_fmac_f32 v248, v224, v236
    buffer_load_dwordx4 v8, s[20:23], s74 offen offset:2048 lds
    s_add_u32 s74, s74, 196608
    v_fmac_f32 v249, v225, v237
    v_fmac_f32 v250, v226, v236
    v_fmac_f32 v251, v227, v237
    v_mul_f32 v244, v244, v228
    v_mul_f32 v245, v245, v229
    v_mul_f32 v246, v246, v230
    v_mul_f32 v247, v247, v231
    ds_read_b64_tr_b16 v[96:97], v17 offset:21632
    ds_read_b64_tr_b16 v[98:99], v17 offset:22400
    s_waitcnt lgkmcnt(7)
    v_mfma_f32_32x32x16_bf16 a[224:239], a[196:199], v[104:107], a[224:239]
    v_mul_f32 v248, v248, v232
    v_mul_f32 v249, v249, v233
    v_mul_f32 v250, v250, v234
    v_mul_f32 v251, v251, v235
    v_cvt_pk_bf16_f32 v132, v244, v246
    v_cvt_pk_bf16_f32 v133, v248, v250
    v_cvt_pk_bf16_f32 v134, v245, v247
    v_cvt_pk_bf16_f32 v135, v249, v251
    v_lshlrev_b32 v214, 16, v146
    v_and_b32 v215, 0xffff0000, v146
    v_lshlrev_b32 v216, 16, v150
    v_and_b32 v217, 0xffff0000, v150
    v_lshlrev_b32 v218, 16, v154
    v_and_b32 v219, 0xffff0000, v154
    v_lshlrev_b32 v220, 16, v158
    v_and_b32 v221, 0xffff0000, v158
    ds_read_b64_tr_b16 v[108:109], v18 offset:12416
    ds_read_b64_tr_b16 v[110:111], v18 offset:13184
    s_waitcnt lgkmcnt(6)
    v_mfma_f32_32x32x16_bf16 v[20:35], v[88:91], v[72:75], v[20:35]
    s_waitcnt vmcnt(14)
    s_waitcnt lgkmcnt(0)
    s_barrier
    ds_read_b128 v[68:71], v9 offset:32768
    ds_read_b64_tr_b16 v[76:77], v17 offset:24576
    ds_read_b64_tr_b16 v[78:79], v17 offset:25344
    v_mfma_f32_32x32x16_bf16 a[240:255], a[196:199], v[108:111], a[240:255]
    ds_read_b64_tr_b16 v[80:81], v17 offset:24640
    ds_read_b64_tr_b16 v[82:83], v17 offset:25408
    v_mfma_f32_32x32x16_bf16 v[36:51], v[92:95], v[72:75], v[36:51]
    ds_read_b64_tr_b16 v[84:85], v17 offset:24704
    ds_read_b64_tr_b16 v[86:87], v17 offset:25472
    v_mfma_f32_32x32x16_bf16 v[52:67], v[96:99], v[72:75], v[52:67]
    s_waitcnt lgkmcnt(4)
    v_mfma_f32_32x32x16_bf16 v[20:35], v[76:79], v[68:71], v[20:35]
    v_lshlrev_b32 v222, 16, v162
    v_and_b32 v223, 0xffff0000, v162
    v_lshlrev_b32 v224, 16, v166
    s_add_u32 m0, s75, 16384
    s_nop 0
    buffer_load_dwordx4 v2, s[8:11], s73 offen offset:0 lds
    v_and_b32 v225, 0xffff0000, v166
    v_lshlrev_b32 v226, 16, v170
    v_and_b32 v227, 0xffff0000, v170
    v_lshlrev_b32 v236, 16, v196
    v_lshlrev_b32 v237, 16, v198
    v_and_b32 v238, 0xffff0000, v196
    v_and_b32 v239, 0xffff0000, v198
    v_lshlrev_b32 v240, 16, v197
    v_lshlrev_b32 v241, 16, v199
    v_and_b32 v242, 0xffff0000, v197
    v_and_b32 v243, 0xffff0000, v199
    v_lshlrev_b32 v228, 16, v174
    ds_read_b128 v[72:75], v10 offset:32768
    ds_read_b64_tr_b16 v[88:89], v17 offset:27648
    ds_read_b64_tr_b16 v[90:91], v17 offset:28416
    s_waitcnt lgkmcnt(5)
    v_mfma_f32_32x32x16_bf16 v[36:51], v[80:83], v[68:71], v[36:51]
    v_and_b32 v229, 0xffff0000, v174
    v_lshlrev_b32 v230, 16, v178
    v_and_b32 v231, 0xffff0000, v178
    v_lshlrev_b32 v232, 16, v182
    v_and_b32 v233, 0xffff0000, v182
    v_lshlrev_b32 v234, 16, v186
    v_and_b32 v235, 0xffff0000, v186
    v_mul_f32 v244, v214, v242
    v_mul_f32 v245, v215, v243
    v_mul_f32 v246, v216, v242
    v_mul_f32 v247, v217, v243
    v_mul_f32 v248, v218, v242
    buffer_load_dwordx4 v3, s[8:11], s73 offen offset:1024 lds
    v_mul_f32 v249, v219, v243
    v_mul_f32 v250, v220, v242
    ds_read_b64_tr_b16 v[92:93], v17 offset:27712
    ds_read_b64_tr_b16 v[94:95], v17 offset:28480
    ds_read_b64_tr_b16 v[100:101], v18 offset:24576
    s_waitcnt lgkmcnt(6)
    v_mfma_f32_32x32x16_bf16 v[52:67], v[84:87], v[68:71], v[52:67]
    v_mul_f32 v251, v221, v243
    v_fmac_f32 v244, v216, v240
    v_fmac_f32 v245, v217, v241
    v_fmac_f32 v246, v218, v240
    v_fmac_f32 v247, v219, v241
    v_fmac_f32 v248, v220, v240
    v_fmac_f32 v249, v221, v241
    v_fmac_f32 v250, v222, v240
    v_fmac_f32 v251, v223, v241
    v_fmac_f32 v244, v218, v238
    v_fmac_f32 v245, v219, v239
    v_fmac_f32 v246, v220, v238
    v_fmac_f32 v247, v221, v239
    v_fmac_f32 v248, v222, v238
    ds_read_b64_tr_b16 v[96:97], v17 offset:27776
    ds_read_b64_tr_b16 v[98:99], v17 offset:28544
    ds_read_b64_tr_b16 v[102:103], v18 offset:25344
    s_waitcnt lgkmcnt(6)
    v_mfma_f32_32x32x16_bf16 v[20:35], v[88:91], v[72:75], v[20:35]
    v_fmac_f32 v249, v223, v239
    v_fmac_f32 v250, v224, v238
    v_fmac_f32 v251, v225, v239
    buffer_load_dwordx4 v4, s[8:11], s73 offen offset:2048 lds
    v_fmac_f32 v244, v220, v236
    v_fmac_f32 v245, v221, v237
    v_fmac_f32 v246, v222, v236
    v_fmac_f32 v247, v223, v237
    v_fmac_f32 v248, v224, v236
    v_fmac_f32 v249, v225, v237
    v_fmac_f32 v250, v226, v236
    v_fmac_f32 v251, v227, v237
    v_mul_f32 v244, v244, v228
    v_mul_f32 v245, v245, v229
    v_mul_f32 v246, v246, v230
    ds_read_b128 v[68:71], v11 offset:32768
    ds_read_b64_tr_b16 v[76:77], v17 offset:30720
    ds_read_b64_tr_b16 v[78:79], v17 offset:31488
    s_waitcnt lgkmcnt(7)
    v_mfma_f32_32x32x16_bf16 v[36:51], v[92:95], v[72:75], v[36:51]
    v_mul_f32 v247, v247, v231
    v_mul_f32 v248, v248, v232
    v_mul_f32 v249, v249, v233
    v_mul_f32 v250, v250, v234
    v_mul_f32 v251, v251, v235
    v_cvt_pk_bf16_f32 v136, v244, v246
    v_cvt_pk_bf16_f32 v137, v248, v250
    v_cvt_pk_bf16_f32 v138, v245, v247
    v_cvt_pk_bf16_f32 v139, v249, v251
    v_lshlrev_b32 v214, 16, v147
    v_and_b32 v215, 0xffff0000, v147
    v_lshlrev_b32 v216, 16, v151
    v_and_b32 v217, 0xffff0000, v151
    buffer_load_dwordx4 v5, s[8:11], s73 offen offset:3072 lds
    v_lshlrev_b32 v218, 16, v155
    ds_read_b64_tr_b16 v[80:81], v17 offset:30784
    ds_read_b64_tr_b16 v[82:83], v17 offset:31552
    s_waitcnt lgkmcnt(6)
    v_mfma_f32_32x32x16_bf16 v[52:67], v[96:99], v[72:75], v[52:67]
    v_and_b32 v219, 0xffff0000, v155
    v_lshlrev_b32 v220, 16, v159
    v_and_b32 v221, 0xffff0000, v159
    v_lshlrev_b32 v222, 16, v163
    v_and_b32 v223, 0xffff0000, v163
    v_lshlrev_b32 v224, 16, v167
    v_and_b32 v225, 0xffff0000, v167
    v_lshlrev_b32 v226, 16, v171
    v_and_b32 v227, 0xffff0000, v171
    v_lshlrev_b32 v236, 16, v200
    v_lshlrev_b32 v237, 16, v202
    v_and_b32 v238, 0xffff0000, v200
    v_and_b32 v239, 0xffff0000, v202
    v_lshlrev_b32 v240, 16, v201
    v_lshlrev_b32 v241, 16, v203
    ds_read_b64_tr_b16 v[84:85], v17 offset:30848
    ds_read_b64_tr_b16 v[86:87], v17 offset:31616
    s_waitcnt lgkmcnt(7)
    v_mfma_f32_32x32x16_bf16 a[208:223], a[196:199], v[100:103], a[208:223]
    v_and_b32 v242, 0xffff0000, v201
    v_and_b32 v243, 0xffff0000, v203
    v_lshlrev_b32 v228, 16, v175
    v_and_b32 v229, 0xffff0000, v175
    v_lshlrev_b32 v230, 16, v179
    v_and_b32 v231, 0xffff0000, v179
    s_add_u32 s73, s73, 128
    s_add_u32 m0, s76, 12288
    s_nop 0
    buffer_load_dwordx4 v6, s[20:23], s74 offen offset:0 lds
    v_lshlrev_b32 v232, 16, v183
    v_and_b32 v233, 0xffff0000, v183
    v_lshlrev_b32 v234, 16, v187
    v_and_b32 v235, 0xffff0000, v187
    v_mul_f32 v244, v214, v242
    v_mul_f32 v245, v215, v243
    v_mul_f32 v246, v216, v242
    v_mul_f32 v247, v217, v243
    ds_read_b64_tr_b16 v[104:105], v18 offset:24640
    ds_read_b64_tr_b16 v[106:107], v18 offset:25408
    s_waitcnt lgkmcnt(6)
    v_mfma_f32_32x32x16_bf16 v[20:35], v[76:79], v[68:71], v[20:35]
    v_mul_f32 v248, v218, v242
    v_mul_f32 v249, v219, v243
    v_mul_f32 v250, v220, v242
    v_mul_f32 v251, v221, v243
    v_fmac_f32 v244, v216, v240
    v_fmac_f32 v245, v217, v241
    v_fmac_f32 v246, v218, v240
    v_fmac_f32 v247, v219, v241
    v_fmac_f32 v248, v220, v240
    v_fmac_f32 v249, v221, v241
    v_fmac_f32 v250, v222, v240
    v_fmac_f32 v251, v223, v241
    v_fmac_f32 v244, v218, v238
    v_fmac_f32 v245, v219, v239
    ds_read_b128 v[72:75], v12 offset:32768
    ds_read_b64_tr_b16 v[88:89], v17 offset:33792
    ds_read_b64_tr_b16 v[90:91], v17 offset:34560
    buffer_load_dwordx4 v7, s[20:23], s74 offen offset:1024 lds
    s_waitcnt lgkmcnt(7)
    v_mfma_f32_32x32x16_bf16 v[36:51], v[80:83], v[68:71], v[36:51]
    v_fmac_f32 v246, v220, v238
    v_fmac_f32 v247, v221, v239
    v_fmac_f32 v248, v222, v238
    v_fmac_f32 v249, v223, v239
    v_fmac_f32 v250, v224, v238
    v_fmac_f32 v251, v225, v239
    v_fmac_f32 v244, v220, v236
    v_fmac_f32 v245, v221, v237
    v_fmac_f32 v246, v222, v236
    v_fmac_f32 v247, v223, v237
    v_fmac_f32 v248, v224, v236
    v_fmac_f32 v249, v225, v237
    v_fmac_f32 v250, v226, v236
    v_fmac_f32 v251, v227, v237
    ds_read_b64_tr_b16 v[92:93], v17 offset:33856
    ds_read_b64_tr_b16 v[94:95], v17 offset:34624
    s_waitcnt lgkmcnt(7)
    v_mfma_f32_32x32x16_bf16 v[52:67], v[84:87], v[68:71], v[52:67]
    v_mul_f32 v244, v244, v228
    v_mul_f32 v245, v245, v229
    v_mul_f32 v246, v246, v230
    v_mul_f32 v247, v247, v231
    v_mul_f32 v248, v248, v232
    v_mul_f32 v249, v249, v233
    v_mul_f32 v250, v250, v234
    v_mul_f32 v251, v251, v235
    v_cvt_pk_bf16_f32 v140, v244, v246
    buffer_load_dwordx4 v8, s[20:23], s74 offen offset:2048 lds
    s_add_u32 s74, s74, 196608
    v_cvt_pk_bf16_f32 v141, v248, v250
    v_cvt_pk_bf16_f32 v142, v245, v247
    v_cvt_pk_bf16_f32 v143, v249, v251
    v_and_b32 v214, 14, v212
    v_xor_b32 v214, v214, v213
    ds_read_b64_tr_b16 v[96:97], v17 offset:33920
    ds_read_b64_tr_b16 v[98:99], v17 offset:34688
    s_waitcnt lgkmcnt(7)
    v_mfma_f32_32x32x16_bf16 a[224:239], a[196:199], v[104:107], a[224:239]
    v_lshlrev_b32 v214, 3, v214
    v_lshl_add_u32 v214, v212, 10, v214
    v_mov_b32 v215, 12288
    v_cmp_gt_u32 vcc, 160, v0
    s_nop 1
    v_cndmask_b32 v214, v215, v214, vcc
    v_add_u32 v214, 114688, v214
    ds_write_b64 v214, v[128:129] offset:0
    ds_write_b64 v214, v[130:131] offset:128
    ds_write_b64 v214, v[132:133] offset:256
    ds_write_b64 v214, v[134:135] offset:384
    ds_write_b64 v214, v[136:137] offset:512
    ds_write_b64 v214, v[138:139] offset:640
    ds_write_b64 v214, v[140:141] offset:768
    ds_write_b64 v214, v[142:143] offset:896
    ds_read_b64_tr_b16 v[108:109], v18 offset:24704
    ds_read_b64_tr_b16 v[110:111], v18 offset:25472
    s_waitcnt lgkmcnt(14)
    v_mfma_f32_32x32x16_bf16 v[20:35], v[88:91], v[72:75], v[20:35]
    s_waitcnt vmcnt(14)
    s_waitcnt lgkmcnt(0)
    s_barrier
    ds_read_b128 v[68:71], v9 offset:49152
    ds_read_b64_tr_b16 v[76:77], v17 offset:36864
    ds_read_b64_tr_b16 v[78:79], v17 offset:37632
    v_mfma_f32_32x32x16_bf16 a[240:255], a[196:199], v[108:111], a[240:255]
    ds_read_b64_tr_b16 v[80:81], v17 offset:36928
    ds_read_b64_tr_b16 v[82:83], v17 offset:37696
    v_mfma_f32_32x32x16_bf16 v[36:51], v[92:95], v[72:75], v[36:51]
    ds_read_b64_tr_b16 v[84:85], v17 offset:36992
    ds_read_b64_tr_b16 v[86:87], v17 offset:37760
    v_mfma_f32_32x32x16_bf16 v[52:67], v[96:99], v[72:75], v[52:67]
    s_waitcnt lgkmcnt(4)
    v_mfma_f32_32x32x16_bf16 v[20:35], v[76:79], v[68:71], v[20:35]
    v_lshrrev_b32 v214, 3, v0
    s_add_u32 m0, s75, 32768
    s_nop 0
    buffer_load_dwordx4 v2, s[8:11], s73 offen offset:0 lds
    v_and_b32 v215, 7, v0
    v_lshrrev_b32 v216, 6, v0
    v_lshlrev_b32 v218, 1, v215
    v_lshlrev_b32 v219, 7, v214
    v_add_u32 v219, 114688, v219
    v_add_u32 v217, 0, v216
    ds_read_b128 v[72:75], v10 offset:49152
    ds_read_b64_tr_b16 v[88:89], v17 offset:39936
    ds_read_b64_tr_b16 v[90:91], v17 offset:40704
    s_waitcnt lgkmcnt(5)
    v_mfma_f32_32x32x16_bf16 v[36:51], v[80:83], v[68:71], v[36:51]
    v_and_b32 v217, 14, v217
    v_xor_b32 v217, v217, v218
    v_lshl_add_u32 v217, v217, 3, v219
    ds_read_b128 v[128:131], v217 offset:0
    buffer_load_dwordx4 v3, s[8:11], s73 offen offset:1024 lds
    v_add_u32 v217, 4, v216
    v_and_b32 v217, 14, v217
    v_xor_b32 v217, v217, v218
    ds_read_b64_tr_b16 v[92:93], v17 offset:40000
    ds_read_b64_tr_b16 v[94:95], v17 offset:40768
    ds_read_b64_tr_b16 v[100:101], v18 offset:36864
    s_waitcnt lgkmcnt(7)
    v_mfma_f32_32x32x16_bf16 v[52:67], v[84:87], v[68:71], v[52:67]
    v_lshl_add_u32 v217, v217, 3, v219
    ds_read_b128 v[132:135], v217 offset:4096
    v_add_u32 v217, 8, v216
    v_and_b32 v217, 14, v217
    v_xor_b32 v217, v217, v218
    v_lshl_add_u32 v217, v217, 3, v219
    ds_read_b64_tr_b16 v[96:97], v17 offset:40064
    ds_read_b64_tr_b16 v[98:99], v17 offset:40832
    buffer_load_dwordx4 v4, s[8:11], s73 offen offset:2048 lds
    ds_read_b64_tr_b16 v[102:103], v18 offset:37632
    s_waitcnt lgkmcnt(8)
    v_mfma_f32_32x32x16_bf16 v[20:35], v[88:91], v[72:75], v[20:35]
    ds_read_b128 v[136:139], v217 offset:8192
    s_mul_i32 s80, s71, 327680
    s_lshl_b32 s81, s70, 7
    s_add_u32 s80, s80, s81
    s_add_u32 s80, s80, 1048576
    v_lshlrev_b32 v220, 12, v214
    v_lshl_add_u32 v220, v215, 4, v220
    ds_read_b128 v[68:71], v11 offset:49152
    ds_read_b64_tr_b16 v[76:77], v17 offset:43008
    ds_read_b64_tr_b16 v[78:79], v17 offset:43776
    s_waitcnt lgkmcnt(9)
    v_mfma_f32_32x32x16_bf16 v[36:51], v[92:95], v[72:75], v[36:51]
    buffer_load_dwordx4 v5, s[8:11], s73 offen offset:3072 lds
    v_add_u32 v221, 131072, v220
    v_add_u32 v222, 262144, v220
    v_mov_b32 v223, 2147483648
    v_cmp_gt_u32 vcc, 128, v0
    s_nop 1
    v_cndmask_b32 v222, v223, v222, vcc
    buffer_store_dwordx4 v[128:131], v220, s[36:39], s80 offen sc1
    ds_read_b64_tr_b16 v[80:81], v17 offset:43072
    ds_read_b64_tr_b16 v[82:83], v17 offset:43840
    s_waitcnt lgkmcnt(7)
    v_mfma_f32_32x32x16_bf16 v[52:67], v[96:99], v[72:75], v[52:67]
    ds_read_b64_tr_b16 v[84:85], v17 offset:43136
    ds_read_b64_tr_b16 v[86:87], v17 offset:43904
    s_add_u32 s73, s73, 128
    s_add_u32 m0, s76, 24576
    s_nop 0
    buffer_load_dwordx4 v6, s[20:23], s74 offen offset:0 lds
    s_waitcnt lgkmcnt(8)
    v_mfma_f32_32x32x16_bf16 a[208:223], a[196:199], v[100:103], a[208:223]
    buffer_store_dwordx4 v[132:135], v221, s[36:39], s80 offen sc1
    ds_read_b64_tr_b16 v[104:105], v18 offset:36928
    ds_read_b64_tr_b16 v[106:107], v18 offset:37696
    s_waitcnt lgkmcnt(6)
    v_mfma_f32_32x32x16_bf16 v[20:35], v[76:79], v[68:71], v[20:35]
    ds_read_b128 v[72:75], v12 offset:49152
    ds_read_b64_tr_b16 v[88:89], v17 offset:46080
    ds_read_b64_tr_b16 v[90:91], v17 offset:46848
    buffer_load_dwordx4 v7, s[20:23], s74 offen offset:1024 lds
    s_waitcnt lgkmcnt(7)
    v_mfma_f32_32x32x16_bf16 v[36:51], v[80:83], v[68:71], v[36:51]
    buffer_store_dwordx4 v[136:139], v222, s[36:39], s80 offen sc1
    ds_read_b64_tr_b16 v[92:93], v17 offset:46144
    ds_read_b64_tr_b16 v[94:95], v17 offset:46912
    s_waitcnt lgkmcnt(7)
    v_mfma_f32_32x32x16_bf16 v[52:67], v[84:87], v[68:71], v[52:67]
    ds_read_b64_tr_b16 v[96:97], v17 offset:46208
    ds_read_b64_tr_b16 v[98:99], v17 offset:46976
    buffer_load_dwordx4 v8, s[20:23], s74 offen offset:2048 lds
    s_add_u32 s74, s74, 196608
    s_waitcnt lgkmcnt(7)
    v_mfma_f32_32x32x16_bf16 a[224:239], a[196:199], v[104:107], a[224:239]
    buffer_store_dwordx2 v[116:117], v122, s[36:39], 0 offen sc1
    ds_read_b64_tr_b16 v[108:109], v18 offset:36992
    ds_read_b64_tr_b16 v[110:111], v18 offset:37760
    s_waitcnt lgkmcnt(6)
    v_mfma_f32_32x32x16_bf16 v[20:35], v[88:91], v[72:75], v[20:35]
    s_waitcnt vmcnt(18)
    s_waitcnt lgkmcnt(0)
    s_barrier
    ds_read_b128 v[68:71], v9 offset:0
    ds_read_b64_tr_b16 v[76:77], v17 offset:0
    ds_read_b64_tr_b16 v[78:79], v17 offset:768
    v_mfma_f32_32x32x16_bf16 a[240:255], a[196:199], v[108:111], a[240:255]
    ds_read_b64_tr_b16 v[80:81], v17 offset:64
    ds_read_b64_tr_b16 v[82:83], v17 offset:832
    v_mfma_f32_32x32x16_bf16 v[36:51], v[92:95], v[72:75], v[36:51]
    ds_read_b64_tr_b16 v[84:85], v17 offset:128
    ds_read_b64_tr_b16 v[86:87], v17 offset:896
    v_mfma_f32_32x32x16_bf16 v[52:67], v[96:99], v[72:75], v[52:67]
    s_waitcnt lgkmcnt(4)
    v_mfma_f32_32x32x16_bf16 v[20:35], v[76:79], v[68:71], v[20:35]
    s_add_u32 m0, s75, 49152
    s_nop 0
    buffer_load_dwordx4 v2, s[8:11], s73 offen offset:0 lds
    s_waitcnt vmcnt(1)
    ds_read_b128 v[72:75], v10 offset:0
    ds_read_b64_tr_b16 v[88:89], v17 offset:3072
    ds_read_b64_tr_b16 v[90:91], v17 offset:3840
    s_waitcnt lgkmcnt(5)
    v_mfma_f32_32x32x16_bf16 v[36:51], v[80:83], v[68:71], v[36:51]
    ds_read_b64_tr_b16 v[92:93], v17 offset:3136
    ds_read_b64_tr_b16 v[94:95], v17 offset:3904
    ds_read_b64_tr_b16 v[100:101], v18 offset:0
    buffer_load_dwordx4 v3, s[8:11], s73 offen offset:1024 lds
    s_waitcnt lgkmcnt(6)
    v_mfma_f32_32x32x16_bf16 v[52:67], v[84:87], v[68:71], v[52:67]
    ds_read_b64_tr_b16 v[96:97], v17 offset:3200
    ds_read_b64_tr_b16 v[98:99], v17 offset:3968
    ds_read_b64_tr_b16 v[102:103], v18 offset:768
    s_waitcnt lgkmcnt(6)
    v_mfma_f32_32x32x16_bf16 v[20:35], v[88:91], v[72:75], v[20:35]
    ds_read_b128 v[68:71], v11 offset:0
    ds_read_b64_tr_b16 v[76:77], v17 offset:6144
    ds_read_b64_tr_b16 v[78:79], v17 offset:6912
    buffer_load_dwordx4 v4, s[8:11], s73 offen offset:2048 lds
    s_waitcnt lgkmcnt(7)
    v_mfma_f32_32x32x16_bf16 v[36:51], v[92:95], v[72:75], v[36:51]
    ds_read_b64_tr_b16 v[80:81], v17 offset:6208
    ds_read_b64_tr_b16 v[82:83], v17 offset:6976
    s_waitcnt lgkmcnt(6)
    v_mfma_f32_32x32x16_bf16 v[52:67], v[96:99], v[72:75], v[52:67]
    buffer_load_dwordx4 v5, s[8:11], s73 offen offset:3072 lds
    ds_read_b64_tr_b16 v[84:85], v17 offset:6272
    ds_read_b64_tr_b16 v[86:87], v17 offset:7040
    s_waitcnt lgkmcnt(7)
    v_mfma_f32_32x32x16_bf16 a[208:223], a[196:199], v[100:103], a[208:223]
    ds_read_b64_tr_b16 v[104:105], v18 offset:64
    ds_read_b64_tr_b16 v[106:107], v18 offset:832
    s_add_u32 s73, s73, 128
    s_add_u32 m0, s76, 36864
    s_nop 0
    buffer_load_dwordx4 v6, s[20:23], s74 offen offset:0 lds
    s_waitcnt lgkmcnt(6)
    v_mfma_f32_32x32x16_bf16 v[20:35], v[76:79], v[68:71], v[20:35]
    ds_read_b128 v[72:75], v12 offset:0
    ds_read_b64_tr_b16 v[88:89], v17 offset:9216
    ds_read_b64_tr_b16 v[90:91], v17 offset:9984
    s_waitcnt lgkmcnt(7)
    v_mfma_f32_32x32x16_bf16 v[36:51], v[80:83], v[68:71], v[36:51]
    ds_read_b64_tr_b16 v[92:93], v17 offset:9280
    ds_read_b64_tr_b16 v[94:95], v17 offset:10048
    buffer_load_dwordx4 v7, s[20:23], s74 offen offset:1024 lds
    s_waitcnt lgkmcnt(7)
    v_mfma_f32_32x32x16_bf16 v[52:67], v[84:87], v[68:71], v[52:67]
    ds_read_b64_tr_b16 v[96:97], v17 offset:9344
    ds_read_b64_tr_b16 v[98:99], v17 offset:10112
    s_waitcnt lgkmcnt(7)
    v_mfma_f32_32x32x16_bf16 a[224:239], a[196:199], v[104:107], a[224:239]
    buffer_load_dwordx4 v8, s[20:23], s74 offen offset:2048 lds
    s_add_u32 s74, s74, 196608
    ds_read_b64_tr_b16 v[108:109], v18 offset:128
    ds_read_b64_tr_b16 v[110:111], v18 offset:896
    s_waitcnt lgkmcnt(6)
    v_mfma_f32_32x32x16_bf16 v[20:35], v[88:91], v[72:75], v[20:35]
    s_waitcnt lgkmcnt(0)
    s_barrier
    ds_read_b128 v[68:71], v9 offset:16384
    ds_read_b64_tr_b16 v[76:77], v17 offset:12288
    ds_read_b64_tr_b16 v[78:79], v17 offset:13056
    v_mfma_f32_32x32x16_bf16 a[240:255], a[196:199], v[108:111], a[240:255]
    ds_read_b64_tr_b16 v[80:81], v17 offset:12352
    ds_read_b64_tr_b16 v[82:83], v17 offset:13120
    v_mfma_f32_32x32x16_bf16 v[36:51], v[92:95], v[72:75], v[36:51]
    ds_read_b64_tr_b16 v[84:85], v17 offset:12416
    ds_read_b64_tr_b16 v[86:87], v17 offset:13184
    v_mfma_f32_32x32x16_bf16 v[52:67], v[96:99], v[72:75], v[52:67]
    s_waitcnt lgkmcnt(4)
    v_mfma_f32_32x32x16_bf16 v[20:35], v[76:79], v[68:71], v[20:35]
    s_mov_b32 s80, s2
    s_add_u32 m0, s75, 0
    s_nop 0
    buffer_load_dwordx4 v2, s[8:11], s73 offen offset:0 lds
    s_lshl_b32 s80, s80, 6
    s_add_u32 s80, s80, 4096
    v_mov_b32 v124, s80
    v_mov_b32 v125, 2147483648
    v_cmp_eq_u32 vcc, 0, v0
    s_nop 1
    v_cndmask_b32 v124, v125, v124, vcc
    v_mov_b32 v125, s5
    buffer_store_dword v125, v124, s[36:39], 0 offen sc1
    s_lshl_b32 s80, s2, 2
    ds_read_b128 v[72:75], v10 offset:16384
    ds_read_b64_tr_b16 v[88:89], v17 offset:15360
    ds_read_b64_tr_b16 v[90:91], v17 offset:16128
    s_waitcnt lgkmcnt(5)
    v_mfma_f32_32x32x16_bf16 v[36:51], v[80:83], v[68:71], v[36:51]
    s_add_u32 s80, s80, s4
    s_lshl_b32 s80, s80, 12
    v_lshlrev_b32 v202, 4, v1
    buffer_load_dwordx4 v[208:211], v202, s[28:31], s80 offen offset:0 nt
    ds_read_b64_tr_b16 v[92:93], v17 offset:15424
    ds_read_b64_tr_b16 v[94:95], v17 offset:16192
    buffer_load_dwordx4 v3, s[8:11], s73 offen offset:1024 lds
    ds_read_b64_tr_b16 v[100:101], v18 offset:12288
    s_waitcnt lgkmcnt(6)
    v_mfma_f32_32x32x16_bf16 v[52:67], v[84:87], v[68:71], v[52:67]
    buffer_load_dwordx4 v[212:215], v202, s[28:31], s80 offen offset:1024 nt
    ds_read_b64_tr_b16 v[96:97], v17 offset:15488
    ds_read_b64_tr_b16 v[98:99], v17 offset:16256
    ds_read_b64_tr_b16 v[102:103], v18 offset:13056
    s_waitcnt lgkmcnt(6)
    v_mfma_f32_32x32x16_bf16 v[20:35], v[88:91], v[72:75], v[20:35]
    buffer_load_dwordx4 v[216:219], v202, s[28:31], s80 offen offset:2048 nt
    ds_read_b128 v[68:71], v11 offset:16384
    ds_read_b64_tr_b16 v[76:77], v17 offset:18432
    ds_read_b64_tr_b16 v[78:79], v17 offset:19200
    s_waitcnt lgkmcnt(7)
    v_mfma_f32_32x32x16_bf16 v[36:51], v[92:95], v[72:75], v[36:51]
    buffer_load_dwordx4 v4, s[8:11], s73 offen offset:2048 lds
    buffer_load_dwordx4 v[220:223], v202, s[28:31], s80 offen offset:3072 nt
    ds_read_b64_tr_b16 v[80:81], v17 offset:18496
    ds_read_b64_tr_b16 v[82:83], v17 offset:19264
    s_waitcnt lgkmcnt(6)
    v_mfma_f32_32x32x16_bf16 v[52:67], v[96:99], v[72:75], v[52:67]
    s_mul_i32 s80, s69, 192
    v_and_b32 v121, 31, v1
    v_lshl_add_u32 v121, v121, 1, s80
    global_load_ushort v118, v121, s[56:57]
    global_load_ushort v119, v121, s[56:57] offset:64
    ds_read_b64_tr_b16 v[84:85], v17 offset:18560
    ds_read_b64_tr_b16 v[86:87], v17 offset:19328
    s_waitcnt lgkmcnt(7)
    v_mfma_f32_32x32x16_bf16 a[208:223], a[196:199], v[100:103], a[208:223]
    global_load_ushort v120, v121, s[56:57] offset:128
    s_mul_i32 s80, s4, 21248
    buffer_load_dwordx4 v5, s[8:11], s73 offen offset:3072 lds
    s_add_u32 s80, s80, 90112
    s_cmp_eq_u32 s4, 3
    s_cselect_b32 s80, 32768, s80
    v_lshlrev_b32 v176, 4, v1
    v_add_u32 v176, s80, v176
    ds_read_b64_tr_b16 v[104:105], v18 offset:12352
    ds_read_b64_tr_b16 v[106:107], v18 offset:13120
    s_waitcnt lgkmcnt(6)
    v_mfma_f32_32x32x16_bf16 v[20:35], v[76:79], v[68:71], v[20:35]
    v_bfe_u32 v177, v1, 1, 2
    v_mul_u32_u24 v177, 4160, v177
    v_and_b32 v178, 1, v1
    v_lshl_add_u32 v177, v178, 4, v177
    v_add_u32 v177, s80, v177
    v_min_u32 v179, 29, v1
    v_lshlrev_b32 v179, 4, v179
    s_add_u32 s80, s80, 16640
    v_add_u32 v179, s80, v179
    v_mov_b32 v180, 0
    v_mov_b32 v181, 0
    s_add_u32 s73, s73, 128
    s_add_u32 m0, s76, 0
    s_nop 0
    buffer_load_dwordx4 v6, s[20:23], s74 offen offset:0 lds
    v_mov_b32 v182, 0
    ds_read_b128 v[72:75], v12 offset:16384
    ds_read_b64_tr_b16 v[88:89], v17 offset:21504
    ds_read_b64_tr_b16 v[90:91], v17 offset:22272
    s_waitcnt lgkmcnt(7)
    v_mfma_f32_32x32x16_bf16 v[36:51], v[80:83], v[68:71], v[36:51]
    v_mov_b32 v183, 0
    v_and_b32 v184, 15, v1
    v_lshrrev_b32 v185, 4, v1
    v_lshlrev_b32 v136, 5, v184
    v_lshlrev_b32 v186, 4, v185
    v_sub_u32 v136, v136, v186
    v_add_u32 v136, 48, v136
    v_add_u32 v136, s80, v136
    v_bfe_u32 v187, v1, 2, 2
    v_mul_u32_u24 v137, 4160, v187
    v_add_u32 v137, v137, v186
    v_and_b32 v187, 3, v1
    ds_read_b64_tr_b16 v[92:93], v17 offset:21568
    buffer_load_dwordx4 v7, s[20:23], s74 offen offset:1024 lds
    ds_read_b64_tr_b16 v[94:95], v17 offset:22336
    s_waitcnt lgkmcnt(7)
    v_mfma_f32_32x32x16_bf16 v[52:67], v[84:87], v[68:71], v[52:67]
    v_lshl_add_u32 v137, v187, 3, v137
    s_sub_u32 s80, s80, 16632
    v_add_u32 v137, s80, v137
    s_and_b32 s81, s4, 1
    s_lshl_b32 s81, s81, 4
    s_lshr_b32 s90, s90, s81
    s_and_b32 s90, s90, 0xffff
    v_lshrrev_b32 v186, 3, v184
    v_add_u32 v186, v186, v185
    v_and_b32 v187, 1, v184
    v_lshlrev_b32 v187, 4, v187
    v_lshlrev_b32 v187, v187, s90
    ds_read_b64_tr_b16 v[96:97], v17 offset:21632
    ds_read_b64_tr_b16 v[98:99], v17 offset:22400
    s_waitcnt lgkmcnt(7)
    v_mfma_f32_32x32x16_bf16 a[224:239], a[196:199], v[104:107], a[224:239]
    buffer_load_dwordx4 v8, s[20:23], s74 offen offset:2048 lds
    s_add_u32 s74, s74, 196608
    v_bfe_u32 v188, v184, 1, 2
    v_mov_b32 v189, 99
    v_cmp_eq_u32 vcc, 1, v186
    s_nop 1
    v_cndmask_b32 v188, v189, v188, vcc
    v_cmp_eq_u32 vcc, 0, v188
    s_nop 1
    v_cndmask_b32 v132, 0, v187, vcc
    v_cmp_eq_u32 vcc, 1, v188
    s_nop 1
    v_cndmask_b32 v133, 0, v187, vcc
    v_cmp_eq_u32 vcc, 2, v188
    s_nop 1
    v_cndmask_b32 v134, 0, v187, vcc
    v_cmp_eq_u32 vcc, 3, v188
    s_nop 1
    v_cndmask_b32 v135, 0, v187, vcc
    ds_read_b64_tr_b16 v[108:109], v18 offset:12416
    ds_read_b64_tr_b16 v[110:111], v18 offset:13184
    s_waitcnt lgkmcnt(6)
    v_mfma_f32_32x32x16_bf16 v[20:35], v[88:91], v[72:75], v[20:35]
    s_waitcnt lgkmcnt(0)
    s_barrier
    ds_read_b128 v[68:71], v9 offset:32768
    ds_read_b64_tr_b16 v[76:77], v17 offset:24576
    ds_read_b64_tr_b16 v[78:79], v17 offset:25344
    v_mfma_f32_32x32x16_bf16 a[240:255], a[196:199], v[108:111], a[240:255]
    ds_read_b64_tr_b16 v[80:81], v17 offset:24640
    ds_read_b64_tr_b16 v[82:83], v17 offset:25408
    v_mfma_f32_32x32x16_bf16 v[36:51], v[92:95], v[72:75], v[36:51]
    ds_read_b64_tr_b16 v[84:85], v17 offset:24704
    ds_read_b64_tr_b16 v[86:87], v17 offset:25472
    v_mfma_f32_32x32x16_bf16 v[52:67], v[96:99], v[72:75], v[52:67]
    s_waitcnt lgkmcnt(4)
    v_mfma_f32_32x32x16_bf16 v[20:35], v[76:79], v[68:71], v[20:35]
    s_add_u32 m0, s75, 16384
    s_nop 0
    buffer_load_dwordx4 v2, s[8:11], s73 offen offset:0 lds
    ds_read_b128 v[72:75], v10 offset:32768
    ds_read_b64_tr_b16 v[88:89], v17 offset:27648
    ds_read_b64_tr_b16 v[90:91], v17 offset:28416
    s_waitcnt lgkmcnt(5)
    v_mfma_f32_32x32x16_bf16 v[36:51], v[80:83], v[68:71], v[36:51]
    ds_read_b64_tr_b16 v[92:93], v17 offset:27712
    ds_read_b64_tr_b16 v[94:95], v17 offset:28480
    ds_read_b64_tr_b16 v[100:101], v18 offset:24576
    buffer_load_dwordx4 v3, s[8:11], s73 offen offset:1024 lds
    s_waitcnt lgkmcnt(6)
    v_mfma_f32_32x32x16_bf16 v[52:67], v[84:87], v[68:71], v[52:67]
    ds_read_b64_tr_b16 v[96:97], v17 offset:27776
    ds_read_b64_tr_b16 v[98:99], v17 offset:28544
    ds_read_b64_tr_b16 v[102:103], v18 offset:25344
    s_waitcnt lgkmcnt(6)
    v_mfma_f32_32x32x16_bf16 v[20:35], v[88:91], v[72:75], v[20:35]
    ds_read_b128 v[68:71], v11 offset:32768
    ds_read_b64_tr_b16 v[76:77], v17 offset:30720
    ds_read_b64_tr_b16 v[78:79], v17 offset:31488
    buffer_load_dwordx4 v4, s[8:11], s73 offen offset:2048 lds
    s_waitcnt lgkmcnt(7)
    v_mfma_f32_32x32x16_bf16 v[36:51], v[92:95], v[72:75], v[36:51]
    ds_read_b64_tr_b16 v[80:81], v17 offset:30784
    ds_read_b64_tr_b16 v[82:83], v17 offset:31552
    s_waitcnt lgkmcnt(6)
    v_mfma_f32_32x32x16_bf16 v[52:67], v[96:99], v[72:75], v[52:67]
    buffer_load_dwordx4 v5, s[8:11], s73 offen offset:3072 lds
    ds_read_b64_tr_b16 v[84:85], v17 offset:30848
    ds_read_b64_tr_b16 v[86:87], v17 offset:31616
    s_waitcnt lgkmcnt(7)
    v_mfma_f32_32x32x16_bf16 a[208:223], a[196:199], v[100:103], a[208:223]
    ds_read_b64_tr_b16 v[104:105], v18 offset:24640
    ds_read_b64_tr_b16 v[106:107], v18 offset:25408
    s_add_u32 s73, s73, 128
    s_add_u32 m0, s76, 12288
    s_nop 0
    buffer_load_dwordx4 v6, s[20:23], s74 offen offset:0 lds
    s_waitcnt lgkmcnt(6)
    v_mfma_f32_32x32x16_bf16 v[20:35], v[76:79], v[68:71], v[20:35]
    ds_read_b128 v[72:75], v12 offset:32768
    ds_read_b64_tr_b16 v[88:89], v17 offset:33792
    ds_read_b64_tr_b16 v[90:91], v17 offset:34560
    s_waitcnt lgkmcnt(7)
    v_mfma_f32_32x32x16_bf16 v[36:51], v[80:83], v[68:71], v[36:51]
    ds_read_b64_tr_b16 v[92:93], v17 offset:33856
    ds_read_b64_tr_b16 v[94:95], v17 offset:34624
    buffer_load_dwordx4 v7, s[20:23], s74 offen offset:1024 lds
    s_waitcnt lgkmcnt(7)
    v_mfma_f32_32x32x16_bf16 v[52:67], v[84:87], v[68:71], v[52:67]
    ds_read_b64_tr_b16 v[96:97], v17 offset:33920
    ds_read_b64_tr_b16 v[98:99], v17 offset:34688
    s_waitcnt lgkmcnt(7)
    v_mfma_f32_32x32x16_bf16 a[224:239], a[196:199], v[104:107], a[224:239]
    buffer_load_dwordx4 v8, s[20:23], s74 offen offset:2048 lds
    s_add_u32 s74, s74, 196608
    ds_read_b64_tr_b16 v[108:109], v18 offset:24704
    ds_read_b64_tr_b16 v[110:111], v18 offset:25472
    s_waitcnt lgkmcnt(6)
    v_mfma_f32_32x32x16_bf16 v[20:35], v[88:91], v[72:75], v[20:35]
    s_waitcnt vmcnt(22)
    s_waitcnt lgkmcnt(0)
    s_barrier
    ds_read_b128 v[68:71], v9 offset:49152
    ds_read_b64_tr_b16 v[76:77], v17 offset:36864
    ds_read_b64_tr_b16 v[78:79], v17 offset:37632
    v_mfma_f32_32x32x16_bf16 a[240:255], a[196:199], v[108:111], a[240:255]
    ds_read_b64_tr_b16 v[80:81], v17 offset:36928
    ds_read_b64_tr_b16 v[82:83], v17 offset:37696
    v_mfma_f32_32x32x16_bf16 v[36:51], v[92:95], v[72:75], v[36:51]
    ds_read_b64_tr_b16 v[84:85], v17 offset:36992
    ds_read_b64_tr_b16 v[86:87], v17 offset:37760
    v_mfma_f32_32x32x16_bf16 v[52:67], v[96:99], v[72:75], v[52:67]
    s_waitcnt lgkmcnt(4)
    v_mfma_f32_32x32x16_bf16 v[20:35], v[76:79], v[68:71], v[20:35]
    v_mov_b32 v224, 0
    v_mov_b32 v203, 0
    s_waitcnt vmcnt(19)
    v_mov_b32 v225, v208
    v_mov_b32 v226, v209
    v_mov_b32_dpp v224, v211 wave_shr:1 row_mask:0xf bank_mask:0xf
    v_mov_b32_dpp v203, v210 wave_shr:1 row_mask:0xf bank_mask:0xf
    v_mov_b32 v227, v210
    v_alignbit_b32 v161, v209, v208, 16
    v_alignbit_b32 v162, v210, v209, 16
    v_alignbit_b32 v163, v211, v210, 16
    v_alignbit_b32 v160, v208, v224, 16
    v_alignbit_b32 v240, v224, v203, 16
    ds_read_b128 v[72:75], v10 offset:49152
    ds_read_b64_tr_b16 v[88:89], v17 offset:39936
    ds_read_b64_tr_b16 v[90:91], v17 offset:40704
    s_waitcnt lgkmcnt(5)
    v_mfma_f32_32x32x16_bf16 v[36:51], v[80:83], v[68:71], v[36:51]
    v_mov_b32 v242, v161
    v_mov_b32 v243, v162
    v_mov_b32 v241, v160
    v_mov_b32_dpp v228, v211 wave_ror:1 row_mask:0xf bank_mask:0xf
    v_mov_b32_dpp v203, v210 wave_ror:1 row_mask:0xf bank_mask:0xf
    s_waitcnt vmcnt(17)
    v_mov_b32 v229, v212
    v_mov_b32 v230, v213
    v_mov_b32_dpp v228, v215 wave_shr:1 row_mask:0xf bank_mask:0xf
    v_mov_b32_dpp v203, v214 wave_shr:1 row_mask:0xf bank_mask:0xf
    v_mov_b32 v231, v214
    v_alignbit_b32 v165, v213, v212, 16
    v_alignbit_b32 v166, v214, v213, 16
    ds_read_b64_tr_b16 v[92:93], v17 offset:40000
    ds_read_b64_tr_b16 v[94:95], v17 offset:40768
    ds_read_b64_tr_b16 v[100:101], v18 offset:36864
    s_waitcnt lgkmcnt(6)
    v_mfma_f32_32x32x16_bf16 v[52:67], v[84:87], v[68:71], v[52:67]
    v_alignbit_b32 v167, v215, v214, 16
    v_alignbit_b32 v164, v212, v228, 16
    v_alignbit_b32 v244, v228, v203, 16
    v_mov_b32 v246, v165
    v_mov_b32 v247, v166
    v_mov_b32 v245, v164
    v_mov_b32_dpp v232, v215 wave_ror:1 row_mask:0xf bank_mask:0xf
    v_mov_b32_dpp v203, v214 wave_ror:1 row_mask:0xf bank_mask:0xf
    s_waitcnt vmcnt(16)
    v_mov_b32 v233, v216
    v_mov_b32 v234, v217
    v_mov_b32_dpp v232, v219 wave_shr:1 row_mask:0xf bank_mask:0xf
    v_mov_b32_dpp v203, v218 wave_shr:1 row_mask:0xf bank_mask:0xf
    ds_read_b64_tr_b16 v[96:97], v17 offset:40064
    ds_read_b64_tr_b16 v[98:99], v17 offset:40832
    ds_read_b64_tr_b16 v[102:103], v18 offset:37632
    s_waitcnt lgkmcnt(6)
    v_mfma_f32_32x32x16_bf16 v[20:35], v[88:91], v[72:75], v[20:35]
    v_mov_b32 v235, v218
    v_alignbit_b32 v169, v217, v216, 16
    v_alignbit_b32 v170, v218, v217, 16
    v_alignbit_b32 v171, v219, v218, 16
    v_alignbit_b32 v168, v216, v232, 16
    v_alignbit_b32 v248, v232, v203, 16
    v_mov_b32 v250, v169
    v_mov_b32 v251, v170
    v_mov_b32 v249, v168
    v_mov_b32_dpp v236, v219 wave_ror:1 row_mask:0xf bank_mask:0xf
    v_mov_b32_dpp v203, v218 wave_ror:1 row_mask:0xf bank_mask:0xf
    s_waitcnt vmcnt(14)
    v_mov_b32 v237, v220
    ds_read_b128 v[68:71], v11 offset:49152
    ds_read_b64_tr_b16 v[76:77], v17 offset:43008
    ds_read_b64_tr_b16 v[78:79], v17 offset:43776
    s_waitcnt lgkmcnt(7)
    v_mfma_f32_32x32x16_bf16 v[36:51], v[92:95], v[72:75], v[36:51]
    v_mov_b32 v238, v221
    v_mov_b32_dpp v236, v223 wave_shr:1 row_mask:0xf bank_mask:0xf
    v_mov_b32_dpp v203, v222 wave_shr:1 row_mask:0xf bank_mask:0xf
    v_mov_b32 v239, v222
    v_alignbit_b32 v173, v221, v220, 16
    v_alignbit_b32 v174, v222, v221, 16
    v_alignbit_b32 v175, v223, v222, 16
    v_alignbit_b32 v172, v220, v236, 16
    v_alignbit_b32 v252, v236, v203, 16
    v_mov_b32 v254, v173
    v_mov_b32 v255, v174
    v_mov_b32 v253, v172
    ds_read_b64_tr_b16 v[80:81], v17 offset:43072
    ds_read_b64_tr_b16 v[82:83], v17 offset:43840
    s_waitcnt lgkmcnt(6)
    v_mfma_f32_32x32x16_bf16 v[52:67], v[96:99], v[72:75], v[52:67]
    s_mul_i32 s80, s71, 12
    s_mul_i32 s81, s4, 3
    s_add_u32 s80, s80, s81
    s_add_u32 s80, s80, 160
    v_min_u32 v126, 2, v1
    v_add_u32 v126, s80, v126
    s_lshl_b32 s80, s68, 7
    s_lshl_b32 s81, s4, 5
    s_add_u32 s80, s80, s81
    s_and_b32 s81, s80, 0xf8
    s_lshr_b32 s80, s80, 8
    s_add_u32 s80, s80, s81
    ds_read_b64_tr_b16 v[84:85], v17 offset:43136
    ds_read_b64_tr_b16 v[86:87], v17 offset:43904
    s_waitcnt lgkmcnt(7)
    v_mfma_f32_32x32x16_bf16 a[208:223], a[196:199], v[100:103], a[208:223]
    v_and_b32 v127, 3, v1
    v_lshlrev_b32 v127, 3, v127
    v_add_u32 v127, s80, v127
    v_lshrrev_b32 v125, 2, v1
    v_cmp_eq_u32 vcc, 1, v125
    s_nop 1
    v_cndmask_b32 v126, v126, v127, vcc
    s_mul_i32 s80, s2, 3277
    s_lshr_b32 s80, s80, 16
    s_lshl_b32 s80, s80, 3
    v_and_b32 v127, 3, v1
    v_lshlrev_b32 v127, 6, v127
    v_bfe_u32 v125, v1, 2, 3
    ds_read_b64_tr_b16 v[104:105], v18 offset:36928
    ds_read_b64_tr_b16 v[106:107], v18 offset:37696
    s_waitcnt lgkmcnt(6)
    v_mfma_f32_32x32x16_bf16 v[20:35], v[76:79], v[68:71], v[20:35]
    v_add_u32 v127, v127, v125
    v_add_u32 v127, s80, v127
    v_cmp_lt_u32 vcc, 31, v1
    s_nop 1
    v_cndmask_b32 v126, v126, v127, vcc
    v_lshlrev_b32 v126, 6, v126
    v_add_u32 v126, 4096, v126
    buffer_load_dword v127, v126, s[36:39], 0 offen sc1
    v_lshlrev_b32 v8, 4, v1
    v_add_u32 v2, 0, v8
    ds_read_b128 v[72:75], v12 offset:49152
    ds_read_b64_tr_b16 v[88:89], v17 offset:46080
    ds_read_b64_tr_b16 v[90:91], v17 offset:46848
    s_waitcnt lgkmcnt(7)
    v_mfma_f32_32x32x16_bf16 v[36:51], v[80:83], v[68:71], v[36:51]
    v_add_u32 v3, 4096, v8
    v_add_u32 v4, 8192, v8
    s_mul_i32 s80, s4, 12288
    s_add_u32 s80, s80, 8388608
    s_lshl_b32 s81, s70, 2
    s_add_u32 s82, s4, 1
    s_and_b32 s82, s82, 3
    s_add_u32 s83, s81, s82
    s_mul_i32 s83, s83, 49152
    s_add_u32 s92, s83, s80
    s_mul_i32 s82, s82, 15360
    s_add_u32 s82, s82, 0
    ds_read_b64_tr_b16 v[92:93], v17 offset:46144
    ds_read_b64_tr_b16 v[94:95], v17 offset:46912
    s_waitcnt lgkmcnt(7)
    v_mfma_f32_32x32x16_bf16 v[52:67], v[84:87], v[68:71], v[52:67]
    v_add_u32 v5, s82, v8
    s_add_u32 s82, s4, 2
    s_and_b32 s82, s82, 3
    s_add_u32 s83, s81, s82
    s_mul_i32 s83, s83, 49152
    s_add_u32 s93, s83, s80
    s_mul_i32 s82, s82, 15360
    s_add_u32 s82, s82, 5120
    v_add_u32 v6, s82, v8
    s_add_u32 s82, s4, 3
    s_and_b32 s82, s82, 3
    s_add_u32 s83, s81, s82
    ds_read_b64_tr_b16 v[96:97], v17 offset:46208
    ds_read_b64_tr_b16 v[98:99], v17 offset:46976
    s_waitcnt lgkmcnt(7)
    v_mfma_f32_32x32x16_bf16 a[224:239], a[196:199], v[104:107], a[224:239]
    s_mul_i32 s83, s83, 49152
    s_add_u32 s94, s83, s80
    s_mul_i32 s82, s82, 15360
    s_add_u32 s82, s82, 10240
    v_add_u32 v7, s82, v8
    s_add_u32 s82, s4, 4
    s_and_b32 s82, s82, 3
    s_add_u32 s83, s81, s82
    s_mul_i32 s83, s83, 49152
    s_add_u32 s95, s83, s80
    s_mul_i32 s82, s4, 15360
    v_add_u32 v8, s82, v8
    ds_read_b64_tr_b16 v[108:109], v18 offset:36992
    ds_read_b64_tr_b16 v[110:111], v18 offset:37760
    s_waitcnt lgkmcnt(6)
    v_mfma_f32_32x32x16_bf16 v[20:35], v[88:91], v[72:75], v[20:35]
    s_waitcnt vmcnt(8)
    s_waitcnt lgkmcnt(0)
    s_barrier
    ds_read_b128 v[68:71], v9 offset:0
    ds_read_b64_tr_b16 v[76:77], v17 offset:0
    ds_read_b64_tr_b16 v[78:79], v17 offset:768
    v_mfma_f32_32x32x16_bf16 a[240:255], a[196:199], v[108:111], a[240:255]
    ds_read_b64_tr_b16 v[80:81], v17 offset:64
    ds_read_b64_tr_b16 v[82:83], v17 offset:832
    v_mfma_f32_32x32x16_bf16 v[36:51], v[92:95], v[72:75], v[36:51]
    ds_read_b64_tr_b16 v[84:85], v17 offset:128
    ds_read_b64_tr_b16 v[86:87], v17 offset:896
    v_mfma_f32_32x32x16_bf16 v[52:67], v[96:99], v[72:75], v[52:67]
    s_waitcnt lgkmcnt(4)
    v_mfma_f32_32x32x16_bf16 v[20:35], v[76:79], v[68:71], v[20:35]
    s_waitcnt vmcnt(0)
    v_cmp_ne_u32 vcc, s5, v127
    s_nop 0
    s_cbranch_vccnz LA_slowp1
LA_backp2:
    s_mul_i32 s78, s71, 245760
    s_mul_i32 s80, s4, 61440
    s_add_u32 s78, s78, s80
    s_add_u32 s78, s78, 16777216
    v_lshlrev_b32 v139, 4, v1
    ds_read_b128 v[72:75], v10 offset:0
    ds_read_b64_tr_b16 v[88:89], v17 offset:3072
    ds_read_b64_tr_b16 v[90:91], v17 offset:3840
    s_waitcnt lgkmcnt(5)
    v_mfma_f32_32x32x16_bf16 v[36:51], v[80:83], v[68:71], v[36:51]
    s_lshl_b32 s80, s68, 7
    s_lshl_b32 s81, s4, 5
    s_add_u32 s80, s80, s81
    v_and_b32 v126, 31, v1
    v_add_u32 v126, s80, v126
    v_lshlrev_b32 v126, 3, v126
    ds_read_b64_tr_b16 v[92:93], v17 offset:3136
    ds_read_b64_tr_b16 v[94:95], v17 offset:3904
    ds_read_b64_tr_b16 v[100:101], v18 offset:0
    s_waitcnt lgkmcnt(6)
    v_mfma_f32_32x32x16_bf16 v[52:67], v[84:87], v[68:71], v[52:67]
    v_add_u32 v126, 65536, v126
    buffer_load_dwordx2 v[116:117], v126, s[36:39], 0 offen sc1
    s_lshl_b32 s80, s2, 2
    s_add_u32 s80, s80, s4
    ds_read_b64_tr_b16 v[96:97], v17 offset:3200
    ds_read_b64_tr_b16 v[98:99], v17 offset:3968
    ds_read_b64_tr_b16 v[102:103], v18 offset:768
    s_waitcnt lgkmcnt(6)
    v_mfma_f32_32x32x16_bf16 v[20:35], v[88:91], v[72:75], v[20:35]
    s_lshl_b32 s80, s80, 12
    s_add_u32 s80, s80, 1048576
    v_lshlrev_b32 v138, 4, v1
    buffer_load_dwordx4 v[140:143], v138, s[36:39], s80 offen offset:0 sc1
    ds_read_b128 v[68:71], v11 offset:0
    ds_read_b64_tr_b16 v[76:77], v17 offset:6144
    ds_read_b64_tr_b16 v[78:79], v17 offset:6912
    s_waitcnt lgkmcnt(7)
    v_mfma_f32_32x32x16_bf16 v[36:51], v[92:95], v[72:75], v[36:51]
    ds_read_b64_tr_b16 v[80:81], v17 offset:6208
    ds_read_b64_tr_b16 v[82:83], v17 offset:6976
    s_waitcnt lgkmcnt(6)
    v_mfma_f32_32x32x16_bf16 v[52:67], v[96:99], v[72:75], v[52:67]
    buffer_load_dwordx4 v[144:147], v138, s[36:39], s80 offen offset:1024 sc1
    ds_read_b64_tr_b16 v[84:85], v17 offset:6272
    ds_read_b64_tr_b16 v[86:87], v17 offset:7040
    s_waitcnt lgkmcnt(7)
    v_mfma_f32_32x32x16_bf16 a[208:223], a[196:199], v[100:103], a[208:223]
    ds_read_b64_tr_b16 v[104:105], v18 offset:64
    ds_read_b64_tr_b16 v[106:107], v18 offset:832
    s_waitcnt lgkmcnt(6)
    v_mfma_f32_32x32x16_bf16 v[20:35], v[76:79], v[68:71], v[20:35]
    buffer_load_dwordx4 v[148:151], v138, s[36:39], s80 offen offset:2048 sc1
    ds_read_b128 v[72:75], v12 offset:0
    ds_read_b64_tr_b16 v[88:89], v17 offset:9216
    ds_read_b64_tr_b16 v[90:91], v17 offset:9984
    s_waitcnt lgkmcnt(7)
    v_mfma_f32_32x32x16_bf16 v[36:51], v[80:83], v[68:71], v[36:51]
    ds_read_b64_tr_b16 v[92:93], v17 offset:9280
    ds_read_b64_tr_b16 v[94:95], v17 offset:10048
    s_waitcnt lgkmcnt(7)
    v_mfma_f32_32x32x16_bf16 v[52:67], v[84:87], v[68:71], v[52:67]
    buffer_load_dwordx4 v[152:155], v138, s[36:39], s80 offen offset:3072 sc1
    ds_read_b64_tr_b16 v[96:97], v17 offset:9344
    ds_read_b64_tr_b16 v[98:99], v17 offset:10112
    s_waitcnt lgkmcnt(7)
    v_mfma_f32_32x32x16_bf16 a[224:239], a[196:199], v[104:107], a[224:239]
    ds_read_b64_tr_b16 v[108:109], v18 offset:128
    ds_read_b64_tr_b16 v[110:111], v18 offset:896
    s_waitcnt lgkmcnt(6)
    v_mfma_f32_32x32x16_bf16 v[20:35], v[88:91], v[72:75], v[20:35]
    s_waitcnt lgkmcnt(0)
    s_barrier
    ds_read_b128 v[68:71], v9 offset:16384
    ds_read_b64_tr_b16 v[76:77], v17 offset:12288
    ds_read_b64_tr_b16 v[78:79], v17 offset:13056
    v_mfma_f32_32x32x16_bf16 a[240:255], a[196:199], v[108:111], a[240:255]
    ds_read_b64_tr_b16 v[80:81], v17 offset:12352
    ds_read_b64_tr_b16 v[82:83], v17 offset:13120
    v_mfma_f32_32x32x16_bf16 v[36:51], v[92:95], v[72:75], v[36:51]
    ds_read_b64_tr_b16 v[84:85], v17 offset:12416
    ds_read_b64_tr_b16 v[86:87], v17 offset:13184
    v_mfma_f32_32x32x16_bf16 v[52:67], v[96:99], v[72:75], v[52:67]
    s_waitcnt lgkmcnt(4)
    v_mfma_f32_32x32x16_bf16 v[20:35], v[76:79], v[68:71], v[20:35]
    ds_write_b128 v177, v[180:183]
    buffer_load_dwordx4 a[0:3], v139, s[36:39], s78 offen offset:0 sc1
    ds_write_b128 v179, v[180:183]
    ds_read_b128 v[72:75], v10 offset:16384
    ds_read_b64_tr_b16 v[88:89], v17 offset:15360
    ds_read_b64_tr_b16 v[90:91], v17 offset:16128
    s_waitcnt lgkmcnt(7)
    v_mfma_f32_32x32x16_bf16 v[36:51], v[80:83], v[68:71], v[36:51]
    ds_write_b128 v176, v[208:211] offset:32
    ds_write_b128 v176, v[160:163] offset:4192
    ds_read_b64_tr_b16 v[92:93], v17 offset:15424
    ds_read_b64_tr_b16 v[94:95], v17 offset:16192
    ds_read_b64_tr_b16 v[100:101], v18 offset:12288
    s_waitcnt lgkmcnt(10)
    v_mfma_f32_32x32x16_bf16 v[52:67], v[84:87], v[68:71], v[52:67]
    ds_write_b128 v176, v[224:227] offset:8352
    ds_read_b64_tr_b16 v[96:97], v17 offset:15488
    ds_read_b64_tr_b16 v[98:99], v17 offset:16256
    ds_read_b64_tr_b16 v[102:103], v18 offset:13056
    s_waitcnt lgkmcnt(9)
    v_mfma_f32_32x32x16_bf16 v[20:35], v[88:91], v[72:75], v[20:35]
    buffer_load_dwordx4 a[4:7], v139, s[36:39], s78 offen offset:1024 sc1
    ds_write_b128 v176, v[240:243] offset:12512
    ds_write_b128 v176, v[212:215] offset:1056
    ds_read_b128 v[68:71], v11 offset:16384
    ds_read_b64_tr_b16 v[76:77], v17 offset:18432
    ds_read_b64_tr_b16 v[78:79], v17 offset:19200
    s_waitcnt lgkmcnt(10)
    v_mfma_f32_32x32x16_bf16 v[36:51], v[92:95], v[72:75], v[36:51]
    ds_write_b128 v176, v[164:167] offset:5216
    ds_write_b128 v176, v[228:231] offset:9376
    ds_read_b64_tr_b16 v[80:81], v17 offset:18496
    ds_read_b64_tr_b16 v[82:83], v17 offset:19264
    s_waitcnt lgkmcnt(10)
    v_mfma_f32_32x32x16_bf16 v[52:67], v[96:99], v[72:75], v[52:67]
    ds_write_b128 v176, v[244:247] offset:13536
    ds_read_b64_tr_b16 v[84:85], v17 offset:18560
    ds_read_b64_tr_b16 v[86:87], v17 offset:19328
    s_waitcnt lgkmcnt(12)
    v_mfma_f32_32x32x16_bf16 a[208:223], a[196:199], v[100:103], a[208:223]
    buffer_load_dwordx4 a[8:11], v139, s[36:39], s78 offen offset:2048 sc1
    ds_write_b128 v176, v[216:219] offset:2080
    ds_write_b128 v176, v[168:171] offset:6240
    ds_read_b64_tr_b16 v[104:105], v18 offset:12352
    ds_read_b64_tr_b16 v[106:107], v18 offset:13120
    s_waitcnt lgkmcnt(11)
    v_mfma_f32_32x32x16_bf16 v[20:35], v[76:79], v[68:71], v[20:35]
    ds_write_b128 v176, v[232:235] offset:10400
    ds_write_b128 v176, v[248:251] offset:14560
    ds_read_b128 v[72:75], v12 offset:16384
    ds_read_b64_tr_b16 v[88:89], v17 offset:21504
    ds_read_b64_tr_b16 v[90:91], v17 offset:22272
    s_waitcnt lgkmcnt(12)
    v_mfma_f32_32x32x16_bf16 v[36:51], v[80:83], v[68:71], v[36:51]
    ds_write_b128 v176, v[220:223] offset:3104
    ds_read_b64_tr_b16 v[92:93], v17 offset:21568
    ds_read_b64_tr_b16 v[94:95], v17 offset:22336
    buffer_load_dwordx4 a[12:15], v139, s[36:39], s78 offen offset:3072 sc1
    s_waitcnt lgkmcnt(12)
    v_mfma_f32_32x32x16_bf16 v[52:67], v[84:87], v[68:71], v[52:67]
    ds_write_b128 v176, v[172:175] offset:7264
    ds_write_b128 v176, v[236:239] offset:11424
    ds_read_b64_tr_b16 v[96:97], v17 offset:21632
    ds_read_b64_tr_b16 v[98:99], v17 offset:22400
    s_waitcnt lgkmcnt(12)
    v_mfma_f32_32x32x16_bf16 a[224:239], a[196:199], v[104:107], a[224:239]
    ds_write_b128 v176, v[252:255] offset:15584
    ds_read_b64_tr_b16 v[108:109], v18 offset:12416
    ds_read_b64_tr_b16 v[110:111], v18 offset:13184
    s_waitcnt lgkmcnt(10)
    v_mfma_f32_32x32x16_bf16 v[20:35], v[88:91], v[72:75], v[20:35]
    s_add_u32 s78, s78, 4096
    buffer_load_dwordx4 a[16:19], v139, s[36:39], s78 offen offset:0 sc1
    s_waitcnt lgkmcnt(0)
    v_mfma_f32_32x32x16_bf16 a[240:255], a[196:199], v[108:111], a[240:255]
    v_mfma_f32_32x32x16_bf16 v[36:51], v[92:95], v[72:75], v[36:51]
    v_mfma_f32_32x32x16_bf16 v[52:67], v[96:99], v[72:75], v[52:67]
    v_and_b32 v94, 31, v1
    v_lshlrev_b32 v94, 2, v94
    v_add_u32 v94, 160768, v94
    s_mul_i32 s80, s4, 384
    v_add_u32 v95, s80, v94
    v_accvgpr_read_b32 v112, a208
    v_accvgpr_read_b32 v113, a224
    s_nop 2
    v_accvgpr_read_b32 v114, a240
    ds_write_b32 v95, v112 offset:0
    ds_write_b32 v95, v113 offset:128
    ds_write_b32 v95, v114 offset:256
    s_waitcnt lgkmcnt(0)
    s_barrier
    ds_read_b32 v100, v94 offset:0
    ds_read_b32 v101, v94 offset:128
    ds_read_b32 v102, v94 offset:256
    ds_read_b32 v103, v94 offset:384
    ds_read_b32 v104, v94 offset:512
    ds_read_b32 v105, v94 offset:640
    ds_read_b32 v106, v94 offset:768
    ds_read_b32 v107, v94 offset:896
    ds_read_b32 v108, v94 offset:1024
    ds_read_b32 v109, v94 offset:1152
    ds_read_b32 v110, v94 offset:1280
    ds_read_b32 v111, v94 offset:1408
    v_cmp_gt_u32 vcc, 32, v1
    s_waitcnt vmcnt(9)
    v_rcp_f32 v92, v117
    v_xor_b32 v88, 0x80000000, v116
    v_lshrrev_b32 v89, 16, v88
    v_or_b32 v88, v88, v89
    v_lshrrev_b32 v89, 16, v117
    v_mov_b32 v90, 0
    v_mov_b32 v91, 0
    s_waitcnt lgkmcnt(8)
    v_add_f32 v112, v100, v103
    s_waitcnt lgkmcnt(2)
    v_add_f32 v76, v106, v109
    v_add_f32 v112, v112, v76
    v_cvt_pk_bf16_f32 v76, v112, v112
    v_lshlrev_b32 v77, 16, v76
    v_sub_f32 v77, v112, v77
    v_cvt_pk_bf16_f32 v76, v112, v77
    v_cndmask_b32 v76, 0, v76, vcc
    v_cndmask_b32 v77, 0, v118, vcc
    v_mov_b32 v78, 0
    v_mov_b32 v79, 0
    s_nop 1
    v_mfma_f32_32x32x16_bf16 v[20:35], v[76:79], v[88:91], v[20:35]
    v_add_f32 v113, v101, v104
    s_waitcnt lgkmcnt(1)
    v_add_f32 v80, v107, v110
    v_add_f32 v113, v113, v80
    v_cvt_pk_bf16_f32 v80, v113, v113
    v_lshlrev_b32 v81, 16, v80
    v_sub_f32 v81, v113, v81
    v_cvt_pk_bf16_f32 v80, v113, v81
    v_cndmask_b32 v80, 0, v80, vcc
    v_cndmask_b32 v81, 0, v119, vcc
    v_mov_b32 v82, 0
    v_mov_b32 v83, 0
    s_nop 1
    v_mfma_f32_32x32x16_bf16 v[36:51], v[80:83], v[88:91], v[36:51]
    v_add_f32 v114, v102, v105
    s_waitcnt lgkmcnt(0)
    v_add_f32 v84, v108, v111
    v_add_f32 v114, v114, v84
    v_cvt_pk_bf16_f32 v84, v114, v114
    v_lshlrev_b32 v85, 16, v84
    v_sub_f32 v85, v114, v85
    v_cvt_pk_bf16_f32 v84, v114, v85
    v_cndmask_b32 v84, 0, v84, vcc
    v_cndmask_b32 v85, 0, v120, vcc
    v_mov_b32 v86, 0
    v_mov_b32 v87, 0
    s_nop 1
    v_mfma_f32_32x32x16_bf16 v[52:67], v[84:87], v[88:91], v[52:67]
    s_lshl_b32 s80, s68, 3
    s_lshl_b32 s81, s4, 1
    s_add_u32 s80, s80, s81
    s_mul_i32 s80, s80, 49152
    s_mul_i32 s81, s69, 3072
    s_add_u32 s80, s80, s81
    s_add_u32 s84, s80, 8388608
    v_bfe_u32 v94, v1, 4, 1
    v_mul_u32_u24 v94, 49152, v94
    v_lshrrev_b32 v95, 5, v1
    v_lshl_add_u32 v94, v95, 8, v94
    v_and_b32 v95, 15, v1
    v_lshl_add_u32 v94, v95, 4, v94
    buffer_load_dwordx4 a[20:23], v139, s[36:39], s78 offen offset:1024 sc1
    v_max_f32 v20, 0, v20
    s_waitcnt vmcnt(9)
    ds_write_b128 v176, v[140:143] offset:17120
    v_max_f32 v21, 0, v21
    v_pk_mul_f32 v[20:21], v[20:21], v[92:93] op_sel_hi:[1,0]
    v_pk_mul_f32 v[20:21], v[20:21], v[20:21]
    v_max_f32 v22, 0, v22
    v_max_f32 v23, 0, v23
    v_pk_mul_f32 v[22:23], v[22:23], v[92:93] op_sel_hi:[1,0]
    v_pk_mul_f32 v[22:23], v[22:23], v[22:23]
    v_max_f32 v24, 0, v24
    v_max_f32 v25, 0, v25
    v_pk_mul_f32 v[24:25], v[24:25], v[92:93] op_sel_hi:[1,0]
    buffer_load_dwordx4 a[24:27], v139, s[36:39], s78 offen offset:2048 sc1
    v_pk_mul_f32 v[24:25], v[24:25], v[24:25]
    v_max_f32 v26, 0, v26
    v_max_f32 v27, 0, v27
    v_pk_mul_f32 v[26:27], v[26:27], v[92:93] op_sel_hi:[1,0]
    v_pk_mul_f32 v[26:27], v[26:27], v[26:27]
    v_cvt_pk_bf16_f32 v20, v20, v21
    v_cvt_pk_bf16_f32 v21, v22, v23
    v_cvt_pk_bf16_f32 v22, v24, v25
    v_cvt_pk_bf16_f32 v23, v26, v27
    buffer_store_dwordx4 v[20:23], v94, s[36:39], s84 offen offset:0 sc1
    v_max_f32 v28, 0, v28
    v_max_f32 v29, 0, v29
    buffer_load_dwordx4 a[28:31], v139, s[36:39], s78 offen offset:3072 sc1
    v_pk_mul_f32 v[28:29], v[28:29], v[92:93] op_sel_hi:[1,0]
    v_pk_mul_f32 v[28:29], v[28:29], v[28:29]
    v_max_f32 v30, 0, v30
    v_max_f32 v31, 0, v31
    v_pk_mul_f32 v[30:31], v[30:31], v[92:93] op_sel_hi:[1,0]
    v_pk_mul_f32 v[30:31], v[30:31], v[30:31]
    v_max_f32 v32, 0, v32
    v_max_f32 v33, 0, v33
    v_pk_mul_f32 v[32:33], v[32:33], v[92:93] op_sel_hi:[1,0]
    s_waitcnt vmcnt(11)
    ds_write_b128 v176, v[144:147] offset:18144
    v_pk_mul_f32 v[32:33], v[32:33], v[32:33]
    v_max_f32 v34, 0, v34
    s_add_u32 s78, s78, 4096
    buffer_load_dwordx4 a[32:35], v139, s[36:39], s78 offen offset:0 sc1
    v_max_f32 v35, 0, v35
    v_pk_mul_f32 v[34:35], v[34:35], v[92:93] op_sel_hi:[1,0]
    v_pk_mul_f32 v[34:35], v[34:35], v[34:35]
    v_cvt_pk_bf16_f32 v28, v28, v29
    v_cvt_pk_bf16_f32 v29, v30, v31
    v_cvt_pk_bf16_f32 v30, v32, v33
    v_cvt_pk_bf16_f32 v31, v34, v35
    buffer_store_dwordx4 v[28:31], v94, s[36:39], s84 offen offset:512 sc1
    v_max_f32 v36, 0, v36
    v_max_f32 v37, 0, v37
    v_pk_mul_f32 v[36:37], v[36:37], v[92:93] op_sel_hi:[1,0]
    v_pk_mul_f32 v[36:37], v[36:37], v[36:37]
    buffer_load_dwordx4 a[36:39], v139, s[36:39], s78 offen offset:1024 sc1
    v_max_f32 v38, 0, v38
    v_max_f32 v39, 0, v39
    v_pk_mul_f32 v[38:39], v[38:39], v[92:93] op_sel_hi:[1,0]
    v_pk_mul_f32 v[38:39], v[38:39], v[38:39]
    v_max_f32 v40, 0, v40
    v_max_f32 v41, 0, v41
    v_pk_mul_f32 v[40:41], v[40:41], v[92:93] op_sel_hi:[1,0]
    v_pk_mul_f32 v[40:41], v[40:41], v[40:41]
    v_max_f32 v42, 0, v42
    v_max_f32 v43, 0, v43
    v_pk_mul_f32 v[42:43], v[42:43], v[92:93] op_sel_hi:[1,0]
    v_pk_mul_f32 v[42:43], v[42:43], v[42:43]
    buffer_load_dwordx4 a[40:43], v139, s[36:39], s78 offen offset:2048 sc1
    v_cvt_pk_bf16_f32 v36, v36, v37
    v_cvt_pk_bf16_f32 v37, v38, v39
    v_cvt_pk_bf16_f32 v38, v40, v41
    v_cvt_pk_bf16_f32 v39, v42, v43
    buffer_store_dwordx4 v[36:39], v94, s[36:39], s84 offen offset:1024 sc1
    v_max_f32 v44, 0, v44
    s_waitcnt vmcnt(15)
    ds_write_b128 v176, v[148:151] offset:19168
    v_max_f32 v45, 0, v45
    v_pk_mul_f32 v[44:45], v[44:45], v[92:93] op_sel_hi:[1,0]
    v_pk_mul_f32 v[44:45], v[44:45], v[44:45]
    v_max_f32 v46, 0, v46
    buffer_load_dwordx4 a[44:47], v139, s[36:39], s78 offen offset:3072 sc1
    v_max_f32 v47, 0, v47
    v_pk_mul_f32 v[46:47], v[46:47], v[92:93] op_sel_hi:[1,0]
    v_pk_mul_f32 v[46:47], v[46:47], v[46:47]
    v_max_f32 v48, 0, v48
    v_max_f32 v49, 0, v49
    v_pk_mul_f32 v[48:49], v[48:49], v[92:93] op_sel_hi:[1,0]
    v_pk_mul_f32 v[48:49], v[48:49], v[48:49]
    v_max_f32 v50, 0, v50
    v_max_f32 v51, 0, v51
    v_pk_mul_f32 v[50:51], v[50:51], v[92:93] op_sel_hi:[1,0]
    v_pk_mul_f32 v[50:51], v[50:51], v[50:51]
    v_cvt_pk_bf16_f32 v44, v44, v45
    s_add_u32 s78, s78, 4096
    buffer_load_dwordx4 a[48:51], v139, s[36:39], s78 offen offset:0 sc1
    v_cvt_pk_bf16_f32 v45, v46, v47
    v_cvt_pk_bf16_f32 v46, v48, v49
    v_cvt_pk_bf16_f32 v47, v50, v51
    buffer_store_dwordx4 v[44:47], v94, s[36:39], s84 offen offset:1536 sc1
    v_max_f32 v52, 0, v52
    v_max_f32 v53, 0, v53
    v_pk_mul_f32 v[52:53], v[52:53], v[92:93] op_sel_hi:[1,0]
    v_pk_mul_f32 v[52:53], v[52:53], v[52:53]
    v_max_f32 v54, 0, v54
    v_max_f32 v55, 0, v55
    v_pk_mul_f32 v[54:55], v[54:55], v[92:93] op_sel_hi:[1,0]
    v_pk_mul_f32 v[54:55], v[54:55], v[54:55]
    buffer_load_dwordx4 a[52:55], v139, s[36:39], s78 offen offset:1024 sc1
    v_max_f32 v56, 0, v56
    v_max_f32 v57, 0, v57
    v_pk_mul_f32 v[56:57], v[56:57], v[92:93] op_sel_hi:[1,0]
    s_waitcnt vmcnt(18)
    ds_write_b128 v176, v[152:155] offset:20192
    v_pk_mul_f32 v[56:57], v[56:57], v[56:57]
    v_max_f32 v58, 0, v58
    v_max_f32 v59, 0, v59
    v_pk_mul_f32 v[58:59], v[58:59], v[92:93] op_sel_hi:[1,0]
    v_pk_mul_f32 v[58:59], v[58:59], v[58:59]
    v_cvt_pk_bf16_f32 v52, v52, v53
    v_cvt_pk_bf16_f32 v53, v54, v55
    v_cvt_pk_bf16_f32 v54, v56, v57
    buffer_load_dwordx4 a[56:59], v139, s[36:39], s78 offen offset:2048 sc1
    v_cvt_pk_bf16_f32 v55, v58, v59
    buffer_store_dwordx4 v[52:55], v94, s[36:39], s84 offen offset:2048 sc1
    v_max_f32 v60, 0, v60
    v_max_f32 v61, 0, v61
    v_pk_mul_f32 v[60:61], v[60:61], v[92:93] op_sel_hi:[1,0]
    v_pk_mul_f32 v[60:61], v[60:61], v[60:61]
    v_max_f32 v62, 0, v62
    v_max_f32 v63, 0, v63
    v_pk_mul_f32 v[62:63], v[62:63], v[92:93] op_sel_hi:[1,0]
    v_pk_mul_f32 v[62:63], v[62:63], v[62:63]
    v_max_f32 v64, 0, v64
    v_max_f32 v65, 0, v65
    buffer_load_dwordx4 a[60:63], v139, s[36:39], s78 offen offset:3072 sc1
    s_add_u32 s78, s78, 4096
    v_pk_mul_f32 v[64:65], v[64:65], v[92:93] op_sel_hi:[1,0]
    v_pk_mul_f32 v[64:65], v[64:65], v[64:65]
    v_max_f32 v66, 0, v66
    v_max_f32 v67, 0, v67
    v_pk_mul_f32 v[66:67], v[66:67], v[92:93] op_sel_hi:[1,0]
    v_pk_mul_f32 v[66:67], v[66:67], v[66:67]
    v_cvt_pk_bf16_f32 v60, v60, v61
    v_cvt_pk_bf16_f32 v61, v62, v63
    v_cvt_pk_bf16_f32 v62, v64, v65
    v_cvt_pk_bf16_f32 v63, v66, v67
    buffer_store_dwordx4 v[60:63], v94, s[36:39], s84 offen offset:2560 sc1
    ds_read_b128 v[52:55], v136 offset:448
    ds_read_b128 v[56:59], v136 offset:960
    ds_read_b128 v[60:63], v136 offset:1472
    ds_read_b128 v[64:67], v136 offset:1984
    ds_read_b128 v[68:71], v136 offset:2496
    ds_read_b128 v[72:75], v136 offset:3008
    ds_read_b128 v[76:79], v136 offset:3520
    ds_read_b128 v[80:83], v136 offset:4032
    ds_read_b64_tr_b16 v[116:117], v137 offset:8
    ds_read_b64_tr_b16 v[118:119], v137 offset:0
    ds_read_b64_tr_b16 v[120:121], v137 offset:3592
    ds_read_b64_tr_b16 v[122:123], v137 offset:3584
    ds_read_b64_tr_b16 v[124:125], v137 offset:520
    ds_read_b64_tr_b16 v[126:127], v137 offset:512
    s_waitcnt lgkmcnt(13)
    v_mfma_f32_16x16x32_bf16 v[20:23], v[132:135], v[52:55], 0
    s_waitcnt lgkmcnt(12)
    v_mfma_f32_16x16x32_bf16 v[24:27], v[132:135], v[56:59], 0
    s_waitcnt lgkmcnt(11)
    v_mfma_f32_16x16x32_bf16 v[28:31], v[132:135], v[60:63], 0
    s_waitcnt lgkmcnt(10)
    v_mfma_f32_16x16x32_bf16 v[32:35], v[132:135], v[64:67], 0
    s_waitcnt lgkmcnt(9)
    v_mfma_f32_16x16x32_bf16 v[36:39], v[132:135], v[68:71], 0
    s_waitcnt lgkmcnt(8)
    v_mfma_f32_16x16x32_bf16 v[40:43], v[132:135], v[72:75], 0
    s_waitcnt lgkmcnt(7)
    v_mfma_f32_16x16x32_bf16 v[44:47], v[132:135], v[76:79], 0
    s_waitcnt lgkmcnt(6)
    v_mfma_f32_16x16x32_bf16 v[48:51], v[132:135], v[80:83], 0
    s_waitcnt lgkmcnt(4)
    v_mfma_f32_16x16x32_bf16 v[48:51], v[116:119], v[80:83], v[48:51]
    buffer_load_dwordx4 a[64:67], v139, s[36:39], s78 offen offset:0 sc1
    ds_read_b128 v[84:87], v136 offset:384
    ds_read_b64_tr_b16 v[128:129], v137 offset:3080
    ds_read_b64_tr_b16 v[130:131], v137 offset:3072
    v_mfma_f32_16x16x32_bf16 v[44:47], v[116:119], v[76:79], v[44:47]
    v_mfma_f32_16x16x32_bf16 v[40:43], v[116:119], v[72:75], v[40:43]
    v_mfma_f32_16x16x32_bf16 v[36:39], v[116:119], v[68:71], v[36:39]
    buffer_load_dwordx4 a[68:71], v139, s[36:39], s78 offen offset:1024 sc1
    ds_read_b128 v[88:91], v136 offset:896
    v_mfma_f32_16x16x32_bf16 v[32:35], v[116:119], v[64:67], v[32:35]
    v_mfma_f32_16x16x32_bf16 v[28:31], v[116:119], v[60:63], v[28:31]
    v_mfma_f32_16x16x32_bf16 v[24:27], v[116:119], v[56:59], v[24:27]
    ds_read_b128 v[92:95], v136 offset:1408
    v_mfma_f32_16x16x32_bf16 v[20:23], v[116:119], v[52:55], v[20:23]
    buffer_load_dwordx4 a[72:75], v139, s[36:39], s78 offen offset:2048 sc1
    s_waitcnt lgkmcnt(7)
    v_mfma_f32_16x16x32_bf16 v[48:51], v[120:123], v[52:55], v[48:51]
    ds_read_b64_tr_b16 v[116:117], v137 offset:1032
    ds_read_b64_tr_b16 v[118:119], v137 offset:1024
    s_waitcnt lgkmcnt(7)
    v_mfma_f32_16x16x32_bf16 v[48:51], v[124:127], v[76:79], v[48:51]
    ds_read_b128 v[96:99], v136 offset:1920
    ds_read_b64_tr_b16 v[120:121], v137 offset:2568
    ds_read_b64_tr_b16 v[122:123], v137 offset:2560
    v_mfma_f32_16x16x32_bf16 v[44:47], v[124:127], v[72:75], v[44:47]
    v_mfma_f32_16x16x32_bf16 v[40:43], v[124:127], v[68:71], v[40:43]
    buffer_load_dwordx4 a[76:79], v139, s[36:39], s78 offen offset:3072 sc1
    v_mfma_f32_16x16x32_bf16 v[36:39], v[124:127], v[64:67], v[36:39]
    ds_read_b128 v[100:103], v136 offset:2432
    v_mfma_f32_16x16x32_bf16 v[32:35], v[124:127], v[60:63], v[32:35]
    v_mfma_f32_16x16x32_bf16 v[28:31], v[124:127], v[56:59], v[28:31]
    v_mfma_f32_16x16x32_bf16 v[24:27], v[124:127], v[52:55], v[24:27]
    s_add_u32 s78, s78, 4096
    ds_read_b128 v[104:107], v136 offset:2944
    s_waitcnt lgkmcnt(9)
    v_mfma_f32_16x16x32_bf16 v[48:51], v[128:131], v[56:59], v[48:51]
    buffer_load_dwordx4 a[80:83], v139, s[36:39], s78 offen offset:0 sc1
    ds_read_b64_tr_b16 v[124:125], v137 offset:1544
    ds_read_b64_tr_b16 v[126:127], v137 offset:1536
    v_mfma_f32_16x16x32_bf16 v[44:47], v[128:131], v[52:55], v[44:47]
    s_waitcnt lgkmcnt(7)
    v_mfma_f32_16x16x32_bf16 v[48:51], v[116:119], v[72:75], v[48:51]
    ds_read_b128 v[108:111], v136 offset:3456
    ds_read_b64_tr_b16 v[128:129], v137 offset:2056
    ds_read_b64_tr_b16 v[130:131], v137 offset:2048
    v_mfma_f32_16x16x32_bf16 v[44:47], v[116:119], v[68:71], v[44:47]
    buffer_load_dwordx4 a[84:87], v139, s[36:39], s78 offen offset:1024 sc1
    v_mfma_f32_16x16x32_bf16 v[40:43], v[116:119], v[64:67], v[40:43]
    v_mfma_f32_16x16x32_bf16 v[36:39], v[116:119], v[60:63], v[36:39]
    ds_read_b128 v[112:115], v136 offset:3968
    v_mfma_f32_16x16x32_bf16 v[32:35], v[116:119], v[56:59], v[32:35]
    v_mfma_f32_16x16x32_bf16 v[28:31], v[116:119], v[52:55], v[28:31]
    buffer_load_dwordx4 a[88:91], v139, s[36:39], s78 offen offset:2048 sc1
    s_waitcnt lgkmcnt(8)
    v_mfma_f32_16x16x32_bf16 v[48:51], v[120:123], v[60:63], v[48:51]
    ds_read_b64_tr_b16 v[116:117], v137 offset:72
    ds_read_b64_tr_b16 v[118:119], v137 offset:64
    v_mfma_f32_16x16x32_bf16 v[44:47], v[120:123], v[56:59], v[44:47]
    v_mfma_f32_16x16x32_bf16 v[40:43], v[120:123], v[52:55], v[40:43]
    s_waitcnt lgkmcnt(6)
    v_mfma_f32_16x16x32_bf16 v[48:51], v[124:127], v[68:71], v[48:51]
    buffer_load_dwordx4 a[92:95], v139, s[36:39], s78 offen offset:3072 sc1
    ds_read_b64_tr_b16 v[120:121], v137 offset:3656
    ds_read_b64_tr_b16 v[122:123], v137 offset:3648
    v_mfma_f32_16x16x32_bf16 v[44:47], v[124:127], v[64:67], v[44:47]
    v_mfma_f32_16x16x32_bf16 v[40:43], v[124:127], v[60:63], v[40:43]
    v_mfma_f32_16x16x32_bf16 v[36:39], v[124:127], v[56:59], v[36:39]
    v_mfma_f32_16x16x32_bf16 v[32:35], v[124:127], v[52:55], v[32:35]
    s_add_u32 s78, s78, 4096
    s_waitcnt lgkmcnt(5)
    v_mfma_f32_16x16x32_bf16 v[48:51], v[128:131], v[64:67], v[48:51]
    buffer_load_dwordx4 a[96:99], v139, s[36:39], s78 offen offset:0 sc1
    ds_read_b64_tr_b16 v[124:125], v137 offset:584
    ds_read_b64_tr_b16 v[126:127], v137 offset:576
    v_mfma_f32_16x16x32_bf16 v[44:47], v[128:131], v[60:63], v[44:47]
    v_mfma_f32_16x16x32_bf16 v[40:43], v[128:131], v[56:59], v[40:43]
    v_mfma_f32_16x16x32_bf16 v[36:39], v[128:131], v[52:55], v[36:39]
    s_waitcnt lgkmcnt(4)
    v_mfma_f32_16x16x32_bf16 v[48:51], v[116:119], v[112:115], v[48:51]
    buffer_load_dwordx4 a[100:103], v139, s[36:39], s78 offen offset:1024 sc1
    ds_read_b128 v[52:55], v136 offset:320
    ds_read_b64_tr_b16 v[128:129], v137 offset:3144
    ds_read_b64_tr_b16 v[130:131], v137 offset:3136
    v_mfma_f32_16x16x32_bf16 v[44:47], v[116:119], v[108:111], v[44:47]
    v_mfma_f32_16x16x32_bf16 v[40:43], v[116:119], v[104:107], v[40:43]
    v_mfma_f32_16x16x32_bf16 v[36:39], v[116:119], v[100:103], v[36:39]
    buffer_load_dwordx4 a[104:107], v139, s[36:39], s78 offen offset:2048 sc1
    ds_read_b128 v[56:59], v136 offset:832
    v_mfma_f32_16x16x32_bf16 v[32:35], v[116:119], v[96:99], v[32:35]
    v_mfma_f32_16x16x32_bf16 v[28:31], v[116:119], v[92:95], v[28:31]
    v_mfma_f32_16x16x32_bf16 v[24:27], v[116:119], v[88:91], v[24:27]
    ds_read_b128 v[60:63], v136 offset:1344
    v_mfma_f32_16x16x32_bf16 v[20:23], v[116:119], v[84:87], v[20:23]
    buffer_load_dwordx4 a[108:111], v139, s[36:39], s78 offen offset:3072 sc1
    s_waitcnt lgkmcnt(7)
    v_mfma_f32_16x16x32_bf16 v[48:51], v[120:123], v[84:87], v[48:51]
    ds_read_b64_tr_b16 v[116:117], v137 offset:1096
    ds_read_b64_tr_b16 v[118:119], v137 offset:1088
    s_waitcnt lgkmcnt(7)
    v_mfma_f32_16x16x32_bf16 v[48:51], v[124:127], v[108:111], v[48:51]
    ds_read_b128 v[64:67], v136 offset:1856
    ds_read_b64_tr_b16 v[120:121], v137 offset:2632
    ds_read_b64_tr_b16 v[122:123], v137 offset:2624
    v_mfma_f32_16x16x32_bf16 v[44:47], v[124:127], v[104:107], v[44:47]
    v_mfma_f32_16x16x32_bf16 v[40:43], v[124:127], v[100:103], v[40:43]
    s_add_u32 s78, s78, 4096
    v_mfma_f32_16x16x32_bf16 v[36:39], v[124:127], v[96:99], v[36:39]
    buffer_load_dwordx4 a[112:115], v139, s[36:39], s78 offen offset:0 sc1
    ds_read_b128 v[68:71], v136 offset:2368
    v_mfma_f32_16x16x32_bf16 v[32:35], v[124:127], v[92:95], v[32:35]
    v_mfma_f32_16x16x32_bf16 v[28:31], v[124:127], v[88:91], v[28:31]
    v_mfma_f32_16x16x32_bf16 v[24:27], v[124:127], v[84:87], v[24:27]
    ds_read_b128 v[72:75], v136 offset:2880
    s_waitcnt lgkmcnt(9)
    v_mfma_f32_16x16x32_bf16 v[48:51], v[128:131], v[88:91], v[48:51]
    buffer_load_dwordx4 a[116:119], v139, s[36:39], s78 offen offset:1024 sc1
    ds_read_b64_tr_b16 v[124:125], v137 offset:1608
    ds_read_b64_tr_b16 v[126:127], v137 offset:1600
    v_mfma_f32_16x16x32_bf16 v[44:47], v[128:131], v[84:87], v[44:47]
    s_waitcnt lgkmcnt(7)
    v_mfma_f32_16x16x32_bf16 v[48:51], v[116:119], v[104:107], v[48:51]
    ds_read_b128 v[76:79], v136 offset:3392
    ds_read_b64_tr_b16 v[128:129], v137 offset:2120
    ds_read_b64_tr_b16 v[130:131], v137 offset:2112
    v_mfma_f32_16x16x32_bf16 v[44:47], v[116:119], v[100:103], v[44:47]
    buffer_load_dwordx4 a[120:123], v139, s[36:39], s78 offen offset:2048 sc1
    v_mfma_f32_16x16x32_bf16 v[40:43], v[116:119], v[96:99], v[40:43]
    v_mfma_f32_16x16x32_bf16 v[36:39], v[116:119], v[92:95], v[36:39]
    ds_read_b128 v[80:83], v136 offset:3904
    v_mfma_f32_16x16x32_bf16 v[32:35], v[116:119], v[88:91], v[32:35]
    v_mfma_f32_16x16x32_bf16 v[28:31], v[116:119], v[84:87], v[28:31]
    buffer_load_dwordx4 a[124:127], v139, s[36:39], s78 offen offset:3072 sc1
    s_waitcnt lgkmcnt(8)
    v_mfma_f32_16x16x32_bf16 v[48:51], v[120:123], v[92:95], v[48:51]
    ds_read_b64_tr_b16 v[116:117], v137 offset:136
    ds_read_b64_tr_b16 v[118:119], v137 offset:128
    v_mfma_f32_16x16x32_bf16 v[44:47], v[120:123], v[88:91], v[44:47]
    v_mfma_f32_16x16x32_bf16 v[40:43], v[120:123], v[84:87], v[40:43]
    s_waitcnt lgkmcnt(6)
    v_mfma_f32_16x16x32_bf16 v[48:51], v[124:127], v[100:103], v[48:51]
    s_add_u32 s78, s78, 4096
    ds_read_b64_tr_b16 v[120:121], v137 offset:3720
    ds_read_b64_tr_b16 v[122:123], v137 offset:3712
    v_mfma_f32_16x16x32_bf16 v[44:47], v[124:127], v[96:99], v[44:47]
    buffer_load_dwordx4 a[128:131], v139, s[36:39], s78 offen offset:0 sc1
    v_mfma_f32_16x16x32_bf16 v[40:43], v[124:127], v[92:95], v[40:43]
    v_mfma_f32_16x16x32_bf16 v[36:39], v[124:127], v[88:91], v[36:39]
    v_mfma_f32_16x16x32_bf16 v[32:35], v[124:127], v[84:87], v[32:35]
    s_waitcnt lgkmcnt(5)
    v_mfma_f32_16x16x32_bf16 v[48:51], v[128:131], v[96:99], v[48:51]
    buffer_load_dwordx4 a[132:135], v139, s[36:39], s78 offen offset:1024 sc1
    ds_read_b64_tr_b16 v[124:125], v137 offset:648
    ds_read_b64_tr_b16 v[126:127], v137 offset:640
    v_mfma_f32_16x16x32_bf16 v[44:47], v[128:131], v[92:95], v[44:47]
    v_mfma_f32_16x16x32_bf16 v[40:43], v[128:131], v[88:91], v[40:43]
    v_mfma_f32_16x16x32_bf16 v[36:39], v[128:131], v[84:87], v[36:39]
    s_waitcnt lgkmcnt(4)
    v_mfma_f32_16x16x32_bf16 v[48:51], v[116:119], v[80:83], v[48:51]
    s_waitcnt vmcnt(18)
    s_barrier
    s_lshl_b32 s80, s68, 4
    s_add_u32 s80, s80, s69
    s_lshl_b32 s80, s80, 6
    ds_read_b128 v[84:87], v136 offset:256
    ds_read_b64_tr_b16 v[128:129], v137 offset:3208
    ds_read_b64_tr_b16 v[130:131], v137 offset:3200
    v_mfma_f32_16x16x32_bf16 v[44:47], v[116:119], v[76:79], v[44:47]
    s_add_u32 s80, s80, 20480
    v_mov_b32 v16, s80
    v_mov_b32 v17, 2147483648
    v_mfma_f32_16x16x32_bf16 v[40:43], v[116:119], v[72:75], v[40:43]
    v_cmp_eq_u32 vcc, 0, v0
    s_nop 1
    v_cndmask_b32 v16, v17, v16, vcc
    v_mov_b32 v17, s5
    buffer_store_dword v17, v16, s[36:39], 0 offen sc1
    v_mfma_f32_16x16x32_bf16 v[36:39], v[116:119], v[68:71], v[36:39]
    ds_read_b128 v[88:91], v136 offset:768
    v_mfma_f32_16x16x32_bf16 v[32:35], v[116:119], v[64:67], v[32:35]
    buffer_load_dwordx4 a[136:139], v139, s[36:39], s78 offen offset:2048 sc1
    v_mfma_f32_16x16x32_bf16 v[28:31], v[116:119], v[60:63], v[28:31]
    v_mfma_f32_16x16x32_bf16 v[24:27], v[116:119], v[56:59], v[24:27]
    ds_read_b128 v[92:95], v136 offset:1280
    v_mfma_f32_16x16x32_bf16 v[20:23], v[116:119], v[52:55], v[20:23]
    buffer_load_dwordx4 a[140:143], v139, s[36:39], s78 offen offset:3072 sc1
    s_waitcnt lgkmcnt(7)
    v_mfma_f32_16x16x32_bf16 v[48:51], v[120:123], v[52:55], v[48:51]
    ds_read_b64_tr_b16 v[116:117], v137 offset:1160
    ds_read_b64_tr_b16 v[118:119], v137 offset:1152
    s_waitcnt lgkmcnt(7)
    v_mfma_f32_16x16x32_bf16 v[48:51], v[124:127], v[76:79], v[48:51]
    ds_read_b128 v[96:99], v136 offset:1792
    ds_read_b64_tr_b16 v[120:121], v137 offset:2696
    ds_read_b64_tr_b16 v[122:123], v137 offset:2688
    v_mfma_f32_16x16x32_bf16 v[44:47], v[124:127], v[72:75], v[44:47]
    v_mfma_f32_16x16x32_bf16 v[40:43], v[124:127], v[68:71], v[40:43]
    s_add_u32 s78, s78, 4096
    buffer_load_dwordx4 a[144:147], v139, s[36:39], s78 offen offset:0 sc1
    v_mfma_f32_16x16x32_bf16 v[36:39], v[124:127], v[64:67], v[36:39]
    ds_read_b128 v[100:103], v136 offset:2304
    v_mfma_f32_16x16x32_bf16 v[32:35], v[124:127], v[60:63], v[32:35]
    v_mfma_f32_16x16x32_bf16 v[28:31], v[124:127], v[56:59], v[28:31]
    buffer_load_dwordx4 a[148:151], v139, s[36:39], s78 offen offset:1024 sc1
    v_mfma_f32_16x16x32_bf16 v[24:27], v[124:127], v[52:55], v[24:27]
    ds_read_b128 v[104:107], v136 offset:2816
    s_waitcnt lgkmcnt(9)
    v_mfma_f32_16x16x32_bf16 v[48:51], v[128:131], v[56:59], v[48:51]
    ds_read_b64_tr_b16 v[124:125], v137 offset:1672
    ds_read_b64_tr_b16 v[126:127], v137 offset:1664
    v_mfma_f32_16x16x32_bf16 v[44:47], v[128:131], v[52:55], v[44:47]
    s_waitcnt lgkmcnt(7)
    v_mfma_f32_16x16x32_bf16 v[48:51], v[116:119], v[72:75], v[48:51]
    buffer_load_dwordx4 a[152:155], v139, s[36:39], s78 offen offset:2048 sc1
    ds_read_b128 v[108:111], v136 offset:3328
    ds_read_b64_tr_b16 v[128:129], v137 offset:2184
    ds_read_b64_tr_b16 v[130:131], v137 offset:2176
    v_mfma_f32_16x16x32_bf16 v[44:47], v[116:119], v[68:71], v[44:47]
    v_mfma_f32_16x16x32_bf16 v[40:43], v[116:119], v[64:67], v[40:43]
    v_mfma_f32_16x16x32_bf16 v[36:39], v[116:119], v[60:63], v[36:39]
    buffer_load_dwordx4 a[156:159], v139, s[36:39], s78 offen offset:3072 sc1
    ds_read_b128 v[112:115], v136 offset:3840
    v_mfma_f32_16x16x32_bf16 v[32:35], v[116:119], v[56:59], v[32:35]
    v_mfma_f32_16x16x32_bf16 v[28:31], v[116:119], v[52:55], v[28:31]
    s_waitcnt lgkmcnt(8)
    v_mfma_f32_16x16x32_bf16 v[48:51], v[120:123], v[60:63], v[48:51]
    ds_read_b64_tr_b16 v[116:117], v137 offset:200
    ds_read_b64_tr_b16 v[118:119], v137 offset:192
    v_mfma_f32_16x16x32_bf16 v[44:47], v[120:123], v[56:59], v[44:47]
    s_add_u32 s78, s78, 4096
    buffer_load_dwordx4 a[160:163], v139, s[36:39], s78 offen offset:0 sc1
    v_mfma_f32_16x16x32_bf16 v[40:43], v[120:123], v[52:55], v[40:43]
    s_waitcnt lgkmcnt(6)
    v_mfma_f32_16x16x32_bf16 v[48:51], v[124:127], v[68:71], v[48:51]
    ds_read_b64_tr_b16 v[120:121], v137 offset:3784
    ds_read_b64_tr_b16 v[122:123], v137 offset:3776
    v_mfma_f32_16x16x32_bf16 v[44:47], v[124:127], v[64:67], v[44:47]
    v_mfma_f32_16x16x32_bf16 v[40:43], v[124:127], v[60:63], v[40:43]
    buffer_load_dwordx4 a[164:167], v139, s[36:39], s78 offen offset:1024 sc1
    v_mfma_f32_16x16x32_bf16 v[36:39], v[124:127], v[56:59], v[36:39]
    v_mfma_f32_16x16x32_bf16 v[32:35], v[124:127], v[52:55], v[32:35]
    s_waitcnt lgkmcnt(5)
    v_mfma_f32_16x16x32_bf16 v[48:51], v[128:131], v[64:67], v[48:51]
    buffer_load_dwordx4 a[168:171], v139, s[36:39], s78 offen offset:2048 sc1
    ds_read_b64_tr_b16 v[124:125], v137 offset:712
    ds_read_b64_tr_b16 v[126:127], v137 offset:704
    v_mfma_f32_16x16x32_bf16 v[44:47], v[128:131], v[60:63], v[44:47]
    v_mfma_f32_16x16x32_bf16 v[40:43], v[128:131], v[56:59], v[40:43]
    v_mfma_f32_16x16x32_bf16 v[36:39], v[128:131], v[52:55], v[36:39]
    s_waitcnt lgkmcnt(4)
    v_mfma_f32_16x16x32_bf16 v[48:51], v[116:119], v[112:115], v[48:51]
    buffer_load_dwordx4 a[172:175], v139, s[36:39], s78 offen offset:3072 sc1
    ds_read_b128 v[52:55], v136 offset:192
    ds_read_b64_tr_b16 v[128:129], v137 offset:3272
    ds_read_b64_tr_b16 v[130:131], v137 offset:3264
    v_mfma_f32_16x16x32_bf16 v[44:47], v[116:119], v[108:111], v[44:47]
    v_mfma_f32_16x16x32_bf16 v[40:43], v[116:119], v[104:107], v[40:43]
    v_mfma_f32_16x16x32_bf16 v[36:39], v[116:119], v[100:103], v[36:39]
    s_add_u32 s78, s78, 4096
    ds_read_b128 v[56:59], v136 offset:704
    v_mfma_f32_16x16x32_bf16 v[32:35], v[116:119], v[96:99], v[32:35]
    buffer_load_dwordx4 a[176:179], v139, s[36:39], s78 offen offset:0 sc1
    v_mfma_f32_16x16x32_bf16 v[28:31], v[116:119], v[92:95], v[28:31]
    v_mfma_f32_16x16x32_bf16 v[24:27], v[116:119], v[88:91], v[24:27]
    ds_read_b128 v[60:63], v136 offset:1216
    v_mfma_f32_16x16x32_bf16 v[20:23], v[116:119], v[84:87], v[20:23]
    s_waitcnt lgkmcnt(7)
    v_mfma_f32_16x16x32_bf16 v[48:51], v[120:123], v[84:87], v[48:51]
    buffer_load_dwordx4 a[180:183], v139, s[36:39], s78 offen offset:1024 sc1
    ds_read_b64_tr_b16 v[116:117], v137 offset:1224
    ds_read_b64_tr_b16 v[118:119], v137 offset:1216
    s_waitcnt lgkmcnt(7)
    v_mfma_f32_16x16x32_bf16 v[48:51], v[124:127], v[108:111], v[48:51]
    ds_read_b128 v[64:67], v136 offset:1728
    ds_read_b64_tr_b16 v[120:121], v137 offset:2760
    ds_read_b64_tr_b16 v[122:123], v137 offset:2752
    v_mfma_f32_16x16x32_bf16 v[44:47], v[124:127], v[104:107], v[44:47]
    v_mfma_f32_16x16x32_bf16 v[40:43], v[124:127], v[100:103], v[40:43]
    v_mfma_f32_16x16x32_bf16 v[36:39], v[124:127], v[96:99], v[36:39]
    buffer_load_dwordx4 a[184:187], v139, s[36:39], s78 offen offset:2048 sc1
    ds_read_b128 v[68:71], v136 offset:2240
    v_mfma_f32_16x16x32_bf16 v[32:35], v[124:127], v[92:95], v[32:35]
    v_mfma_f32_16x16x32_bf16 v[28:31], v[124:127], v[88:91], v[28:31]
    v_mfma_f32_16x16x32_bf16 v[24:27], v[124:127], v[84:87], v[24:27]
    buffer_load_dwordx4 a[188:191], v139, s[36:39], s78 offen offset:3072 sc1
    ds_read_b128 v[72:75], v136 offset:2752
    s_waitcnt lgkmcnt(9)
    v_mfma_f32_16x16x32_bf16 v[48:51], v[128:131], v[88:91], v[48:51]
    ds_read_b64_tr_b16 v[124:125], v137 offset:1736
    ds_read_b64_tr_b16 v[126:127], v137 offset:1728
    v_mfma_f32_16x16x32_bf16 v[44:47], v[128:131], v[84:87], v[44:47]
    s_waitcnt lgkmcnt(7)
    v_mfma_f32_16x16x32_bf16 v[48:51], v[116:119], v[104:107], v[48:51]
    ds_read_b128 v[76:79], v136 offset:3264
    ds_read_b64_tr_b16 v[128:129], v137 offset:2248
    ds_read_b64_tr_b16 v[130:131], v137 offset:2240
    v_mfma_f32_16x16x32_bf16 v[44:47], v[116:119], v[100:103], v[44:47]
    s_add_u32 s78, s78, 4096
    v_mfma_f32_16x16x32_bf16 v[40:43], v[116:119], v[96:99], v[40:43]
    buffer_load_dwordx4 a[192:195], v139, s[36:39], s78 offen offset:0 sc1
    v_mfma_f32_16x16x32_bf16 v[36:39], v[116:119], v[92:95], v[36:39]
    ds_read_b128 v[80:83], v136 offset:3776
    v_mfma_f32_16x16x32_bf16 v[32:35], v[116:119], v[88:91], v[32:35]
    v_mfma_f32_16x16x32_bf16 v[28:31], v[116:119], v[84:87], v[28:31]
    s_waitcnt lgkmcnt(8)
    v_mfma_f32_16x16x32_bf16 v[48:51], v[120:123], v[92:95], v[48:51]
    buffer_load_dwordx4 a[196:199], v139, s[36:39], s78 offen offset:1024 sc1
    ds_read_b64_tr_b16 v[116:117], v137 offset:264
    ds_read_b64_tr_b16 v[118:119], v137 offset:256
    v_mfma_f32_16x16x32_bf16 v[44:47], v[120:123], v[88:91], v[44:47]
    v_mfma_f32_16x16x32_bf16 v[40:43], v[120:123], v[84:87], v[40:43]
    s_waitcnt lgkmcnt(6)
    v_mfma_f32_16x16x32_bf16 v[48:51], v[124:127], v[100:103], v[48:51]
    buffer_load_dwordx4 a[200:203], v139, s[36:39], s78 offen offset:2048 sc1
    ds_read_b64_tr_b16 v[120:121], v137 offset:3848
    ds_read_b64_tr_b16 v[122:123], v137 offset:3840
    v_mfma_f32_16x16x32_bf16 v[44:47], v[124:127], v[96:99], v[44:47]
    v_mfma_f32_16x16x32_bf16 v[40:43], v[124:127], v[92:95], v[40:43]
    v_mfma_f32_16x16x32_bf16 v[36:39], v[124:127], v[88:91], v[36:39]
    v_mfma_f32_16x16x32_bf16 v[32:35], v[124:127], v[84:87], v[32:35]
    buffer_load_dwordx4 a[204:207], v139, s[36:39], s78 offen offset:3072 sc1
    s_waitcnt lgkmcnt(5)
    v_mfma_f32_16x16x32_bf16 v[48:51], v[128:131], v[96:99], v[48:51]
    ds_read_b64_tr_b16 v[124:125], v137 offset:776
    ds_read_b64_tr_b16 v[126:127], v137 offset:768
    v_mfma_f32_16x16x32_bf16 v[44:47], v[128:131], v[92:95], v[44:47]
    v_mfma_f32_16x16x32_bf16 v[40:43], v[128:131], v[88:91], v[40:43]
    v_mfma_f32_16x16x32_bf16 v[36:39], v[128:131], v[84:87], v[36:39]
    s_add_u32 s78, s78, 4096
    s_waitcnt lgkmcnt(4)
    v_mfma_f32_16x16x32_bf16 v[48:51], v[116:119], v[80:83], v[48:51]
    s_lshr_b32 s80, s70, 1
    s_lshl_b32 s80, s80, 4
    s_lshl_b32 s81, s4, 2
    s_add_u32 s80, s80, s81
    ds_read_b128 v[84:87], v136 offset:128
    ds_read_b64_tr_b16 v[128:129], v137 offset:3336
    ds_read_b64_tr_b16 v[130:131], v137 offset:3328
    v_mfma_f32_16x16x32_bf16 v[44:47], v[116:119], v[76:79], v[44:47]
    v_and_b32 v13, 3, v1
    v_add_u32 v13, s80, v13
    v_lshlrev_b32 v13, 6, v13
    v_mfma_f32_16x16x32_bf16 v[40:43], v[116:119], v[72:75], v[40:43]
    v_add_u32 v13, 20480, v13
    buffer_load_dword v14, v13, s[36:39], 0 offen sc1
    v_mfma_f32_16x16x32_bf16 v[36:39], v[116:119], v[68:71], v[36:39]
    buffer_load_dwordx4 a[208:211], v139, s[36:39], s78 offen offset:0 sc1
    ds_read_b128 v[88:91], v136 offset:640
    v_mfma_f32_16x16x32_bf16 v[32:35], v[116:119], v[64:67], v[32:35]
    v_mfma_f32_16x16x32_bf16 v[28:31], v[116:119], v[60:63], v[28:31]
    v_mfma_f32_16x16x32_bf16 v[24:27], v[116:119], v[56:59], v[24:27]
    ds_read_b128 v[92:95], v136 offset:1152
    v_mfma_f32_16x16x32_bf16 v[20:23], v[116:119], v[52:55], v[20:23]
    buffer_load_dwordx4 a[212:215], v139, s[36:39], s78 offen offset:1024 sc1
    s_waitcnt lgkmcnt(7)
    v_mfma_f32_16x16x32_bf16 v[48:51], v[120:123], v[52:55], v[48:51]
    ds_read_b64_tr_b16 v[116:117], v137 offset:1288
    ds_read_b64_tr_b16 v[118:119], v137 offset:1280
    s_waitcnt lgkmcnt(7)
    v_mfma_f32_16x16x32_bf16 v[48:51], v[124:127], v[76:79], v[48:51]
    ds_read_b128 v[96:99], v136 offset:1664
    ds_read_b64_tr_b16 v[120:121], v137 offset:2824
    ds_read_b64_tr_b16 v[122:123], v137 offset:2816
    v_mfma_f32_16x16x32_bf16 v[44:47], v[124:127], v[72:75], v[44:47]
    v_mfma_f32_16x16x32_bf16 v[40:43], v[124:127], v[68:71], v[40:43]
    buffer_load_dwordx4 a[216:219], v139, s[36:39], s78 offen offset:2048 sc1
    v_mfma_f32_16x16x32_bf16 v[36:39], v[124:127], v[64:67], v[36:39]
    ds_read_b128 v[100:103], v136 offset:2176
    v_mfma_f32_16x16x32_bf16 v[32:35], v[124:127], v[60:63], v[32:35]
    v_mfma_f32_16x16x32_bf16 v[28:31], v[124:127], v[56:59], v[28:31]
    v_mfma_f32_16x16x32_bf16 v[24:27], v[124:127], v[52:55], v[24:27]
    buffer_load_dwordx4 a[220:223], v139, s[36:39], s78 offen offset:3072 sc1
    ds_read_b128 v[104:107], v136 offset:2688
    s_waitcnt lgkmcnt(9)
    v_mfma_f32_16x16x32_bf16 v[48:51], v[128:131], v[56:59], v[48:51]
    ds_read_b64_tr_b16 v[124:125], v137 offset:1800
    ds_read_b64_tr_b16 v[126:127], v137 offset:1792
    v_mfma_f32_16x16x32_bf16 v[44:47], v[128:131], v[52:55], v[44:47]
    s_waitcnt lgkmcnt(7)
    v_mfma_f32_16x16x32_bf16 v[48:51], v[116:119], v[72:75], v[48:51]
    ds_read_b128 v[108:111], v136 offset:3200
    ds_read_b64_tr_b16 v[128:129], v137 offset:2312
    ds_read_b64_tr_b16 v[130:131], v137 offset:2304
    v_mfma_f32_16x16x32_bf16 v[44:47], v[116:119], v[68:71], v[44:47]
    s_add_u32 s78, s78, 4096
    buffer_load_dwordx4 a[224:227], v139, s[36:39], s78 offen offset:0 sc1
    v_mfma_f32_16x16x32_bf16 v[40:43], v[116:119], v[64:67], v[40:43]
    v_mfma_f32_16x16x32_bf16 v[36:39], v[116:119], v[60:63], v[36:39]
    ds_read_b128 v[112:115], v136 offset:3712
    v_mfma_f32_16x16x32_bf16 v[32:35], v[116:119], v[56:59], v[32:35]
    v_mfma_f32_16x16x32_bf16 v[28:31], v[116:119], v[52:55], v[28:31]
    buffer_load_dwordx4 a[228:231], v139, s[36:39], s78 offen offset:1024 sc1
    s_waitcnt lgkmcnt(8)
    v_mfma_f32_16x16x32_bf16 v[48:51], v[120:123], v[60:63], v[48:51]
    ds_read_b64_tr_b16 v[116:117], v137 offset:328
    ds_read_b64_tr_b16 v[118:119], v137 offset:320
    v_mfma_f32_16x16x32_bf16 v[44:47], v[120:123], v[56:59], v[44:47]
    v_mfma_f32_16x16x32_bf16 v[40:43], v[120:123], v[52:55], v[40:43]
    s_waitcnt lgkmcnt(6)
    v_mfma_f32_16x16x32_bf16 v[48:51], v[124:127], v[68:71], v[48:51]
    buffer_load_dwordx4 a[232:235], v139, s[36:39], s78 offen offset:2048 sc1
    ds_read_b64_tr_b16 v[120:121], v137 offset:3912
    ds_read_b64_tr_b16 v[122:123], v137 offset:3904
    v_mfma_f32_16x16x32_bf16 v[44:47], v[124:127], v[64:67], v[44:47]
    v_mfma_f32_16x16x32_bf16 v[40:43], v[124:127], v[60:63], v[40:43]
    v_mfma_f32_16x16x32_bf16 v[36:39], v[124:127], v[56:59], v[36:39]
    v_mfma_f32_16x16x32_bf16 v[32:35], v[124:127], v[52:55], v[32:35]
    buffer_load_dwordx4 a[236:239], v139, s[36:39], s78 offen offset:3072 sc1
    s_waitcnt lgkmcnt(5)
    v_mfma_f32_16x16x32_bf16 v[48:51], v[128:131], v[64:67], v[48:51]
    ds_read_b64_tr_b16 v[124:125], v137 offset:840
    ds_read_b64_tr_b16 v[126:127], v137 offset:832
    v_mfma_f32_16x16x32_bf16 v[44:47], v[128:131], v[60:63], v[44:47]
    v_mfma_f32_16x16x32_bf16 v[40:43], v[128:131], v[56:59], v[40:43]
    v_mfma_f32_16x16x32_bf16 v[36:39], v[128:131], v[52:55], v[36:39]
    s_add_u32 s78, s78, 4096
    s_waitcnt lgkmcnt(4)
    v_mfma_f32_16x16x32_bf16 v[48:51], v[116:119], v[112:115], v[48:51]
    s_waitcnt vmcnt(8)
    v_cmp_ne_u32 vcc, s5, v14
    s_nop 0
    s_cbranch_vccnz LA_slowg13
LA_backg14:
    buffer_load_dwordx4 v[148:151], v2, s[36:39], s92 offen offset:0 sc1
    ds_read_b128 v[52:55], v136 offset:64
    ds_read_b64_tr_b16 v[128:129], v137 offset:3400
    ds_read_b64_tr_b16 v[130:131], v137 offset:3392
    v_mfma_f32_16x16x32_bf16 v[44:47], v[116:119], v[108:111], v[44:47]
    v_mfma_f32_16x16x32_bf16 v[40:43], v[116:119], v[104:107], v[40:43]
    v_mfma_f32_16x16x32_bf16 v[36:39], v[116:119], v[100:103], v[36:39]
    ds_read_b128 v[56:59], v136 offset:576
    v_mfma_f32_16x16x32_bf16 v[32:35], v[116:119], v[96:99], v[32:35]
    v_mfma_f32_16x16x32_bf16 v[28:31], v[116:119], v[92:95], v[28:31]
    v_mfma_f32_16x16x32_bf16 v[24:27], v[116:119], v[88:91], v[24:27]
    buffer_load_dwordx4 v[152:155], v2, s[36:39], s92 offen offset:1024 sc1
    ds_read_b128 v[60:63], v136 offset:1088
    v_mfma_f32_16x16x32_bf16 v[20:23], v[116:119], v[84:87], v[20:23]
    s_waitcnt lgkmcnt(7)
    v_mfma_f32_16x16x32_bf16 v[48:51], v[120:123], v[84:87], v[48:51]
    ds_read_b64_tr_b16 v[116:117], v137 offset:1352
    ds_read_b64_tr_b16 v[118:119], v137 offset:1344
    s_waitcnt lgkmcnt(7)
    v_mfma_f32_16x16x32_bf16 v[48:51], v[124:127], v[108:111], v[48:51]
    ds_read_b128 v[64:67], v136 offset:1600
    ds_read_b64_tr_b16 v[120:121], v137 offset:2888
    ds_read_b64_tr_b16 v[122:123], v137 offset:2880
    v_mfma_f32_16x16x32_bf16 v[44:47], v[124:127], v[104:107], v[44:47]
    v_mfma_f32_16x16x32_bf16 v[40:43], v[124:127], v[100:103], v[40:43]
    v_mfma_f32_16x16x32_bf16 v[36:39], v[124:127], v[96:99], v[36:39]
    buffer_load_dwordx4 v[156:159], v2, s[36:39], s92 offen offset:2048 sc1
    ds_read_b128 v[68:71], v136 offset:2112
    v_mfma_f32_16x16x32_bf16 v[32:35], v[124:127], v[92:95], v[32:35]
    v_mfma_f32_16x16x32_bf16 v[28:31], v[124:127], v[88:91], v[28:31]
    v_mfma_f32_16x16x32_bf16 v[24:27], v[124:127], v[84:87], v[24:27]
    ds_read_b128 v[72:75], v136 offset:2624
    s_waitcnt lgkmcnt(9)
    v_mfma_f32_16x16x32_bf16 v[48:51], v[128:131], v[88:91], v[48:51]
    ds_read_b64_tr_b16 v[124:125], v137 offset:1864
    ds_read_b64_tr_b16 v[126:127], v137 offset:1856
    v_mfma_f32_16x16x32_bf16 v[44:47], v[128:131], v[84:87], v[44:47]
    s_waitcnt lgkmcnt(7)
    v_mfma_f32_16x16x32_bf16 v[48:51], v[116:119], v[104:107], v[48:51]
    buffer_load_dwordx4 v[160:163], v2, s[36:39], s92 offen offset:3072 sc1
    ds_read_b128 v[76:79], v136 offset:3136
    ds_read_b64_tr_b16 v[128:129], v137 offset:2376
    ds_read_b64_tr_b16 v[130:131], v137 offset:2368
    v_mfma_f32_16x16x32_bf16 v[44:47], v[116:119], v[100:103], v[44:47]
    v_mfma_f32_16x16x32_bf16 v[40:43], v[116:119], v[96:99], v[40:43]
    v_mfma_f32_16x16x32_bf16 v[36:39], v[116:119], v[92:95], v[36:39]
    ds_read_b128 v[80:83], v136 offset:3648
    v_mfma_f32_16x16x32_bf16 v[32:35], v[116:119], v[88:91], v[32:35]
    v_mfma_f32_16x16x32_bf16 v[28:31], v[116:119], v[84:87], v[28:31]
    s_waitcnt lgkmcnt(8)
    v_mfma_f32_16x16x32_bf16 v[48:51], v[120:123], v[92:95], v[48:51]
    buffer_load_dwordx4 v[164:167], v3, s[36:39], s92 offen offset:0 sc1
    ds_read_b64_tr_b16 v[116:117], v137 offset:392
    ds_read_b64_tr_b16 v[118:119], v137 offset:384
    v_mfma_f32_16x16x32_bf16 v[44:47], v[120:123], v[88:91], v[44:47]
    v_mfma_f32_16x16x32_bf16 v[40:43], v[120:123], v[84:87], v[40:43]
    s_waitcnt lgkmcnt(6)
    v_mfma_f32_16x16x32_bf16 v[48:51], v[124:127], v[100:103], v[48:51]
    ds_read_b64_tr_b16 v[120:121], v137 offset:3976
    ds_read_b64_tr_b16 v[122:123], v137 offset:3968
    v_mfma_f32_16x16x32_bf16 v[44:47], v[124:127], v[96:99], v[44:47]
    v_mfma_f32_16x16x32_bf16 v[40:43], v[124:127], v[92:95], v[40:43]
    v_mfma_f32_16x16x32_bf16 v[36:39], v[124:127], v[88:91], v[36:39]
    buffer_load_dwordx4 v[168:171], v3, s[36:39], s92 offen offset:1024 sc1
    v_mfma_f32_16x16x32_bf16 v[32:35], v[124:127], v[84:87], v[32:35]
    s_waitcnt lgkmcnt(5)
    v_mfma_f32_16x16x32_bf16 v[48:51], v[128:131], v[96:99], v[48:51]
    ds_read_b64_tr_b16 v[124:125], v137 offset:904
    ds_read_b64_tr_b16 v[126:127], v137 offset:896
    v_mfma_f32_16x16x32_bf16 v[44:47], v[128:131], v[92:95], v[44:47]
    v_mfma_f32_16x16x32_bf16 v[40:43], v[128:131], v[88:91], v[40:43]
    v_mfma_f32_16x16x32_bf16 v[36:39], v[128:131], v[84:87], v[36:39]
    s_waitcnt lgkmcnt(4)
    v_mfma_f32_16x16x32_bf16 v[48:51], v[116:119], v[80:83], v[48:51]
    buffer_load_dwordx4 v[172:175], v3, s[36:39], s92 offen offset:2048 sc1
    ds_read_b128 v[84:87], v136 offset:0
    ds_read_b64_tr_b16 v[128:129], v137 offset:3464
    ds_read_b64_tr_b16 v[130:131], v137 offset:3456
    v_mfma_f32_16x16x32_bf16 v[44:47], v[116:119], v[76:79], v[44:47]
    v_mfma_f32_16x16x32_bf16 v[40:43], v[116:119], v[72:75], v[40:43]
    v_mfma_f32_16x16x32_bf16 v[36:39], v[116:119], v[68:71], v[36:39]
    ds_read_b128 v[88:91], v136 offset:512
    v_mfma_f32_16x16x32_bf16 v[32:35], v[116:119], v[64:67], v[32:35]
    v_mfma_f32_16x16x32_bf16 v[28:31], v[116:119], v[60:63], v[28:31]
    buffer_load_dwordx4 v[176:179], v3, s[36:39], s92 offen offset:3072 sc1
    v_mfma_f32_16x16x32_bf16 v[24:27], v[116:119], v[56:59], v[24:27]
    ds_read_b128 v[92:95], v136 offset:1024
    v_mfma_f32_16x16x32_bf16 v[20:23], v[116:119], v[52:55], v[20:23]
    s_waitcnt lgkmcnt(7)
    v_mfma_f32_16x16x32_bf16 v[48:51], v[120:123], v[52:55], v[48:51]
    ds_read_b64_tr_b16 v[116:117], v137 offset:1416
    ds_read_b64_tr_b16 v[118:119], v137 offset:1408
    s_waitcnt lgkmcnt(7)
    v_mfma_f32_16x16x32_bf16 v[48:51], v[124:127], v[76:79], v[48:51]
    ds_read_b128 v[96:99], v136 offset:1536
    ds_read_b64_tr_b16 v[120:121], v137 offset:2952
    ds_read_b64_tr_b16 v[122:123], v137 offset:2944
    v_mfma_f32_16x16x32_bf16 v[44:47], v[124:127], v[72:75], v[44:47]
    buffer_load_dwordx4 v[180:183], v4, s[36:39], s92 offen offset:0 sc1
    v_mfma_f32_16x16x32_bf16 v[40:43], v[124:127], v[68:71], v[40:43]
    v_mfma_f32_16x16x32_bf16 v[36:39], v[124:127], v[64:67], v[36:39]
    ds_read_b128 v[100:103], v136 offset:2048
    v_mfma_f32_16x16x32_bf16 v[32:35], v[124:127], v[60:63], v[32:35]
    v_mfma_f32_16x16x32_bf16 v[28:31], v[124:127], v[56:59], v[28:31]
    v_mfma_f32_16x16x32_bf16 v[24:27], v[124:127], v[52:55], v[24:27]
    buffer_load_dwordx4 v[184:187], v4, s[36:39], s92 offen offset:1024 sc1
    ds_read_b128 v[104:107], v136 offset:2560
    s_waitcnt lgkmcnt(9)
    v_mfma_f32_16x16x32_bf16 v[48:51], v[128:131], v[56:59], v[48:51]
    ds_read_b64_tr_b16 v[124:125], v137 offset:1928
    ds_read_b64_tr_b16 v[126:127], v137 offset:1920
    v_mfma_f32_16x16x32_bf16 v[44:47], v[128:131], v[52:55], v[44:47]
    s_waitcnt lgkmcnt(7)
    v_mfma_f32_16x16x32_bf16 v[48:51], v[116:119], v[72:75], v[48:51]
    ds_read_b128 v[108:111], v136 offset:3072
    ds_read_b64_tr_b16 v[128:129], v137 offset:2440
    ds_read_b64_tr_b16 v[130:131], v137 offset:2432
    v_mfma_f32_16x16x32_bf16 v[44:47], v[116:119], v[68:71], v[44:47]
    v_mfma_f32_16x16x32_bf16 v[40:43], v[116:119], v[64:67], v[40:43]
    buffer_load_dwordx4 v[188:191], v4, s[36:39], s92 offen offset:2048 sc1
    v_mfma_f32_16x16x32_bf16 v[36:39], v[116:119], v[60:63], v[36:39]
    ds_read_b128 v[112:115], v136 offset:3584
    v_mfma_f32_16x16x32_bf16 v[32:35], v[116:119], v[56:59], v[32:35]
    v_mfma_f32_16x16x32_bf16 v[28:31], v[116:119], v[52:55], v[28:31]
    s_waitcnt lgkmcnt(8)
    v_mfma_f32_16x16x32_bf16 v[48:51], v[120:123], v[60:63], v[48:51]
    ds_read_b64_tr_b16 v[116:117], v137 offset:456
    ds_read_b64_tr_b16 v[118:119], v137 offset:448
    v_mfma_f32_16x16x32_bf16 v[44:47], v[120:123], v[56:59], v[44:47]
    buffer_load_dwordx4 v[192:195], v4, s[36:39], s92 offen offset:3072 sc1
    v_mfma_f32_16x16x32_bf16 v[40:43], v[120:123], v[52:55], v[40:43]
    s_waitcnt lgkmcnt(6)
    v_mfma_f32_16x16x32_bf16 v[48:51], v[124:127], v[68:71], v[48:51]
    ds_read_b64_tr_b16 v[120:121], v137 offset:4040
    ds_read_b64_tr_b16 v[122:123], v137 offset:4032
    v_mfma_f32_16x16x32_bf16 v[44:47], v[124:127], v[64:67], v[44:47]
    v_mfma_f32_16x16x32_bf16 v[40:43], v[124:127], v[60:63], v[40:43]
    v_mfma_f32_16x16x32_bf16 v[36:39], v[124:127], v[56:59], v[36:39]
    buffer_load_dwordx4 v[196:199], v2, s[36:39], s93 offen offset:0 sc1
    v_mfma_f32_16x16x32_bf16 v[32:35], v[124:127], v[52:55], v[32:35]
    s_waitcnt lgkmcnt(5)
    v_mfma_f32_16x16x32_bf16 v[48:51], v[128:131], v[64:67], v[48:51]
    ds_read_b64_tr_b16 v[124:125], v137 offset:968
    ds_read_b64_tr_b16 v[126:127], v137 offset:960
    v_mfma_f32_16x16x32_bf16 v[44:47], v[128:131], v[60:63], v[44:47]
    v_mfma_f32_16x16x32_bf16 v[40:43], v[128:131], v[56:59], v[40:43]
    v_mfma_f32_16x16x32_bf16 v[36:39], v[128:131], v[52:55], v[36:39]
    s_waitcnt lgkmcnt(4)
    v_mfma_f32_16x16x32_bf16 v[48:51], v[116:119], v[112:115], v[48:51]
    buffer_load_dwordx4 v[200:203], v2, s[36:39], s93 offen offset:1024 sc1
    ds_read_b64_tr_b16 v[128:129], v137 offset:3528
    ds_read_b64_tr_b16 v[130:131], v137 offset:3520
    v_mfma_f32_16x16x32_bf16 v[44:47], v[116:119], v[108:111], v[44:47]
    v_mfma_f32_16x16x32_bf16 v[40:43], v[116:119], v[104:107], v[40:43]
    v_mfma_f32_16x16x32_bf16 v[36:39], v[116:119], v[100:103], v[36:39]
    v_mfma_f32_16x16x32_bf16 v[32:35], v[116:119], v[96:99], v[32:35]
    v_mfma_f32_16x16x32_bf16 v[28:31], v[116:119], v[92:95], v[28:31]
    buffer_load_dwordx4 v[204:207], v2, s[36:39], s93 offen offset:2048 sc1
    v_mfma_f32_16x16x32_bf16 v[24:27], v[116:119], v[88:91], v[24:27]
    v_mfma_f32_16x16x32_bf16 v[20:23], v[116:119], v[84:87], v[20:23]
    s_waitcnt lgkmcnt(4)
    v_mfma_f32_16x16x32_bf16 v[48:51], v[120:123], v[84:87], v[48:51]
    ds_read_b64_tr_b16 v[116:117], v137 offset:1480
    ds_read_b64_tr_b16 v[118:119], v137 offset:1472
    s_waitcnt lgkmcnt(4)
    v_mfma_f32_16x16x32_bf16 v[48:51], v[124:127], v[108:111], v[48:51]
    ds_read_b64_tr_b16 v[120:121], v137 offset:3016
    ds_read_b64_tr_b16 v[122:123], v137 offset:3008
    v_mfma_f32_16x16x32_bf16 v[44:47], v[124:127], v[104:107], v[44:47]
    buffer_load_dwordx4 v[208:211], v2, s[36:39], s93 offen offset:3072 sc1
    v_mfma_f32_16x16x32_bf16 v[40:43], v[124:127], v[100:103], v[40:43]
    v_mfma_f32_16x16x32_bf16 v[36:39], v[124:127], v[96:99], v[36:39]
    v_mfma_f32_16x16x32_bf16 v[32:35], v[124:127], v[92:95], v[32:35]
    v_mfma_f32_16x16x32_bf16 v[28:31], v[124:127], v[88:91], v[28:31]
    v_mfma_f32_16x16x32_bf16 v[24:27], v[124:127], v[84:87], v[24:27]
    buffer_load_dwordx4 v[212:215], v3, s[36:39], s93 offen offset:0 sc1
    s_waitcnt lgkmcnt(4)
    v_mfma_f32_16x16x32_bf16 v[48:51], v[128:131], v[88:91], v[48:51]
    ds_read_b64_tr_b16 v[124:125], v137 offset:1992
    ds_read_b64_tr_b16 v[126:127], v137 offset:1984
    v_mfma_f32_16x16x32_bf16 v[44:47], v[128:131], v[84:87], v[44:47]
    s_waitcnt lgkmcnt(4)
    v_mfma_f32_16x16x32_bf16 v[48:51], v[116:119], v[104:107], v[48:51]
    ds_read_b64_tr_b16 v[128:129], v137 offset:2504
    ds_read_b64_tr_b16 v[130:131], v137 offset:2496
    v_mfma_f32_16x16x32_bf16 v[44:47], v[116:119], v[100:103], v[44:47]
    v_mfma_f32_16x16x32_bf16 v[40:43], v[116:119], v[96:99], v[40:43]
    buffer_load_dwordx4 v[216:219], v3, s[36:39], s93 offen offset:1024 sc1
    v_mfma_f32_16x16x32_bf16 v[36:39], v[116:119], v[92:95], v[36:39]
    v_mfma_f32_16x16x32_bf16 v[32:35], v[116:119], v[88:91], v[32:35]
    v_mfma_f32_16x16x32_bf16 v[28:31], v[116:119], v[84:87], v[28:31]
    s_waitcnt lgkmcnt(4)
    v_mfma_f32_16x16x32_bf16 v[48:51], v[120:123], v[92:95], v[48:51]
    v_mfma_f32_16x16x32_bf16 v[44:47], v[120:123], v[88:91], v[44:47]
    buffer_load_dwordx4 v[220:223], v3, s[36:39], s93 offen offset:2048 sc1
    v_mfma_f32_16x16x32_bf16 v[40:43], v[120:123], v[84:87], v[40:43]
    s_waitcnt lgkmcnt(2)
    v_mfma_f32_16x16x32_bf16 v[48:51], v[124:127], v[100:103], v[48:51]
    v_mfma_f32_16x16x32_bf16 v[44:47], v[124:127], v[96:99], v[44:47]
    v_mfma_f32_16x16x32_bf16 v[40:43], v[124:127], v[92:95], v[40:43]
    v_mfma_f32_16x16x32_bf16 v[36:39], v[124:127], v[88:91], v[36:39]
    buffer_load_dwordx4 v[224:227], v3, s[36:39], s93 offen offset:3072 sc1
    v_mfma_f32_16x16x32_bf16 v[32:35], v[124:127], v[84:87], v[32:35]
    s_waitcnt lgkmcnt(0)
    v_mfma_f32_16x16x32_bf16 v[48:51], v[128:131], v[96:99], v[48:51]
    v_mfma_f32_16x16x32_bf16 v[44:47], v[128:131], v[92:95], v[44:47]
    v_mfma_f32_16x16x32_bf16 v[40:43], v[128:131], v[88:91], v[40:43]
    v_mfma_f32_16x16x32_bf16 v[36:39], v[128:131], v[84:87], v[36:39]
    s_lshl_b32 s80, s2, 2
    s_add_u32 s80, s80, s4
    s_lshl_b32 s80, s80, 12
    s_add_u32 s80, s80, 4194304
    v_and_b32 v52, 15, v1
    v_lshlrev_b32 v52, 5, v52
    v_bfe_u32 v53, v1, 4, 1
    v_lshl_add_u32 v52, v53, 9, v52
    v_bfe_u32 v53, v1, 5, 1
    v_lshl_add_u32 v52, v53, 4, v52
    v_cvt_pk_bf16_f32 v56, v20, v21
    v_cvt_pk_bf16_f32 v57, v22, v23
    v_cvt_pk_bf16_f32 v58, v24, v25
    v_cvt_pk_bf16_f32 v59, v26, v27
    s_nop 0
    v_permlane16_swap_b32 v56, v58
    v_permlane16_swap_b32 v57, v59
    buffer_store_dwordx4 v[56:59], v52, s[36:39], s80 offen offset:0 sc1
    v_cvt_pk_bf16_f32 v60, v28, v29
    v_cvt_pk_bf16_f32 v61, v30, v31
    v_cvt_pk_bf16_f32 v62, v32, v33
    v_cvt_pk_bf16_f32 v63, v34, v35
    s_nop 0
    v_permlane16_swap_b32 v60, v62
    v_permlane16_swap_b32 v61, v63
    buffer_store_dwordx4 v[60:63], v52, s[36:39], s80 offen offset:1024 sc1
    v_cvt_pk_bf16_f32 v64, v36, v37
    v_cvt_pk_bf16_f32 v65, v38, v39
    v_cvt_pk_bf16_f32 v66, v40, v41
    v_cvt_pk_bf16_f32 v67, v42, v43
    s_nop 0
    v_permlane16_swap_b32 v64, v66
    v_permlane16_swap_b32 v65, v67
    buffer_store_dwordx4 v[64:67], v52, s[36:39], s80 offen offset:2048 sc1
    v_cvt_pk_bf16_f32 v68, v44, v45
    v_cvt_pk_bf16_f32 v69, v46, v47
    v_cvt_pk_bf16_f32 v70, v48, v49
    v_cvt_pk_bf16_f32 v71, v50, v51
    s_nop 0
    v_permlane16_swap_b32 v68, v70
    v_permlane16_swap_b32 v69, v71
    buffer_store_dwordx4 v[68:71], v52, s[36:39], s80 offen offset:3072 sc1
    s_waitcnt vmcnt(23)
    v_mfma_f32_16x16x32_bf16 v[20:23], a[0:3], v[148:151], 0
    buffer_load_dwordx4 v[228:231], v4, s[36:39], s93 offen offset:0 sc1
    v_mfma_f32_16x16x32_bf16 v[24:27], a[4:7], v[148:151], 0
    v_mfma_f32_16x16x32_bf16 v[28:31], a[8:11], v[148:151], 0
    v_mfma_f32_16x16x32_bf16 v[32:35], a[12:15], v[148:151], 0
    v_mfma_f32_16x16x32_bf16 v[36:39], a[16:19], v[148:151], 0
    s_waitcnt vmcnt(23)
    v_mfma_f32_16x16x32_bf16 v[20:23], a[20:23], v[152:155], v[20:23]
    buffer_load_dwordx4 v[232:235], v4, s[36:39], s93 offen offset:1024 sc1
    v_mfma_f32_16x16x32_bf16 v[24:27], a[24:27], v[152:155], v[24:27]
    v_mfma_f32_16x16x32_bf16 v[28:31], a[28:31], v[152:155], v[28:31]
    v_mfma_f32_16x16x32_bf16 v[32:35], a[32:35], v[152:155], v[32:35]
    v_mfma_f32_16x16x32_bf16 v[36:39], a[36:39], v[152:155], v[36:39]
    s_waitcnt vmcnt(23)
    v_mfma_f32_16x16x32_bf16 v[20:23], a[40:43], v[156:159], v[20:23]
    buffer_load_dwordx4 v[236:239], v4, s[36:39], s93 offen offset:2048 sc1
    v_mfma_f32_16x16x32_bf16 v[24:27], a[44:47], v[156:159], v[24:27]
    v_mfma_f32_16x16x32_bf16 v[28:31], a[48:51], v[156:159], v[28:31]
    v_mfma_f32_16x16x32_bf16 v[32:35], a[52:55], v[156:159], v[32:35]
    v_mfma_f32_16x16x32_bf16 v[36:39], a[56:59], v[156:159], v[36:39]
    s_waitcnt vmcnt(23)
    v_mfma_f32_16x16x32_bf16 v[20:23], a[60:63], v[160:163], v[20:23]
    buffer_load_dwordx4 v[240:243], v4, s[36:39], s93 offen offset:3072 sc1
    v_mfma_f32_16x16x32_bf16 v[24:27], a[64:67], v[160:163], v[24:27]
    v_mfma_f32_16x16x32_bf16 v[28:31], a[68:71], v[160:163], v[28:31]
    s_lshl_b32 s80, s70, 6
    s_lshl_b32 s81, s4, 4
    s_add_u32 s80, s80, s81
    v_and_b32 v9, 15, v1
    v_mfma_f32_16x16x32_bf16 v[32:35], a[72:75], v[160:163], v[32:35]
    v_add_u32 v9, s80, v9
    v_lshrrev_b32 v10, 4, v1
    s_mul_i32 s82, s71, 160
    v_lshl_add_u32 v10, v10, 3, s82
    v_mul_u32_u24 v11, 1280, v9
    v_mfma_f32_16x16x32_bf16 v[36:39], a[76:79], v[160:163], v[36:39]
    v_add_u32 v11, v11, v10
    buffer_load_dwordx2 v[60:61], v11, s[8:11], 0 offen offset:0
    s_waitcnt vmcnt(24)
    v_mfma_f32_16x16x32_bf16 v[20:23], a[80:83], v[164:167], v[20:23]
    buffer_load_dwordx4 v[244:247], v2, s[36:39], s94 offen offset:0 sc1
    v_mfma_f32_16x16x32_bf16 v[24:27], a[84:87], v[164:167], v[24:27]
    v_mfma_f32_16x16x32_bf16 v[28:31], a[88:91], v[164:167], v[28:31]
    v_mfma_f32_16x16x32_bf16 v[32:35], a[92:95], v[164:167], v[32:35]
    v_mfma_f32_16x16x32_bf16 v[36:39], a[96:99], v[164:167], v[36:39]
    s_waitcnt vmcnt(24)
    v_mfma_f32_16x16x32_bf16 v[20:23], a[100:103], v[168:171], v[20:23]
    buffer_load_dwordx4 v[248:251], v2, s[36:39], s94 offen offset:1024 sc1
    v_mfma_f32_16x16x32_bf16 v[24:27], a[104:107], v[168:171], v[24:27]
    v_mfma_f32_16x16x32_bf16 v[28:31], a[108:111], v[168:171], v[28:31]
    v_mfma_f32_16x16x32_bf16 v[32:35], a[112:115], v[168:171], v[32:35]
    buffer_load_dwordx2 v[62:63], v11, s[8:11], 0 offen offset:32
    v_mfma_f32_16x16x32_bf16 v[36:39], a[116:119], v[168:171], v[36:39]
    s_waitcnt vmcnt(25)
    v_mfma_f32_16x16x32_bf16 v[20:23], a[120:123], v[172:175], v[20:23]
    buffer_load_dwordx4 v[252:255], v2, s[36:39], s94 offen offset:2048 sc1
    v_mfma_f32_16x16x32_bf16 v[24:27], a[124:127], v[172:175], v[24:27]
    v_mfma_f32_16x16x32_bf16 v[28:31], a[128:131], v[172:175], v[28:31]
    v_mfma_f32_16x16x32_bf16 v[32:35], a[132:135], v[172:175], v[32:35]
    v_mfma_f32_16x16x32_bf16 v[36:39], a[136:139], v[172:175], v[36:39]
    s_waitcnt vmcnt(25)
    v_mfma_f32_16x16x32_bf16 v[20:23], a[140:143], v[176:179], v[20:23]
    buffer_load_dwordx4 v[104:107], v2, s[36:39], s94 offen offset:3072 sc1
    v_mfma_f32_16x16x32_bf16 v[24:27], a[144:147], v[176:179], v[24:27]
    v_mfma_f32_16x16x32_bf16 v[28:31], a[148:151], v[176:179], v[28:31]
    v_mfma_f32_16x16x32_bf16 v[32:35], a[152:155], v[176:179], v[32:35]
    buffer_load_dwordx2 v[64:65], v11, s[8:11], 0 offen offset:64
    v_mfma_f32_16x16x32_bf16 v[36:39], a[156:159], v[176:179], v[36:39]
    s_waitcnt vmcnt(26)
    v_mfma_f32_16x16x32_bf16 v[20:23], a[160:163], v[180:183], v[20:23]
    buffer_load_dwordx4 v[108:111], v3, s[36:39], s94 offen offset:0 sc1
    v_mfma_f32_16x16x32_bf16 v[24:27], a[164:167], v[180:183], v[24:27]
    v_mfma_f32_16x16x32_bf16 v[28:31], a[168:171], v[180:183], v[28:31]
    v_mfma_f32_16x16x32_bf16 v[32:35], a[172:175], v[180:183], v[32:35]
    v_mfma_f32_16x16x32_bf16 v[36:39], a[176:179], v[180:183], v[36:39]
    s_waitcnt vmcnt(26)
    v_mfma_f32_16x16x32_bf16 v[20:23], a[180:183], v[184:187], v[20:23]
    buffer_load_dwordx4 v[112:115], v3, s[36:39], s94 offen offset:1024 sc1
    v_mfma_f32_16x16x32_bf16 v[24:27], a[184:187], v[184:187], v[24:27]
    v_mfma_f32_16x16x32_bf16 v[28:31], a[188:191], v[184:187], v[28:31]
    v_mfma_f32_16x16x32_bf16 v[32:35], a[192:195], v[184:187], v[32:35]
    buffer_load_dwordx2 v[66:67], v11, s[8:11], 0 offen offset:96
    v_mfma_f32_16x16x32_bf16 v[36:39], a[196:199], v[184:187], v[36:39]
    s_waitcnt vmcnt(27)
    v_mfma_f32_16x16x32_bf16 v[20:23], a[200:203], v[188:191], v[20:23]
    buffer_load_dwordx4 v[116:119], v3, s[36:39], s94 offen offset:2048 sc1
    v_mfma_f32_16x16x32_bf16 v[24:27], a[204:207], v[188:191], v[24:27]
    v_mfma_f32_16x16x32_bf16 v[28:31], a[208:211], v[188:191], v[28:31]
    s_waitcnt vmcnt(15)
    s_barrier
    s_mov_b32 s80, s2
    s_lshl_b32 s80, s80, 6
    v_mfma_f32_16x16x32_bf16 v[32:35], a[212:215], v[188:191], v[32:35]
    s_add_u32 s80, s80, 36864
    v_mov_b32 v16, s80
    v_mov_b32 v17, 2147483648
    v_cmp_eq_u32 vcc, 0, v0
    s_nop 1
    v_cndmask_b32 v16, v17, v16, vcc
    v_mfma_f32_16x16x32_bf16 v[36:39], a[216:219], v[188:191], v[36:39]
    v_mov_b32 v17, s5
    buffer_store_dword v17, v16, s[36:39], 0 offen sc1
    v_mfma_f32_16x16x32_bf16 v[20:23], a[220:223], v[192:195], v[20:23]
    buffer_load_dwordx4 v[120:123], v3, s[36:39], s94 offen offset:3072 sc1
    v_mfma_f32_16x16x32_bf16 v[24:27], a[224:227], v[192:195], v[24:27]
    v_mfma_f32_16x16x32_bf16 v[28:31], a[228:231], v[192:195], v[28:31]
    v_mfma_f32_16x16x32_bf16 v[32:35], a[232:235], v[192:195], v[32:35]
    buffer_load_dwordx2 v[68:69], v11, s[8:11], 0 offen offset:128
    v_mfma_f32_16x16x32_bf16 v[36:39], a[236:239], v[192:195], v[36:39]
    v_mfma_f32_16x16x32_bf16 v[40:43], a[0:3], v[196:199], 0
    buffer_load_dwordx4 v[124:127], v4, s[36:39], s94 offen offset:0 sc1
    v_mfma_f32_16x16x32_bf16 v[44:47], a[4:7], v[196:199], 0
    v_mfma_f32_16x16x32_bf16 v[48:51], a[8:11], v[196:199], 0
    v_mfma_f32_16x16x32_bf16 v[52:55], a[12:15], v[196:199], 0
    v_mfma_f32_16x16x32_bf16 v[56:59], a[16:19], v[196:199], 0
    v_mfma_f32_16x16x32_bf16 v[40:43], a[20:23], v[200:203], v[40:43]
    buffer_load_dwordx4 v[128:131], v4, s[36:39], s94 offen offset:1024 sc1
    v_mfma_f32_16x16x32_bf16 v[44:47], a[24:27], v[200:203], v[44:47]
    v_mfma_f32_16x16x32_bf16 v[48:51], a[28:31], v[200:203], v[48:51]
    global_load_dwordx2 v[70:71], v10, s[60:61] offset:0
    v_mfma_f32_16x16x32_bf16 v[52:55], a[32:35], v[200:203], v[52:55]
    ds_write_b128 v5, v[20:23] offset:0
    v_mfma_f32_16x16x32_bf16 v[56:59], a[36:39], v[200:203], v[56:59]
    ds_write_b128 v5, v[24:27] offset:1024
    ds_write_b128 v5, v[28:31] offset:2048
    ds_write_b128 v5, v[32:35] offset:3072
    ds_write_b128 v5, v[36:39] offset:4096
    v_mfma_f32_16x16x32_bf16 v[40:43], a[40:43], v[204:207], v[40:43]
    buffer_load_dwordx4 v[132:135], v4, s[36:39], s94 offen offset:2048 sc1
    v_mfma_f32_16x16x32_bf16 v[44:47], a[44:47], v[204:207], v[44:47]
    v_mfma_f32_16x16x32_bf16 v[48:51], a[48:51], v[204:207], v[48:51]
    v_mfma_f32_16x16x32_bf16 v[52:55], a[52:55], v[204:207], v[52:55]
    v_mfma_f32_16x16x32_bf16 v[56:59], a[56:59], v[204:207], v[56:59]
    v_mfma_f32_16x16x32_bf16 v[40:43], a[60:63], v[208:211], v[40:43]
    buffer_load_dwordx4 v[136:139], v4, s[36:39], s94 offen offset:3072 sc1
    v_mfma_f32_16x16x32_bf16 v[44:47], a[64:67], v[208:211], v[44:47]
    v_mfma_f32_16x16x32_bf16 v[48:51], a[68:71], v[208:211], v[48:51]
    v_mfma_f32_16x16x32_bf16 v[52:55], a[72:75], v[208:211], v[52:55]
    global_load_dwordx2 v[72:73], v10, s[60:61] offset:32
    v_mfma_f32_16x16x32_bf16 v[56:59], a[76:79], v[208:211], v[56:59]
    v_mfma_f32_16x16x32_bf16 v[40:43], a[80:83], v[212:215], v[40:43]
    buffer_load_dwordx4 v[140:143], v2, s[36:39], s95 offen offset:0 sc1
    v_mfma_f32_16x16x32_bf16 v[44:47], a[84:87], v[212:215], v[44:47]
    v_mfma_f32_16x16x32_bf16 v[48:51], a[88:91], v[212:215], v[48:51]
    s_cmp_eq_u32 s2, 0
    s_cselect_b32 s84, s5, 0
    s_cselect_b32 s85, 0, 2147483648
    v_mfma_f32_16x16x32_bf16 v[52:55], a[92:95], v[212:215], v[52:55]
    s_lshl_b32 s80, s4, 6
    v_add_u32 v15, s80, v1
    v_lshlrev_b32 v15, 6, v15
    v_add_u32 v15, 4096, v15
    v_or_b32 v15, s85, v15
    v_mfma_f32_16x16x32_bf16 v[56:59], a[96:99], v[212:215], v[56:59]
    buffer_load_dword v18, v15, s[36:39], 0 offen sc1
    v_mfma_f32_16x16x32_bf16 v[40:43], a[100:103], v[216:219], v[40:43]
    buffer_load_dwordx4 v[144:147], v2, s[36:39], s95 offen offset:1024 sc1
    v_mfma_f32_16x16x32_bf16 v[44:47], a[104:107], v[216:219], v[44:47]
    v_mfma_f32_16x16x32_bf16 v[48:51], a[108:111], v[216:219], v[48:51]
    v_mfma_f32_16x16x32_bf16 v[52:55], a[112:115], v[216:219], v[52:55]
    global_load_dwordx2 v[74:75], v10, s[60:61] offset:64
    v_mfma_f32_16x16x32_bf16 v[56:59], a[116:119], v[216:219], v[56:59]
    v_mfma_f32_16x16x32_bf16 v[40:43], a[120:123], v[220:223], v[40:43]
    buffer_load_dwordx4 v[148:151], v2, s[36:39], s95 offen offset:2048 sc1
    v_mfma_f32_16x16x32_bf16 v[44:47], a[124:127], v[220:223], v[44:47]
    v_mfma_f32_16x16x32_bf16 v[48:51], a[128:131], v[220:223], v[48:51]
    v_mfma_f32_16x16x32_bf16 v[52:55], a[132:135], v[220:223], v[52:55]
    v_mfma_f32_16x16x32_bf16 v[56:59], a[136:139], v[220:223], v[56:59]
    v_mfma_f32_16x16x32_bf16 v[40:43], a[140:143], v[224:227], v[40:43]
    buffer_load_dwordx4 v[152:155], v2, s[36:39], s95 offen offset:3072 sc1
    v_mfma_f32_16x16x32_bf16 v[44:47], a[144:147], v[224:227], v[44:47]
    v_mfma_f32_16x16x32_bf16 v[48:51], a[148:151], v[224:227], v[48:51]
    v_mfma_f32_16x16x32_bf16 v[52:55], a[152:155], v[224:227], v[52:55]
    global_load_dwordx2 v[76:77], v10, s[60:61] offset:96
    v_mfma_f32_16x16x32_bf16 v[56:59], a[156:159], v[224:227], v[56:59]
    s_waitcnt vmcnt(30)
    v_mfma_f32_16x16x32_bf16 v[40:43], a[160:163], v[228:231], v[40:43]
    buffer_load_dwordx4 v[156:159], v3, s[36:39], s95 offen offset:0 sc1
    v_mfma_f32_16x16x32_bf16 v[44:47], a[164:167], v[228:231], v[44:47]
    v_mfma_f32_16x16x32_bf16 v[48:51], a[168:171], v[228:231], v[48:51]
    v_mfma_f32_16x16x32_bf16 v[52:55], a[172:175], v[228:231], v[52:55]
    v_mfma_f32_16x16x32_bf16 v[56:59], a[176:179], v[228:231], v[56:59]
    s_waitcnt vmcnt(30)
    v_mfma_f32_16x16x32_bf16 v[40:43], a[180:183], v[232:235], v[40:43]
    buffer_load_dwordx4 v[160:163], v3, s[36:39], s95 offen offset:1024 sc1
    v_mfma_f32_16x16x32_bf16 v[44:47], a[184:187], v[232:235], v[44:47]
    v_mfma_f32_16x16x32_bf16 v[48:51], a[188:191], v[232:235], v[48:51]
    v_mfma_f32_16x16x32_bf16 v[52:55], a[192:195], v[232:235], v[52:55]
    global_load_dwordx2 v[78:79], v10, s[60:61] offset:128
    v_mfma_f32_16x16x32_bf16 v[56:59], a[196:199], v[232:235], v[56:59]
    s_waitcnt vmcnt(31)
    v_mfma_f32_16x16x32_bf16 v[40:43], a[200:203], v[236:239], v[40:43]
    buffer_load_dwordx4 v[164:167], v3, s[36:39], s95 offen offset:2048 sc1
    v_mfma_f32_16x16x32_bf16 v[44:47], a[204:207], v[236:239], v[44:47]
    v_mfma_f32_16x16x32_bf16 v[48:51], a[208:211], v[236:239], v[48:51]
    s_mul_i32 s80, s71, 20
    v_mfma_f32_16x16x32_bf16 v[52:55], a[212:215], v[236:239], v[52:55]
    v_min_u32 v13, 19, v1
    v_add_u32 v13, s80, v13
    v_lshlrev_b32 v13, 6, v13
    v_add_u32 v13, 36864, v13
    v_mfma_f32_16x16x32_bf16 v[56:59], a[216:219], v[236:239], v[56:59]
    buffer_load_dword v14, v13, s[36:39], 0 offen sc1
    s_waitcnt vmcnt(32)
    v_mfma_f32_16x16x32_bf16 v[40:43], a[220:223], v[240:243], v[40:43]
    buffer_load_dwordx4 v[168:171], v3, s[36:39], s95 offen offset:3072 sc1
    v_mfma_f32_16x16x32_bf16 v[44:47], a[224:227], v[240:243], v[44:47]
    v_mfma_f32_16x16x32_bf16 v[48:51], a[228:231], v[240:243], v[48:51]
    v_mfma_f32_16x16x32_bf16 v[52:55], a[232:235], v[240:243], v[52:55]
    v_lshlrev_b32 v12, 3, v9
    v_add_u32 v12, 65536, v12
    buffer_load_dwordx2 v[80:81], v12, s[36:39], 0 offen sc1
    v_mfma_f32_16x16x32_bf16 v[56:59], a[236:239], v[240:243], v[56:59]
    s_waitcnt vmcnt(32)
    v_mfma_f32_16x16x32_bf16 v[20:23], a[0:3], v[244:247], 0
    buffer_load_dwordx4 v[172:175], v4, s[36:39], s95 offen offset:0 sc1
    v_mfma_f32_16x16x32_bf16 v[24:27], a[4:7], v[244:247], 0
    v_mfma_f32_16x16x32_bf16 v[28:31], a[8:11], v[244:247], 0
    v_mfma_f32_16x16x32_bf16 v[32:35], a[12:15], v[244:247], 0
    v_mfma_f32_16x16x32_bf16 v[36:39], a[16:19], v[244:247], 0
    s_waitcnt vmcnt(13)
    v_cmp_ne_u32 vcc, s84, v18
    s_nop 0
    s_cbranch_vccnz LA_slowtk5
LA_backtk6:
    v_mfma_f32_16x16x32_bf16 v[20:23], a[20:23], v[248:251], v[20:23]
    buffer_load_dwordx4 v[176:179], v4, s[36:39], s95 offen offset:1024 sc1
    v_mfma_f32_16x16x32_bf16 v[24:27], a[24:27], v[248:251], v[24:27]
    v_mfma_f32_16x16x32_bf16 v[28:31], a[28:31], v[248:251], v[28:31]
    v_mfma_f32_16x16x32_bf16 v[32:35], a[32:35], v[248:251], v[32:35]
    ds_write_b128 v6, v[40:43] offset:0
    ds_write_b128 v6, v[44:47] offset:1024
    v_mfma_f32_16x16x32_bf16 v[36:39], a[36:39], v[248:251], v[36:39]
    ds_write_b128 v6, v[48:51] offset:2048
    ds_write_b128 v6, v[52:55] offset:3072
    ds_write_b128 v6, v[56:59] offset:4096
    v_mfma_f32_16x16x32_bf16 v[20:23], a[40:43], v[252:255], v[20:23]
    buffer_load_dwordx4 v[180:183], v4, s[36:39], s95 offen offset:2048 sc1
    v_mfma_f32_16x16x32_bf16 v[24:27], a[44:47], v[252:255], v[24:27]
    v_mfma_f32_16x16x32_bf16 v[28:31], a[48:51], v[252:255], v[28:31]
    v_mfma_f32_16x16x32_bf16 v[32:35], a[52:55], v[252:255], v[32:35]
    v_mfma_f32_16x16x32_bf16 v[36:39], a[56:59], v[252:255], v[36:39]
    v_mfma_f32_16x16x32_bf16 v[20:23], a[60:63], v[104:107], v[20:23]
    buffer_load_dwordx4 v[184:187], v4, s[36:39], s95 offen offset:3072 sc1
    v_mfma_f32_16x16x32_bf16 v[24:27], a[64:67], v[104:107], v[24:27]
    v_mfma_f32_16x16x32_bf16 v[28:31], a[68:71], v[104:107], v[28:31]
    v_mfma_f32_16x16x32_bf16 v[32:35], a[72:75], v[104:107], v[32:35]
    v_mfma_f32_16x16x32_bf16 v[36:39], a[76:79], v[104:107], v[36:39]
    v_mfma_f32_16x16x32_bf16 v[20:23], a[80:83], v[108:111], v[20:23]
    v_mfma_f32_16x16x32_bf16 v[24:27], a[84:87], v[108:111], v[24:27]
    v_mfma_f32_16x16x32_bf16 v[28:31], a[88:91], v[108:111], v[28:31]
    v_mfma_f32_16x16x32_bf16 v[32:35], a[92:95], v[108:111], v[32:35]
    v_mfma_f32_16x16x32_bf16 v[36:39], a[96:99], v[108:111], v[36:39]
    v_mfma_f32_16x16x32_bf16 v[20:23], a[100:103], v[112:115], v[20:23]
    s_waitcnt vmcnt(6)
    v_cmp_ne_u32 vcc, s5, v14
    s_nop 0
    s_cbranch_vccnz LA_slowy7
LA_backy8:
    v_lshlrev_b32 v12, 11, v10
    v_lshl_add_u32 v12, v9, 1, v12
    v_mfma_f32_16x16x32_bf16 v[24:27], a[104:107], v[112:115], v[24:27]
    v_add_u32 v12, 4194304, v12
    s_mov_b32 s80, 0
    buffer_load_ushort v82, v12, s[36:39], s80 offen sc1
    v_mfma_f32_16x16x32_bf16 v[28:31], a[108:111], v[112:115], v[28:31]
    s_mov_b32 s80, 4096
    buffer_load_ushort v83, v12, s[36:39], s80 offen sc1
    v_mfma_f32_16x16x32_bf16 v[32:35], a[112:115], v[112:115], v[32:35]
    s_mov_b32 s80, 8192
    v_mfma_f32_16x16x32_bf16 v[36:39], a[116:119], v[112:115], v[36:39]
    buffer_load_ushort v84, v12, s[36:39], s80 offen sc1
    v_mfma_f32_16x16x32_bf16 v[20:23], a[120:123], v[116:119], v[20:23]
    s_mov_b32 s80, 12288
    buffer_load_ushort v85, v12, s[36:39], s80 offen sc1
    v_mfma_f32_16x16x32_bf16 v[24:27], a[124:127], v[116:119], v[24:27]
    s_mov_b32 s80, 65536
    buffer_load_ushort v86, v12, s[36:39], s80 offen sc1
    v_mfma_f32_16x16x32_bf16 v[28:31], a[128:131], v[116:119], v[28:31]
    v_mfma_f32_16x16x32_bf16 v[32:35], a[132:135], v[116:119], v[32:35]
    s_mov_b32 s80, 69632
    buffer_load_ushort v87, v12, s[36:39], s80 offen sc1
    v_mfma_f32_16x16x32_bf16 v[36:39], a[136:139], v[116:119], v[36:39]
    s_mov_b32 s80, 73728
    v_mfma_f32_16x16x32_bf16 v[20:23], a[140:143], v[120:123], v[20:23]
    buffer_load_ushort v88, v12, s[36:39], s80 offen sc1
    v_mfma_f32_16x16x32_bf16 v[24:27], a[144:147], v[120:123], v[24:27]
    s_mov_b32 s80, 77824
    buffer_load_ushort v89, v12, s[36:39], s80 offen sc1
    v_mfma_f32_16x16x32_bf16 v[28:31], a[148:151], v[120:123], v[28:31]
    s_mov_b32 s80, 131072
    buffer_load_ushort v90, v12, s[36:39], s80 offen sc1
    v_mfma_f32_16x16x32_bf16 v[32:35], a[152:155], v[120:123], v[32:35]
    s_mov_b32 s80, 135168
    buffer_load_ushort v91, v12, s[36:39], s80 offen sc1
    v_mfma_f32_16x16x32_bf16 v[36:39], a[156:159], v[120:123], v[36:39]
    v_mfma_f32_16x16x32_bf16 v[20:23], a[160:163], v[124:127], v[20:23]
    s_mov_b32 s80, 139264
    buffer_load_ushort v92, v12, s[36:39], s80 offen sc1
    v_mfma_f32_16x16x32_bf16 v[24:27], a[164:167], v[124:127], v[24:27]
    s_mov_b32 s80, 143360
    buffer_load_ushort v93, v12, s[36:39], s80 offen sc1
    v_mfma_f32_16x16x32_bf16 v[28:31], a[168:171], v[124:127], v[28:31]
    v_mfma_f32_16x16x32_bf16 v[32:35], a[172:175], v[124:127], v[32:35]
    s_mov_b32 s80, 196608
    buffer_load_ushort v94, v12, s[36:39], s80 offen sc1
    v_mfma_f32_16x16x32_bf16 v[36:39], a[176:179], v[124:127], v[36:39]
    s_mov_b32 s80, 200704
    v_mfma_f32_16x16x32_bf16 v[20:23], a[180:183], v[128:131], v[20:23]
    buffer_load_ushort v95, v12, s[36:39], s80 offen sc1
    v_mfma_f32_16x16x32_bf16 v[24:27], a[184:187], v[128:131], v[24:27]
    s_mov_b32 s80, 204800
    buffer_load_ushort v96, v12, s[36:39], s80 offen sc1
    v_mfma_f32_16x16x32_bf16 v[28:31], a[188:191], v[128:131], v[28:31]
    s_mov_b32 s80, 208896
    buffer_load_ushort v97, v12, s[36:39], s80 offen sc1
    v_mfma_f32_16x16x32_bf16 v[32:35], a[192:195], v[128:131], v[32:35]
    s_mov_b32 s80, 262144
    buffer_load_ushort v98, v12, s[36:39], s80 offen sc1
    v_mfma_f32_16x16x32_bf16 v[36:39], a[196:199], v[128:131], v[36:39]
    v_mfma_f32_16x16x32_bf16 v[20:23], a[200:203], v[132:135], v[20:23]
    s_mov_b32 s80, 266240
    buffer_load_ushort v99, v12, s[36:39], s80 offen sc1
    v_mfma_f32_16x16x32_bf16 v[24:27], a[204:207], v[132:135], v[24:27]
    s_mov_b32 s80, 270336
    v_mfma_f32_16x16x32_bf16 v[28:31], a[208:211], v[132:135], v[28:31]
    buffer_load_ushort v100, v12, s[36:39], s80 offen sc1
    v_mfma_f32_16x16x32_bf16 v[32:35], a[212:215], v[132:135], v[32:35]
    s_mov_b32 s80, 274432
    buffer_load_ushort v101, v12, s[36:39], s80 offen sc1
    v_mfma_f32_16x16x32_bf16 v[36:39], a[216:219], v[132:135], v[36:39]
    v_mfma_f32_16x16x32_bf16 v[20:23], a[220:223], v[136:139], v[20:23]
    v_mfma_f32_16x16x32_bf16 v[24:27], a[224:227], v[136:139], v[24:27]
    v_mfma_f32_16x16x32_bf16 v[28:31], a[228:231], v[136:139], v[28:31]
    v_mfma_f32_16x16x32_bf16 v[32:35], a[232:235], v[136:139], v[32:35]
    v_mfma_f32_16x16x32_bf16 v[36:39], a[236:239], v[136:139], v[36:39]
    v_mfma_f32_16x16x32_bf16 v[40:43], a[0:3], v[140:143], 0
    s_nop 2
    ds_write_b128 v7, v[20:23] offset:0
    ds_write_b128 v7, v[24:27] offset:1024
    v_mfma_f32_16x16x32_bf16 v[40:43], a[20:23], v[144:147], v[40:43]
    ds_write_b128 v7, v[28:31] offset:2048
    v_mfma_f32_16x16x32_bf16 v[40:43], a[40:43], v[148:151], v[40:43]
    ds_write_b128 v7, v[32:35] offset:3072
    v_mfma_f32_16x16x32_bf16 v[40:43], a[60:63], v[152:155], v[40:43]
    ds_write_b128 v7, v[36:39] offset:4096
    s_waitcnt lgkmcnt(0)
    s_barrier
    v_mfma_f32_16x16x32_bf16 v[40:43], a[80:83], v[156:159], v[40:43]
    ds_read_b128 v[188:191], v8 offset:0
    v_mfma_f32_16x16x32_bf16 v[40:43], a[100:103], v[160:163], v[40:43]
    ds_read_b128 v[192:195], v8 offset:1024
    v_mfma_f32_16x16x32_bf16 v[40:43], a[120:123], v[164:167], v[40:43]
    ds_read_b128 v[208:211], v8 offset:5120
    ds_read_b128 v[212:215], v8 offset:6144
    s_waitcnt vmcnt(25)
    v_mfma_f32_16x16x32_bf16 v[40:43], a[140:143], v[168:171], v[40:43]
    ds_read_b128 v[228:231], v8 offset:10240
    s_waitcnt vmcnt(23)
    v_mfma_f32_16x16x32_bf16 v[40:43], a[160:163], v[172:175], v[40:43]
    ds_read_b128 v[232:235], v8 offset:11264
    s_waitcnt vmcnt(22)
    v_mfma_f32_16x16x32_bf16 v[40:43], a[180:183], v[176:179], v[40:43]
    v_rcp_f32 v124, v81
    s_nop 0
    v_mul_f32 v125, v80, v124
    s_waitcnt vmcnt(21)
    v_mfma_f32_16x16x32_bf16 v[40:43], a[200:203], v[180:183], v[40:43]
    v_xor_b32 v125, 0x80000000, v125
    s_waitcnt vmcnt(20)
    v_mfma_f32_16x16x32_bf16 v[40:43], a[220:223], v[184:187], v[40:43]
    s_mov_b32 s80, 0xbfb8aa3b
    v_mfma_f32_16x16x32_bf16 v[44:47], a[4:7], v[140:143], 0
    ds_read_b128 v[196:199], v8 offset:2048
    ds_read_b128 v[216:219], v8 offset:7168
    ds_read_b128 v[236:239], v8 offset:12288
    v_lshlrev_b32 v128, 16, v70
    v_and_b32 v129, 0xffff0000, v70
    s_waitcnt lgkmcnt(6)
    v_add_f32 v188, v188, v208
    v_mfma_f32_16x16x32_bf16 v[44:47], a[24:27], v[144:147], v[44:47]
    v_add_f32 v189, v189, v209
    s_waitcnt lgkmcnt(4)
    v_add_f32 v128, v128, v228
    v_add_f32 v129, v129, v229
    v_add_f32 v188, v188, v128
    v_add_f32 v189, v189, v129
    v_lshlrev_b32 v128, 16, v71
    v_mfma_f32_16x16x32_bf16 v[44:47], a[44:47], v[148:151], v[44:47]
    v_and_b32 v129, 0xffff0000, v71
    v_add_f32 v190, v190, v210
    v_add_f32 v191, v191, v211
    v_add_f32 v128, v128, v230
    v_add_f32 v129, v129, v231
    v_add_f32 v190, v190, v128
    v_mfma_f32_16x16x32_bf16 v[44:47], a[64:67], v[152:155], v[44:47]
    v_add_f32 v191, v191, v129
    v_lshlrev_b32 v104, 16, v60
    v_and_b32 v105, 0xffff0000, v60
    s_waitcnt vmcnt(19)
    v_lshlrev_b32 v82, 16, v82
    s_waitcnt vmcnt(18)
    v_lshlrev_b32 v83, 16, v83
    v_mfma_f32_16x16x32_bf16 v[44:47], a[84:87], v[156:159], v[44:47]
    v_fma_f32 v126, v104, v124, v125
    v_fma_f32 v127, v105, v124, v125
    v_mul_f32 v82, v82, v126
    v_mul_f32 v83, v83, v127
    v_lshlrev_b32 v106, 16, v61
    v_and_b32 v107, 0xffff0000, v61
    v_mfma_f32_16x16x32_bf16 v[44:47], a[104:107], v[160:163], v[44:47]
    s_waitcnt vmcnt(17)
    v_lshlrev_b32 v84, 16, v84
    s_waitcnt vmcnt(16)
    v_lshlrev_b32 v85, 16, v85
    v_fma_f32 v126, v106, v124, v125
    v_fma_f32 v127, v107, v124, v125
    v_mul_f32 v84, v84, v126
    v_mul_f32 v85, v85, v127
    v_mfma_f32_16x16x32_bf16 v[44:47], a[124:127], v[164:167], v[44:47]
    v_add_f32 v40, v40, v188
    v_add_f32 v41, v41, v189
    v_mul_f32 v130, s80, v40
    v_mul_f32 v131, s80, v41
    v_exp_f32 v130, v130
    v_exp_f32 v131, v131
    v_mfma_f32_16x16x32_bf16 v[44:47], a[144:147], v[168:171], v[44:47]
    v_add_f32 v130, 1.0, v130
    v_add_f32 v131, 1.0, v131
    v_rcp_f32 v130, v130
    v_rcp_f32 v131, v131
    v_mul_f32 v130, v130, v40
    v_mfma_f32_16x16x32_bf16 v[44:47], a[164:167], v[172:175], v[44:47]
    v_mul_f32 v131, v131, v41
    v_fma_f32 v130, v130, v82, v104
    v_fma_f32 v131, v131, v83, v105
    v_cvt_pk_bf16_f32 v60, v130, v131
    v_add_f32 v42, v42, v190
    v_add_f32 v43, v43, v191
    v_mfma_f32_16x16x32_bf16 v[44:47], a[184:187], v[176:179], v[44:47]
    v_mul_f32 v132, s80, v42
    v_mul_f32 v133, s80, v43
    v_exp_f32 v132, v132
    v_exp_f32 v133, v133
    v_add_f32 v132, 1.0, v132
    v_add_f32 v133, 1.0, v133
    v_mfma_f32_16x16x32_bf16 v[44:47], a[204:207], v[180:183], v[44:47]
    v_rcp_f32 v132, v132
    v_rcp_f32 v133, v133
    v_mul_f32 v132, v132, v42
    v_mul_f32 v133, v133, v43
    v_fma_f32 v132, v132, v84, v106
    v_fma_f32 v133, v133, v85, v107
    v_mfma_f32_16x16x32_bf16 v[44:47], a[224:227], v[184:187], v[44:47]
    v_cvt_pk_bf16_f32 v61, v132, v133
    buffer_store_dwordx2 v[60:61], v11, s[32:35], 0 offen offset:0
    v_mfma_f32_16x16x32_bf16 v[48:51], a[8:11], v[140:143], 0
    ds_read_b128 v[200:203], v8 offset:3072
    ds_read_b128 v[220:223], v8 offset:8192
    ds_read_b128 v[240:243], v8 offset:13312
    v_lshlrev_b32 v128, 16, v72
    v_and_b32 v129, 0xffff0000, v72
    v_add_f32 v192, v192, v212
    v_mfma_f32_16x16x32_bf16 v[48:51], a[28:31], v[144:147], v[48:51]
    v_add_f32 v193, v193, v213
    s_waitcnt lgkmcnt(6)
    v_add_f32 v128, v128, v232
    v_add_f32 v129, v129, v233
    v_add_f32 v192, v192, v128
    v_add_f32 v193, v193, v129
    v_lshlrev_b32 v128, 16, v73
    v_mfma_f32_16x16x32_bf16 v[48:51], a[48:51], v[148:151], v[48:51]
    v_and_b32 v129, 0xffff0000, v73
    v_add_f32 v194, v194, v214
    v_add_f32 v195, v195, v215
    v_add_f32 v128, v128, v234
    v_add_f32 v129, v129, v235
    v_add_f32 v194, v194, v128
    v_mfma_f32_16x16x32_bf16 v[48:51], a[68:71], v[152:155], v[48:51]
    v_add_f32 v195, v195, v129
    v_lshlrev_b32 v108, 16, v62
    v_and_b32 v109, 0xffff0000, v62
    s_waitcnt vmcnt(16)
    v_lshlrev_b32 v86, 16, v86
    s_waitcnt vmcnt(15)
    v_lshlrev_b32 v87, 16, v87
    v_mfma_f32_16x16x32_bf16 v[48:51], a[88:91], v[156:159], v[48:51]
    v_fma_f32 v126, v108, v124, v125
    v_fma_f32 v127, v109, v124, v125
    v_mul_f32 v86, v86, v126
    v_mul_f32 v87, v87, v127
    v_lshlrev_b32 v110, 16, v63
    v_and_b32 v111, 0xffff0000, v63
    v_mfma_f32_16x16x32_bf16 v[48:51], a[108:111], v[160:163], v[48:51]
    s_waitcnt vmcnt(14)
    v_lshlrev_b32 v88, 16, v88
    s_waitcnt vmcnt(13)
    v_lshlrev_b32 v89, 16, v89
    v_fma_f32 v126, v110, v124, v125
    v_fma_f32 v127, v111, v124, v125
    v_mul_f32 v88, v88, v126
    v_mul_f32 v89, v89, v127
    v_mfma_f32_16x16x32_bf16 v[48:51], a[128:131], v[164:167], v[48:51]
    v_add_f32 v44, v44, v192
    v_add_f32 v45, v45, v193
    v_mul_f32 v130, s80, v44
    v_mul_f32 v131, s80, v45
    v_exp_f32 v130, v130
    v_exp_f32 v131, v131
    v_mfma_f32_16x16x32_bf16 v[48:51], a[148:151], v[168:171], v[48:51]
    v_add_f32 v130, 1.0, v130
    v_add_f32 v131, 1.0, v131
    v_rcp_f32 v130, v130
    v_rcp_f32 v131, v131
    v_mul_f32 v130, v130, v44
    v_mfma_f32_16x16x32_bf16 v[48:51], a[168:171], v[172:175], v[48:51]
    v_mul_f32 v131, v131, v45
    v_fma_f32 v130, v130, v86, v108
    v_fma_f32 v131, v131, v87, v109
    v_cvt_pk_bf16_f32 v62, v130, v131
    v_add_f32 v46, v46, v194
    v_add_f32 v47, v47, v195
    v_mfma_f32_16x16x32_bf16 v[48:51], a[188:191], v[176:179], v[48:51]
    v_mul_f32 v132, s80, v46
    v_mul_f32 v133, s80, v47
    v_exp_f32 v132, v132
    v_exp_f32 v133, v133
    v_add_f32 v132, 1.0, v132
    v_add_f32 v133, 1.0, v133
    v_mfma_f32_16x16x32_bf16 v[48:51], a[208:211], v[180:183], v[48:51]
    v_rcp_f32 v132, v132
    v_rcp_f32 v133, v133
    v_mul_f32 v132, v132, v46
    v_mul_f32 v133, v133, v47
    v_fma_f32 v132, v132, v88, v110
    v_fma_f32 v133, v133, v89, v111
    v_mfma_f32_16x16x32_bf16 v[48:51], a[228:231], v[184:187], v[48:51]
    v_cvt_pk_bf16_f32 v63, v132, v133
    buffer_store_dwordx2 v[62:63], v11, s[32:35], 0 offen offset:32
    v_mfma_f32_16x16x32_bf16 v[52:55], a[12:15], v[140:143], 0
    ds_read_b128 v[204:207], v8 offset:4096
    ds_read_b128 v[224:227], v8 offset:9216
    ds_read_b128 v[244:247], v8 offset:14336
    v_lshlrev_b32 v128, 16, v74
    v_and_b32 v129, 0xffff0000, v74
    s_waitcnt lgkmcnt(7)
    v_add_f32 v196, v196, v216
    v_mfma_f32_16x16x32_bf16 v[52:55], a[32:35], v[144:147], v[52:55]
    v_add_f32 v197, v197, v217
    s_waitcnt lgkmcnt(6)
    v_add_f32 v128, v128, v236
    v_add_f32 v129, v129, v237
    v_add_f32 v196, v196, v128
    v_add_f32 v197, v197, v129
    v_lshlrev_b32 v128, 16, v75
    v_mfma_f32_16x16x32_bf16 v[52:55], a[52:55], v[148:151], v[52:55]
    v_and_b32 v129, 0xffff0000, v75
    v_add_f32 v198, v198, v218
    v_add_f32 v199, v199, v219
    v_add_f32 v128, v128, v238
    v_add_f32 v129, v129, v239
    v_add_f32 v198, v198, v128
    v_mfma_f32_16x16x32_bf16 v[52:55], a[72:75], v[152:155], v[52:55]
    v_add_f32 v199, v199, v129
    v_lshlrev_b32 v112, 16, v64
    v_and_b32 v113, 0xffff0000, v64
    s_waitcnt vmcnt(13)
    v_lshlrev_b32 v90, 16, v90
    s_waitcnt vmcnt(12)
    v_lshlrev_b32 v91, 16, v91
    v_mfma_f32_16x16x32_bf16 v[52:55], a[92:95], v[156:159], v[52:55]
    v_fma_f32 v126, v112, v124, v125
    v_fma_f32 v127, v113, v124, v125
    v_mul_f32 v90, v90, v126
    v_mul_f32 v91, v91, v127
    v_lshlrev_b32 v114, 16, v65
    v_and_b32 v115, 0xffff0000, v65
    v_mfma_f32_16x16x32_bf16 v[52:55], a[112:115], v[160:163], v[52:55]
    s_waitcnt vmcnt(11)
    v_lshlrev_b32 v92, 16, v92
    s_waitcnt vmcnt(10)
    v_lshlrev_b32 v93, 16, v93
    v_fma_f32 v126, v114, v124, v125
    v_fma_f32 v127, v115, v124, v125
    v_mul_f32 v92, v92, v126
    v_mul_f32 v93, v93, v127
    v_mfma_f32_16x16x32_bf16 v[52:55], a[132:135], v[164:167], v[52:55]
    v_add_f32 v48, v48, v196
    v_add_f32 v49, v49, v197
    v_mul_f32 v130, s80, v48
    v_mul_f32 v131, s80, v49
    v_exp_f32 v130, v130
    v_exp_f32 v131, v131
    v_mfma_f32_16x16x32_bf16 v[52:55], a[152:155], v[168:171], v[52:55]
    v_add_f32 v130, 1.0, v130
    v_add_f32 v131, 1.0, v131
    v_rcp_f32 v130, v130
    v_rcp_f32 v131, v131
    v_mul_f32 v130, v130, v48
    v_mfma_f32_16x16x32_bf16 v[52:55], a[172:175], v[172:175], v[52:55]
    v_mul_f32 v131, v131, v49
    v_fma_f32 v130, v130, v90, v112
    v_fma_f32 v131, v131, v91, v113
    v_cvt_pk_bf16_f32 v64, v130, v131
    v_add_f32 v50, v50, v198
    v_add_f32 v51, v51, v199
    v_mfma_f32_16x16x32_bf16 v[52:55], a[192:195], v[176:179], v[52:55]
    v_mul_f32 v132, s80, v50
    v_mul_f32 v133, s80, v51
    v_exp_f32 v132, v132
    v_exp_f32 v133, v133
    v_add_f32 v132, 1.0, v132
    v_add_f32 v133, 1.0, v133
    v_mfma_f32_16x16x32_bf16 v[52:55], a[212:215], v[180:183], v[52:55]
    v_rcp_f32 v132, v132
    v_rcp_f32 v133, v133
    v_mul_f32 v132, v132, v50
    v_mul_f32 v133, v133, v51
    v_fma_f32 v132, v132, v92, v114
    v_fma_f32 v133, v133, v93, v115
    v_mfma_f32_16x16x32_bf16 v[52:55], a[232:235], v[184:187], v[52:55]
    v_cvt_pk_bf16_f32 v65, v132, v133
    buffer_store_dwordx2 v[64:65], v11, s[32:35], 0 offen offset:64
    v_mfma_f32_16x16x32_bf16 v[56:59], a[16:19], v[140:143], 0
    v_lshlrev_b32 v128, 16, v76
    v_and_b32 v129, 0xffff0000, v76
    s_waitcnt lgkmcnt(4)
    v_add_f32 v200, v200, v220
    v_add_f32 v201, v201, v221
    s_waitcnt lgkmcnt(3)
    v_add_f32 v128, v128, v240
    v_add_f32 v129, v129, v241
    v_mfma_f32_16x16x32_bf16 v[56:59], a[36:39], v[144:147], v[56:59]
    v_add_f32 v200, v200, v128
    v_add_f32 v201, v201, v129
    v_lshlrev_b32 v128, 16, v77
    v_and_b32 v129, 0xffff0000, v77
    v_add_f32 v202, v202, v222
    v_mfma_f32_16x16x32_bf16 v[56:59], a[56:59], v[148:151], v[56:59]
    v_add_f32 v203, v203, v223
    v_add_f32 v128, v128, v242
    v_add_f32 v129, v129, v243
    v_add_f32 v202, v202, v128
    v_add_f32 v203, v203, v129
    v_lshlrev_b32 v116, 16, v66
    v_mfma_f32_16x16x32_bf16 v[56:59], a[76:79], v[152:155], v[56:59]
    v_and_b32 v117, 0xffff0000, v66
    s_waitcnt vmcnt(10)
    v_lshlrev_b32 v94, 16, v94
    s_waitcnt vmcnt(9)
    v_lshlrev_b32 v95, 16, v95
    v_fma_f32 v126, v116, v124, v125
    v_fma_f32 v127, v117, v124, v125
    v_mfma_f32_16x16x32_bf16 v[56:59], a[96:99], v[156:159], v[56:59]
    v_mul_f32 v94, v94, v126
    v_mul_f32 v95, v95, v127
    v_lshlrev_b32 v118, 16, v67
    v_and_b32 v119, 0xffff0000, v67
    s_waitcnt vmcnt(8)
    v_lshlrev_b32 v96, 16, v96
    s_waitcnt vmcnt(7)
    v_lshlrev_b32 v97, 16, v97
    v_mfma_f32_16x16x32_bf16 v[56:59], a[116:119], v[160:163], v[56:59]
    v_fma_f32 v126, v118, v124, v125
    v_fma_f32 v127, v119, v124, v125
    v_mul_f32 v96, v96, v126
    v_mul_f32 v97, v97, v127
    v_add_f32 v52, v52, v200
    v_mfma_f32_16x16x32_bf16 v[56:59], a[136:139], v[164:167], v[56:59]
    v_add_f32 v53, v53, v201
    v_mul_f32 v130, s80, v52
    v_mul_f32 v131, s80, v53
    v_exp_f32 v130, v130
    v_exp_f32 v131, v131
    v_add_f32 v130, 1.0, v130
    v_mfma_f32_16x16x32_bf16 v[56:59], a[156:159], v[168:171], v[56:59]
    v_add_f32 v131, 1.0, v131
    v_rcp_f32 v130, v130
    v_rcp_f32 v131, v131
    v_mul_f32 v130, v130, v52
    v_mul_f32 v131, v131, v53
    v_mfma_f32_16x16x32_bf16 v[56:59], a[176:179], v[172:175], v[56:59]
    v_fma_f32 v130, v130, v94, v116
    v_fma_f32 v131, v131, v95, v117
    v_cvt_pk_bf16_f32 v66, v130, v131
    v_add_f32 v54, v54, v202
    v_add_f32 v55, v55, v203
    v_mul_f32 v132, s80, v54
    v_mfma_f32_16x16x32_bf16 v[56:59], a[196:199], v[176:179], v[56:59]
    v_mul_f32 v133, s80, v55
    v_exp_f32 v132, v132
    v_exp_f32 v133, v133
    v_add_f32 v132, 1.0, v132
    v_add_f32 v133, 1.0, v133
    v_mfma_f32_16x16x32_bf16 v[56:59], a[216:219], v[180:183], v[56:59]
    v_rcp_f32 v132, v132
    v_rcp_f32 v133, v133
    v_mul_f32 v132, v132, v54
    v_mul_f32 v133, v133, v55
    v_fma_f32 v132, v132, v96, v118
    v_fma_f32 v133, v133, v97, v119
    v_mfma_f32_16x16x32_bf16 v[56:59], a[236:239], v[184:187], v[56:59]
    v_cvt_pk_bf16_f32 v67, v132, v133
    buffer_store_dwordx2 v[66:67], v11, s[32:35], 0 offen offset:96
    v_lshlrev_b32 v128, 16, v78
    v_and_b32 v129, 0xffff0000, v78
    s_waitcnt lgkmcnt(1)
    v_add_f32 v204, v204, v224
    v_add_f32 v205, v205, v225
    s_waitcnt lgkmcnt(0)
    v_add_f32 v128, v128, v244
    v_add_f32 v129, v129, v245
    v_add_f32 v204, v204, v128
    v_add_f32 v205, v205, v129
    v_lshlrev_b32 v128, 16, v79
    v_and_b32 v129, 0xffff0000, v79
    v_add_f32 v206, v206, v226
    v_add_f32 v207, v207, v227
    v_add_f32 v128, v128, v246
    v_add_f32 v129, v129, v247
    v_add_f32 v206, v206, v128
    v_add_f32 v207, v207, v129
    v_lshlrev_b32 v120, 16, v68
    v_and_b32 v121, 0xffff0000, v68
    s_waitcnt vmcnt(7)
    v_lshlrev_b32 v98, 16, v98
    s_waitcnt vmcnt(6)
    v_lshlrev_b32 v99, 16, v99
    v_fma_f32 v126, v120, v124, v125
    v_fma_f32 v127, v121, v124, v125
    v_mul_f32 v98, v98, v126
    v_mul_f32 v99, v99, v127
    v_lshlrev_b32 v122, 16, v69
    v_and_b32 v123, 0xffff0000, v69
    s_waitcnt vmcnt(5)
    v_lshlrev_b32 v100, 16, v100
    s_waitcnt vmcnt(4)
    v_lshlrev_b32 v101, 16, v101
    v_fma_f32 v126, v122, v124, v125
    v_fma_f32 v127, v123, v124, v125
    v_mul_f32 v100, v100, v126
    v_mul_f32 v101, v101, v127
    v_add_f32 v56, v56, v204
    v_add_f32 v57, v57, v205
    v_mul_f32 v130, s80, v56
    v_mul_f32 v131, s80, v57
    v_exp_f32 v130, v130
    v_exp_f32 v131, v131
    v_add_f32 v130, 1.0, v130
    v_add_f32 v131, 1.0, v131
    v_rcp_f32 v130, v130
    v_rcp_f32 v131, v131
    v_mul_f32 v130, v130, v56
    v_mul_f32 v131, v131, v57
    v_fma_f32 v130, v130, v98, v120
    v_fma_f32 v131, v131, v99, v121
    v_cvt_pk_bf16_f32 v68, v130, v131
    v_add_f32 v58, v58, v206
    v_add_f32 v59, v59, v207
    v_mul_f32 v132, s80, v58
    v_mul_f32 v133, s80, v59
    v_exp_f32 v132, v132
    v_exp_f32 v133, v133
    v_add_f32 v132, 1.0, v132
    v_add_f32 v133, 1.0, v133
    v_rcp_f32 v132, v132
    v_rcp_f32 v133, v133
    v_mul_f32 v132, v132, v58
    v_mul_f32 v133, v133, v59
    v_fma_f32 v132, v132, v100, v122
    v_fma_f32 v133, v133, v101, v123
    v_cvt_pk_bf16_f32 v69, v132, v133
    buffer_store_dwordx2 v[68:69], v11, s[32:35], 0 offen offset:128
    v_mov_b32 v18, 2147483648
    v_mov_b32 v15, s85
    v_cmp_eq_u32 vcc, 0, v0
    s_nop 1
    v_cndmask_b32 v15, v18, v15, vcc
    v_mov_b32 v18, s5
    buffer_store_dword v18, v15, s[36:39], 0 offen sc1
    s_endpgm
LA_slowp1:
    s_mov_b32 s79, 0
LA_slowp1_l:
    s_sleep 1
    buffer_load_dword v127, v126, s[36:39], 0 offen sc1
    s_add_u32 s79, s79, 1
    s_cmp_gt_u32 s79, 0x8000
    s_cbranch_scc1 LA_slowp1_x
    s_waitcnt vmcnt(0)
    v_cmp_ne_u32 vcc, s5, v127
    s_nop 4
    s_cbranch_vccnz LA_slowp1_l
LA_slowp1_x:
    s_waitcnt vmcnt(0)
    s_nop 7
    s_branch LA_backp2
LA_slowg13:
    s_mov_b32 s79, 0
LA_slowg13_l:
    s_sleep 1
    buffer_load_dword v14, v13, s[36:39], 0 offen sc1
    s_add_u32 s79, s79, 1
    s_cmp_gt_u32 s79, 0x8000
    s_cbranch_scc1 LA_slowg13_x
    s_waitcnt vmcnt(0)
    v_cmp_ne_u32 vcc, s5, v14
    s_nop 4
    s_cbranch_vccnz LA_slowg13_l
LA_slowg13_x:
    s_waitcnt vmcnt(0)
    s_nop 7
    s_branch LA_backg14
LA_slowtk5:
    s_mov_b32 s79, 0
LA_slowtk5_l:
    s_sleep 1
    buffer_load_dword v18, v15, s[36:39], 0 offen sc1
    s_add_u32 s79, s79, 1
    s_cmp_gt_u32 s79, 0x8000
    s_cbranch_scc1 LA_slowtk5_x
    s_waitcnt vmcnt(0)
    v_cmp_ne_u32 vcc, s84, v18
    s_nop 4
    s_cbranch_vccnz LA_slowtk5_l
LA_slowtk5_x:
    s_waitcnt vmcnt(0)
    s_nop 7
    s_branch LA_backtk6
LA_slowy7:
    s_mov_b32 s79, 0
LA_slowy7_l:
    s_sleep 1
    buffer_load_dword v14, v13, s[36:39], 0 offen sc1
    s_add_u32 s79, s79, 1
    s_cmp_gt_u32 s79, 0x8000
    s_cbranch_scc1 LA_slowy7_x
    s_waitcnt vmcnt(0)
    v_cmp_ne_u32 vcc, s5, v14
    s_nop 4
    s_cbranch_vccnz LA_slowy7_l
LA_slowy7_x:
    s_waitcnt vmcnt(0)
    s_nop 7
    s_branch LA_backy8
Lend_A:
    s_endpgm
L_exit:
    s_endpgm
.p2align 6
L_roleB:
    s_getpc_b64 s[6:7]
Lpc_B:
    s_mov_b32 s8, Lend_B-Lpc_B-4
    v_and_b32 v3, 63, v0
    v_lshlrev_b32 v3, 7, v3
    v_lshrrev_b32 v4, 6, v0
    v_lshl_add_u32 v3, v4, 13, v3
    v_min_u32 v3, s8, v3
    global_load_dword a203, v3, s[6:7]
    s_load_dwordx16 s[40:55], s[0:1], 0
    s_load_dwordx8 s[56:63], s[0:1], 64
    s_load_dwordx4 s[64:67], s[0:1], 96
    v_and_b32 v1, 63, v0
    v_lshrrev_b32 v2, 6, v0
    s_and_b32 s80, s2, 7
    s_lshr_b32 s81, s2, 3
    v_readfirstlane_b32 s4, v2
    s_lshr_b32 s82, s80, 1
    s_lshl_b32 s82, s82, 2
    s_lshr_b32 s83, s81, 3
    s_add_u32 s68, s82, s83
    s_and_b32 s82, s80, 1
    s_lshl_b32 s82, s82, 3
    s_and_b32 s71, s81, 7
    s_add_u32 s69, s82, s71
    s_lshl_b32 s70, s80, 2
    s_add_u32 s70, s70, s83
    s_mov_b32 s86, 0x3f803f80
    s_waitcnt lgkmcnt(0)
    s_mov_b32 s12, s42
    s_mov_b32 s13, s43
    s_mov_b32 s14, 2621440
    s_mov_b32 s15, 0x20000
    s_mov_b32 s16, s44
    s_mov_b32 s17, s45
    s_mov_b32 s18, 2621440
    s_mov_b32 s19, 0x20000
    s_mov_b32 s28, s46
    s_mov_b32 s29, s47
    s_mov_b32 s30, 5120
    s_mov_b32 s31, 0x20000
    s_mov_b32 s8, s40
    s_mov_b32 s9, s41
    s_mov_b32 s10, 2621440
    s_mov_b32 s11, 0x20000
    s_mov_b32 s36, s66
    s_mov_b32 s37, s67
    s_mov_b32 s38, 20971520
    s_mov_b32 s39, 0x20000
    s_mov_b32 s20, s54
    s_mov_b32 s21, s55
    s_mov_b32 s22, 1966080
    s_mov_b32 s23, 0x20000
    s_mov_b32 s24, s58
    s_mov_b32 s25, s59
    s_mov_b32 s26, 1966080
    s_mov_b32 s27, 0x20000
    s_load_dword s87, s[66:67], 0
    v_lshrrev_b32 v20, 3, v1
    v_and_b32 v21, 7, v1
    v_lshrrev_b32 v22, 4, v1
    s_lshl_b32 s80, s4, 5
    v_add_u32 v20, s80, v20
    v_mul_u32_u24 v20, 1280, v20
    v_xor_b32 v23, v21, v22
    v_add_u32 v24, 4, v22
    v_xor_b32 v24, v21, v24
    v_lshl_add_u32 v2, v23, 4, v20
    v_lshl_add_u32 v24, v24, 4, v20
    v_add_u32 v3, 9216, v24
    v_add_u32 v4, 18432, v2
    v_add_u32 v5, 27648, v24
    s_mul_i32 s73, s68, 163840
    s_lshl_b32 s75, s4, 12
    s_mul_i32 s74, s69, 192
    s_mul_i32 s76, s4, 3072
    s_add_u32 s76, s76, 65536
    s_mul_i32 s80, s4, 192
    s_mov_b32 s81, 0x15555556
    v_add_u32 v20, s80, v1
    v_add_u32 v20, 0, v20
    v_mul_hi_u32 v21, v20, s81
    v_mul_u32_u24 v22, 12, v21
    v_sub_u32 v22, v20, v22
    v_mul_u32_u24 v21, 3072, v21
    v_lshl_add_u32 v21, v22, 4, v21
    v_subrev_u32 v6, 0, v21
    v_add_u32 v20, s80, v1
    v_add_u32 v20, 64, v20
    v_mul_hi_u32 v21, v20, s81
    v_mul_u32_u24 v22, 12, v21
    v_sub_u32 v22, v20, v22
    v_mul_u32_u24 v21, 3072, v21
    v_lshl_add_u32 v21, v22, 4, v21
    v_subrev_u32 v7, 1024, v21
    v_add_u32 v20, s80, v1
    v_add_u32 v20, 128, v20
    v_mul_hi_u32 v21, v20, s81
    v_mul_u32_u24 v22, 12, v21
    v_sub_u32 v22, v20, v22
    v_mul_u32_u24 v21, 3072, v21
    v_lshl_add_u32 v21, v22, 4, v21
    v_subrev_u32 v8, 2048, v21
    s_add_u32 m0, s75, 0
    s_nop 0
    buffer_load_dwordx4 v2, s[8:11], s73 offen offset:0 lds
    buffer_load_dwordx4 v3, s[8:11], s73 offen offset:1024 lds
    buffer_load_dwordx4 v4, s[8:11], s73 offen offset:2048 lds
    buffer_load_dwordx4 v5, s[8:11], s73 offen offset:3072 lds
    s_add_u32 s73, s73, 128
    s_add_u32 m0, s76, 0
    s_nop 0
    buffer_load_dwordx4 v6, s[20:23], s74 offen offset:0 lds
    buffer_load_dwordx4 v7, s[20:23], s74 offen offset:1024 lds
    buffer_load_dwordx4 v8, s[20:23], s74 offen offset:2048 lds
    s_add_u32 s74, s74, 196608
    s_lshl_b32 s80, s70, 6
    s_sub_u32 s81, s80, 3
    s_mul_i32 s81, s81, 1280
    s_mul_i32 s80, s80, 1280
    s_mul_i32 s82, s71, 160
    s_mov_b32 s83, 0x1999999a
    s_lshl_b32 s84, s4, 6
    s_lshl_b32 s85, s4, 10
    v_add_u32 v204, s84, v1
    v_add_u32 v204, 0, v204
    v_mul_hi_u32 v205, v204, s83
    v_mul_u32_u24 v206, 10, v205
    v_sub_u32 v206, v204, v206
    v_mul_u32_u24 v205, 1280, v205
    v_lshl_add_u32 v205, v206, 4, v205
    v_add_u32 v205, s82, v205
    v_add_u32 v207, s81, v205
    v_add_u32 v208, s80, v205
    v_mov_b32 v209, 2147483648
    v_cmp_gt_u32 vcc, 670, v204
    s_nop 1
    v_cndmask_b32 v207, v209, v207, vcc
    v_cmp_gt_u32 vcc, 640, v204
    s_nop 1
    v_cndmask_b32 v208, v209, v208, vcc
    s_add_u32 m0, s85, 114688
    s_nop 0
    buffer_load_dwordx4 v207, s[12:15], 0 offen nt lds
    s_add_u32 m0, s85, 126976
    s_nop 0
    buffer_load_dwordx4 v208, s[16:19], 0 offen nt lds
    v_add_u32 v204, s84, v1
    v_add_u32 v204, 256, v204
    v_mul_hi_u32 v205, v204, s83
    v_mul_u32_u24 v206, 10, v205
    v_sub_u32 v206, v204, v206
    v_mul_u32_u24 v205, 1280, v205
    v_lshl_add_u32 v205, v206, 4, v205
    v_add_u32 v205, s82, v205
    v_add_u32 v207, s81, v205
    v_add_u32 v208, s80, v205
    v_mov_b32 v209, 2147483648
    v_cmp_gt_u32 vcc, 670, v204
    s_nop 1
    v_cndmask_b32 v207, v209, v207, vcc
    v_cmp_gt_u32 vcc, 640, v204
    s_nop 1
    v_cndmask_b32 v208, v209, v208, vcc
    s_add_u32 m0, s85, 118784
    s_nop 0
    buffer_load_dwordx4 v207, s[12:15], 0 offen nt lds
    s_add_u32 m0, s85, 131072
    s_nop 0
    buffer_load_dwordx4 v208, s[16:19], 0 offen nt lds
    v_add_u32 v204, s84, v1
    v_add_u32 v204, 512, v204
    v_mul_hi_u32 v205, v204, s83
    v_mul_u32_u24 v206, 10, v205
    v_sub_u32 v206, v204, v206
    v_mul_u32_u24 v205, 1280, v205
    v_lshl_add_u32 v205, v206, 4, v205
    v_add_u32 v205, s82, v205
    v_add_u32 v207, s81, v205
    v_add_u32 v208, s80, v205
    v_mov_b32 v209, 2147483648
    v_cmp_gt_u32 vcc, 670, v204
    s_nop 1
    v_cndmask_b32 v207, v209, v207, vcc
    v_cmp_gt_u32 vcc, 640, v204
    s_nop 1
    v_cndmask_b32 v208, v209, v208, vcc
    s_add_u32 m0, s85, 122880
    s_nop 0
    buffer_load_dwordx4 v207, s[12:15], 0 offen nt lds
    s_add_u32 m0, s85, 135168
    s_nop 0
    buffer_load_dwordx4 v208, s[16:19], 0 offen nt lds
    s_mul_i32 s82, s71, 640
    v_lshl_add_u32 v204, v1, 4, s82
    v_mov_b32 v209, 2147483648
    v_cmp_gt_u32 vcc, 40, v1
    s_nop 1
    v_cndmask_b32 v204, v209, v204, vcc
    s_mov_b32 m0, 139264
    s_nop 0
    buffer_load_dwordx4 v204, s[28:31], 0 offen lds
    s_mov_b32 s77, 0
    s_sub_u32 s80, s2, 160
    s_lshl_b32 s80, s80, 2
    s_add_u32 s80, s80, s4
    s_mul_i32 s81, s80, 1366
    s_lshr_b32 s81, s81, 16
    s_mul_i32 s82, s81, 48
    s_sub_u32 s82, s80, s82
    s_mul_i32 s82, s82, 40960
    s_mul_i32 s81, s81, 160
    s_add_u32 s82, s82, s81
    s_mul_i32 s78, s80, 5120
    s_add_u32 s78, s78, 16777216
    s_mul_i32 s83, s4, 5120
    s_add_u32 s83, s83, 140288
    s_mov_b32 s81, 0x1999999a
    v_add_u32 v240, 0, v1
    v_mul_hi_u32 v241, v240, s81
    v_mul_u32_u24 v242, 10, v241
    v_sub_u32 v242, v240, v242
    v_mul_u32_u24 v241, 1280, v241
    v_lshl_add_u32 v241, v242, 4, v241
    v_subrev_u32 v248, 0, v241
    v_or_b32 v248, s77, v248
    v_add_u32 v240, 64, v1
    v_mul_hi_u32 v241, v240, s81
    v_mul_u32_u24 v242, 10, v241
    v_sub_u32 v242, v240, v242
    v_mul_u32_u24 v241, 1280, v241
    v_lshl_add_u32 v241, v242, 4, v241
    v_subrev_u32 v249, 1024, v241
    v_or_b32 v249, s77, v249
    v_add_u32 v240, 128, v1
    v_mul_hi_u32 v241, v240, s81
    v_mul_u32_u24 v242, 10, v241
    v_sub_u32 v242, v240, v242
    v_mul_u32_u24 v241, 1280, v241
    v_lshl_add_u32 v241, v242, 4, v241
    v_subrev_u32 v250, 2048, v241
    v_or_b32 v250, s77, v250
    v_add_u32 v240, 192, v1
    v_mul_hi_u32 v241, v240, s81
    v_mul_u32_u24 v242, 10, v241
    v_sub_u32 v242, v240, v242
    v_mul_u32_u24 v241, 1280, v241
    v_lshl_add_u32 v241, v242, 4, v241
    v_subrev_u32 v251, 3072, v241
    v_or_b32 v251, s77, v251
    v_add_u32 v240, 256, v1
    v_mul_hi_u32 v241, v240, s81
    v_mul_u32_u24 v242, 10, v241
    v_sub_u32 v242, v240, v242
    v_mul_u32_u24 v241, 1280, v241
    v_lshl_add_u32 v241, v242, 4, v241
    v_subrev_u32 v252, 0, v241
    v_or_b32 v252, s77, v252
    s_mov_b32 m0, s83
    s_nop 0
    buffer_load_dwordx4 v248, s[24:27], s82 offen offset:0 nt lds
    buffer_load_dwordx4 v249, s[24:27], s82 offen offset:1024 nt lds
    buffer_load_dwordx4 v250, s[24:27], s82 offen offset:2048 nt lds
    buffer_load_dwordx4 v251, s[24:27], s82 offen offset:3072 nt lds
    s_add_u32 m0, s83, 4096
    s_nop 0
    buffer_load_dwordx4 v252, s[24:27], s82 offen nt lds
    v_bfe_u32 v240, v1, 5, 1
    v_lshlrev_b32 v240, 4, v240
    v_bfe_u32 v241, v1, 4, 1
    v_lshl_add_u32 v240, v241, 2, v240
    v_bfe_u32 v241, v1, 2, 2
    v_add_u32 v240, v240, v241
    v_mul_u32_u24 v240, 160, v240
    v_and_b32 v241, 3, v1
    v_lshl_add_u32 v240, v241, 3, v240
    v_add_u32 v253, s83, v240
    v_lshlrev_b32 v254, 4, v1
    v_or_b32 v254, s77, v254
    s_and_b32 s80, s2, 7
    s_lshl_b32 s80, s80, 8
    s_and_b32 s81, s2, -8
    s_add_u32 s80, s80, s81
    s_lshl_b32 s81, s4, 1
    s_add_u32 s80, s80, s81
    v_lshrrev_b32 v226, 5, v1
    v_add_u32 v226, s80, v226
    v_and_b32 v227, 31, v1
    v_mul_u32_u24 v224, 1280, v226
    v_lshl_add_u32 v225, v227, 3, v224
    v_lshl_add_u32 v224, v227, 4, v224
    buffer_load_dwordx4 v[214:217], v224, s[8:11], 0 offen
    buffer_load_dwordx4 v[218:221], v224, s[8:11], 0 offen offset:512
    buffer_load_dwordx2 v[222:223], v225, s[8:11], 0 offen offset:1024
    s_add_u32 m0, s75, 16384
    s_nop 0
    buffer_load_dwordx4 v2, s[8:11], s73 offen offset:0 lds
    s_mov_b32 s32, s62
    s_mov_b32 s33, s63
    s_mov_b32 s34, 2621440
    s_mov_b32 s35, 0x20000
    v_and_b32 v20, 31, v1
    v_lshrrev_b32 v21, 5, v1
    v_bfe_u32 v22, v1, 1, 3
    buffer_load_dwordx4 v3, s[8:11], s73 offen offset:1024 lds
    v_lshlrev_b32 v20, 7, v20
    v_add_u32 v20, s75, v20
    v_add_u32 v23, 0, v21
    v_xor_b32 v23, v23, v22
    v_lshl_add_u32 v9, v23, 4, v20
    v_add_u32 v23, 2, v21
    buffer_load_dwordx4 v4, s[8:11], s73 offen offset:2048 lds
    v_xor_b32 v23, v23, v22
    v_lshl_add_u32 v10, v23, 4, v20
    v_add_u32 v23, 4, v21
    v_xor_b32 v23, v23, v22
    v_lshl_add_u32 v11, v23, 4, v20
    v_add_u32 v23, 6, v21
    buffer_load_dwordx4 v5, s[8:11], s73 offen offset:3072 lds
    v_xor_b32 v23, v23, v22
    v_lshl_add_u32 v12, v23, 4, v20
    v_lshrrev_b32 v20, 5, v1
    v_lshlrev_b32 v20, 3, v20
    v_bfe_u32 v21, v1, 2, 2
    v_add_u32 v20, v20, v21
    v_mul_u32_u24 v20, 192, v20
    s_add_u32 s73, s73, 128
    s_add_u32 m0, s76, 12288
    s_nop 0
    buffer_load_dwordx4 v6, s[20:23], s74 offen offset:0 lds
    v_bfe_u32 v21, v1, 4, 1
    v_lshl_add_u32 v20, v21, 5, v20
    v_and_b32 v21, 3, v1
    v_lshl_add_u32 v20, v21, 3, v20
    v_add_u32 v17, 65536, v20
    s_mul_i32 s80, s4, 3072
    buffer_load_dwordx4 v7, s[20:23], s74 offen offset:1024 lds
    v_add_u32 v18, s80, v17
    v_mov_b32 v20, 0
    v_mov_b32 v21, 0
    v_mov_b32 v22, 0
    v_mov_b32 v23, 0
    v_mov_b32 v24, 0
    buffer_load_dwordx4 v8, s[20:23], s74 offen offset:2048 lds
    v_mov_b32 v25, 0
    v_mov_b32 v26, 0
    v_mov_b32 v27, 0
    v_mov_b32 v28, 0
    v_mov_b32 v29, 0
    v_mov_b32 v30, 0
    s_add_u32 s74, s74, 196608
    s_add_u32 m0, s75, 32768
    s_nop 0
    buffer_load_dwordx4 v2, s[8:11], s73 offen offset:0 lds
    v_mov_b32 v31, 0
    v_mov_b32 v32, 0
    v_mov_b32 v33, 0
    v_mov_b32 v34, 0
    v_mov_b32 v35, 0
    v_mov_b32 v36, 0
    v_mov_b32 v37, 0
    buffer_load_dwordx4 v3, s[8:11], s73 offen offset:1024 lds
    v_mov_b32 v38, 0
    v_mov_b32 v39, 0
    v_mov_b32 v40, 0
    v_mov_b32 v41, 0
    v_mov_b32 v42, 0
    v_mov_b32 v43, 0
    buffer_load_dwordx4 v4, s[8:11], s73 offen offset:2048 lds
    v_mov_b32 v44, 0
    v_mov_b32 v45, 0
    v_mov_b32 v46, 0
    v_mov_b32 v47, 0
    v_mov_b32 v48, 0
    v_mov_b32 v49, 0
    buffer_load_dwordx4 v5, s[8:11], s73 offen offset:3072 lds
    v_mov_b32 v50, 0
    v_mov_b32 v51, 0
    v_mov_b32 v52, 0
    v_mov_b32 v53, 0
    v_mov_b32 v54, 0
    v_mov_b32 v55, 0
    v_mov_b32 v56, 0
    s_add_u32 s73, s73, 128
    s_add_u32 m0, s76, 24576
    s_nop 0
    buffer_load_dwordx4 v6, s[20:23], s74 offen offset:0 lds
    v_mov_b32 v57, 0
    v_mov_b32 v58, 0
    v_mov_b32 v59, 0
    v_mov_b32 v60, 0
    v_mov_b32 v61, 0
    v_mov_b32 v62, 0
    buffer_load_dwordx4 v7, s[20:23], s74 offen offset:1024 lds
    v_mov_b32 v63, 0
    v_mov_b32 v64, 0
    v_mov_b32 v65, 0
    v_mov_b32 v66, 0
    v_mov_b32 v67, 0
    v_mov_b32 v121, s86
    buffer_load_dwordx4 v8, s[20:23], s74 offen offset:2048 lds
    s_add_u32 s74, s74, 196608
    v_accvgpr_write_b32 a196, v121
    v_accvgpr_write_b32 a197, v121
    v_accvgpr_write_b32 a198, v121
    v_accvgpr_write_b32 a199, v121
    s_waitcnt lgkmcnt(0)
    s_mul_i32 s5, s87, 0x9e3779b1
    s_add_u32 s5, s5, 0x7f4a7c15
    s_waitcnt vmcnt(29)
    s_barrier
    ds_read_b128 v[68:71], v9 offset:0
    ds_read_b64_tr_b16 v[76:77], v17 offset:0
    ds_read_b64_tr_b16 v[78:79], v17 offset:768
    ds_read_b64_tr_b16 v[80:81], v17 offset:64
    ds_read_b64_tr_b16 v[82:83], v17 offset:832
    ds_read_b64_tr_b16 v[84:85], v17 offset:128
    ds_read_b64_tr_b16 v[86:87], v17 offset:896
    s_waitcnt lgkmcnt(4)
    v_mfma_f32_32x32x16_bf16 v[20:35], v[76:79], v[68:71], v[20:35]
    s_waitcnt vmcnt(17)
    ds_read_b64_tr_b16 a[0:1], v253 offset:0
    ds_read_b64_tr_b16 a[2:3], v253 offset:1280
    ds_read_b64_tr_b16 a[4:5], v253 offset:32
    ds_read_b64_tr_b16 a[6:7], v253 offset:1312
    ds_read_b64_tr_b16 a[8:9], v253 offset:64
    ds_read_b64_tr_b16 a[10:11], v253 offset:1344
    ds_read_b64_tr_b16 a[12:13], v253 offset:96
    ds_read_b128 v[72:75], v10 offset:0
    ds_read_b64_tr_b16 v[88:89], v17 offset:3072
    ds_read_b64_tr_b16 v[90:91], v17 offset:3840
    s_waitcnt lgkmcnt(12)
    v_mfma_f32_32x32x16_bf16 v[36:51], v[80:83], v[68:71], v[36:51]
    ds_read_b64_tr_b16 a[14:15], v253 offset:1376
    ds_read_b64_tr_b16 a[16:17], v253 offset:128
    ds_read_b64_tr_b16 a[18:19], v253 offset:1408
    v_mov_b32 v123, v254
    v_mov_b32 v228, 0
    v_mov_b32 v229, 0
    ds_read_b64_tr_b16 v[92:93], v17 offset:3136
    ds_read_b64_tr_b16 v[94:95], v17 offset:3904
    ds_read_b64_tr_b16 v[100:101], v18 offset:0
    s_waitcnt lgkmcnt(15)
    v_mfma_f32_32x32x16_bf16 v[52:67], v[84:87], v[68:71], v[52:67]
    s_waitcnt vmcnt(16)
    v_dot2c_f32_bf16 v228, s86, v214
    v_dot2c_f32_bf16 v229, v214, v214
    v_dot2c_f32_bf16 v228, s86, v215
    v_dot2c_f32_bf16 v229, v215, v215
    v_dot2c_f32_bf16 v228, s86, v216
    v_dot2c_f32_bf16 v229, v216, v216
    ds_read_b64_tr_b16 v[96:97], v17 offset:3200
    ds_read_b64_tr_b16 v[98:99], v17 offset:3968
    ds_read_b64_tr_b16 v[102:103], v18 offset:768
    s_waitcnt lgkmcnt(9)
    v_mfma_f32_32x32x16_bf16 v[20:35], v[88:91], v[72:75], v[20:35]
    v_dot2c_f32_bf16 v228, s86, v217
    v_dot2c_f32_bf16 v229, v217, v217
    s_waitcnt vmcnt(15)
    v_dot2c_f32_bf16 v228, s86, v218
    v_dot2c_f32_bf16 v229, v218, v218
    v_dot2c_f32_bf16 v228, s86, v219
    v_dot2c_f32_bf16 v229, v219, v219
    ds_read_b128 v[68:71], v11 offset:0
    ds_read_b64_tr_b16 v[76:77], v17 offset:6144
    ds_read_b64_tr_b16 v[78:79], v17 offset:6912
    s_waitcnt lgkmcnt(7)
    v_mfma_f32_32x32x16_bf16 v[36:51], v[92:95], v[72:75], v[36:51]
    v_dot2c_f32_bf16 v228, s86, v220
    v_dot2c_f32_bf16 v229, v220, v220
    v_dot2c_f32_bf16 v228, s86, v221
    v_dot2c_f32_bf16 v229, v221, v221
    s_waitcnt vmcnt(14)
    v_dot2c_f32_bf16 v228, s86, v222
    v_dot2c_f32_bf16 v229, v222, v222
    ds_read_b64_tr_b16 v[80:81], v17 offset:6208
    ds_read_b64_tr_b16 v[82:83], v17 offset:6976
    s_waitcnt lgkmcnt(6)
    v_mfma_f32_32x32x16_bf16 v[52:67], v[96:99], v[72:75], v[52:67]
    v_dot2c_f32_bf16 v228, s86, v223
    v_dot2c_f32_bf16 v229, v223, v223
    s_nop 1
    v_add_f32_dpp v228, v228, v228 row_ror:8 row_mask:0xf bank_mask:0xf
    v_add_f32_dpp v229, v229, v229 row_ror:8 row_mask:0xf bank_mask:0xf
    s_nop 0
    v_add_f32_dpp v228, v228, v228 row_ror:4 row_mask:0xf bank_mask:0xf
    v_add_f32_dpp v229, v229, v229 row_ror:4 row_mask:0xf bank_mask:0xf
    s_add_u32 m0, s75, 49152
    s_nop 0
    buffer_load_dwordx4 v2, s[8:11], s73 offen offset:0 lds
    v_add_f32_dpp v228, v228, v228 row_ror:2 row_mask:0xf bank_mask:0xf
    ds_read_b64_tr_b16 v[84:85], v17 offset:6272
    ds_read_b64_tr_b16 v[86:87], v17 offset:7040
    s_waitcnt lgkmcnt(7)
    v_mfma_f32_32x32x16_bf16 a[208:223], a[196:199], v[100:103], 0
    v_add_f32_dpp v229, v229, v229 row_ror:2 row_mask:0xf bank_mask:0xf
    v_add_f32_dpp v228, v228, v228 row_ror:1 row_mask:0xf bank_mask:0xf
    s_nop 0
    v_add_f32_dpp v229, v229, v229 row_ror:1 row_mask:0xf bank_mask:0xf
    v_mov_b32 v230, v228
    buffer_load_dwordx4 v3, s[8:11], s73 offen offset:1024 lds
    v_mov_b32 v231, v229
    v_permlane16_swap_b32 v228, v230
    ds_read_b64_tr_b16 v[104:105], v18 offset:64
    ds_read_b64_tr_b16 v[106:107], v18 offset:832
    s_waitcnt lgkmcnt(6)
    v_mfma_f32_32x32x16_bf16 v[20:35], v[76:79], v[68:71], v[20:35]
    v_permlane16_swap_b32 v229, v231
    v_add_f32 v228, v228, v230
    v_add_f32 v229, v229, v231
    buffer_load_dwordx4 v4, s[8:11], s73 offen offset:2048 lds
    v_mul_f32 v228, 0x3acccccd, v228
    v_mul_f32 v229, 0x3acccccd, v229
    v_fma_f32 v229, -v228, v228, v229
    ds_read_b128 v[72:75], v12 offset:0
    ds_read_b64_tr_b16 v[88:89], v17 offset:9216
    ds_read_b64_tr_b16 v[90:91], v17 offset:9984
    s_waitcnt lgkmcnt(7)
    v_mfma_f32_32x32x16_bf16 v[36:51], v[80:83], v[68:71], v[36:51]
    buffer_load_dwordx4 v5, s[8:11], s73 offen offset:3072 lds
    v_max_f32 v229, 0, v229
    v_cvt_pk_bf16_f32 v228, v228, v229
    v_and_b32 v229, 0xffff0000, v228
    v_lshlrev_b32 v228, 16, v228
    v_add_f32 v229, 0x3727c5ac, v229
    v_cvt_pk_bf16_f32 v229, v229, v229
    ds_read_b64_tr_b16 v[92:93], v17 offset:9280
    ds_read_b64_tr_b16 v[94:95], v17 offset:10048
    s_waitcnt lgkmcnt(7)
    v_mfma_f32_32x32x16_bf16 v[52:67], v[84:87], v[68:71], v[52:67]
    s_add_u32 s73, s73, 128
    s_add_u32 m0, s76, 36864
    s_nop 0
    buffer_load_dwordx4 v6, s[20:23], s74 offen offset:0 lds
    v_lshlrev_b32 v229, 16, v229
    v_sqrt_f32 v229, v229
    s_nop 0
    v_cvt_pk_bf16_f32 v229, v229, v229
    v_lshlrev_b32 v229, 16, v229
    v_lshlrev_b32 v230, 3, v226
    v_add_u32 v230, 65536, v230
    ds_read_b64_tr_b16 v[96:97], v17 offset:9344
    buffer_load_dwordx4 v7, s[20:23], s74 offen offset:1024 lds
    ds_read_b64_tr_b16 v[98:99], v17 offset:10112
    s_waitcnt lgkmcnt(7)
    v_mfma_f32_32x32x16_bf16 a[224:239], a[196:199], v[104:107], 0
    v_mov_b32 v231, 2147483648
    v_cmp_eq_u32 vcc, 0, v227
    s_nop 1
    v_cndmask_b32 v230, v231, v230, vcc
    v_mov_b32 v116, v228
    v_mov_b32 v117, v229
    buffer_load_dwordx4 v8, s[20:23], s74 offen offset:2048 lds
    s_add_u32 s74, s74, 196608
    v_mov_b32 v122, v230
    ds_read_b64_tr_b16 v[108:109], v18 offset:128
    ds_read_b64_tr_b16 v[110:111], v18 offset:896
    s_waitcnt lgkmcnt(6)
    v_mfma_f32_32x32x16_bf16 v[20:35], v[88:91], v[72:75], v[20:35]
    s_waitcnt vmcnt(14)
    s_waitcnt lgkmcnt(0)
    s_barrier
    ds_read_b128 v[68:71], v9 offset:16384
    ds_read_b64_tr_b16 v[76:77], v17 offset:12288
    ds_read_b64_tr_b16 v[78:79], v17 offset:13056
    v_mfma_f32_32x32x16_bf16 a[240:255], a[196:199], v[108:111], 0
    ds_read_b64_tr_b16 v[80:81], v17 offset:12352
    ds_read_b64_tr_b16 v[82:83], v17 offset:13120
    v_mfma_f32_32x32x16_bf16 v[36:51], v[92:95], v[72:75], v[36:51]
    ds_read_b64_tr_b16 v[84:85], v17 offset:12416
    ds_read_b64_tr_b16 v[86:87], v17 offset:13184
    v_mfma_f32_32x32x16_bf16 v[52:67], v[96:99], v[72:75], v[52:67]
    s_waitcnt lgkmcnt(4)
    v_mfma_f32_32x32x16_bf16 v[20:35], v[76:79], v[68:71], v[20:35]
    v_mul_u32_u24 v213, 6554, v0
    v_lshrrev_b32 v213, 16, v213
    v_mul_u32_u24 v212, 10, v213
    s_add_u32 m0, s75, 0
    s_nop 0
    buffer_load_dwordx4 v2, s[8:11], s73 offen offset:0 lds
    v_sub_u32 v212, v0, v212
    v_min_u32 v204, 15, v213
    v_mul_u32_u24 v204, 640, v204
    v_lshl_add_u32 v204, v212, 4, v204
    v_add_u32 v205, 126976, v204
    v_add_u32 v204, 114688, v204
    v_lshlrev_b32 v206, 6, v212
    v_add_u32 v206, 139264, v206
    ds_read_b128 v[144:147], v204 offset:0
    ds_read_b128 v[148:151], v204 offset:160
    ds_read_b128 v[152:155], v204 offset:320
    ds_read_b128 v[156:159], v204 offset:480
    ds_read_b128 v[160:163], v204 offset:640
    ds_read_b128 v[164:167], v204 offset:800
    ds_read_b128 v[72:75], v10 offset:16384
    ds_read_b64_tr_b16 v[88:89], v17 offset:15360
    ds_read_b64_tr_b16 v[90:91], v17 offset:16128
    s_waitcnt lgkmcnt(11)
    v_mfma_f32_32x32x16_bf16 v[36:51], v[80:83], v[68:71], v[36:51]
    ds_read_b128 v[168:171], v204 offset:960
    ds_read_b128 v[188:191], v206 offset:0
    ds_read_b128 v[192:195], v206 offset:16
    ds_read_b128 v[196:199], v206 offset:32
    ds_read_b128 v[200:203], v206 offset:48
    ds_read_b128 v[172:175], v205 offset:0
    ds_read_b128 v[176:179], v205 offset:160
    ds_read_b128 v[180:183], v205 offset:320
    ds_read_b128 v[184:187], v205 offset:480
    s_waitcnt lgkmcnt(15)
    v_lshlrev_b32 v214, 16, v144
    v_and_b32 v215, 0xffff0000, v144
    v_lshlrev_b32 v216, 16, v148
    v_and_b32 v217, 0xffff0000, v148
    v_lshlrev_b32 v218, 16, v152
    buffer_load_dwordx4 v3, s[8:11], s73 offen offset:1024 lds
    v_and_b32 v219, 0xffff0000, v152
    s_waitcnt lgkmcnt(14)
    v_lshlrev_b32 v220, 16, v156
    v_and_b32 v221, 0xffff0000, v156
    ds_read_b64_tr_b16 v[92:93], v17 offset:15424
    ds_read_b64_tr_b16 v[94:95], v17 offset:16192
    ds_read_b64_tr_b16 v[100:101], v18 offset:12288
    v_mfma_f32_32x32x16_bf16 v[52:67], v[84:87], v[68:71], v[52:67]
    s_waitcnt lgkmcnt(15)
    v_lshlrev_b32 v222, 16, v160
    v_and_b32 v223, 0xffff0000, v160
    v_lshlrev_b32 v224, 16, v164
    v_and_b32 v225, 0xffff0000, v164
    s_waitcnt lgkmcnt(11)
    v_lshlrev_b32 v226, 16, v168
    v_and_b32 v227, 0xffff0000, v168
    s_waitcnt lgkmcnt(10)
    v_lshlrev_b32 v236, 16, v188
    v_lshlrev_b32 v237, 16, v190
    v_and_b32 v238, 0xffff0000, v188
    v_and_b32 v239, 0xffff0000, v190
    v_lshlrev_b32 v240, 16, v189
    v_lshlrev_b32 v241, 16, v191
    v_and_b32 v242, 0xffff0000, v189
    v_and_b32 v243, 0xffff0000, v191
    s_waitcnt lgkmcnt(6)
    v_lshlrev_b32 v228, 16, v172
    v_and_b32 v229, 0xffff0000, v172
    ds_read_b64_tr_b16 v[96:97], v17 offset:15488
    ds_read_b64_tr_b16 v[98:99], v17 offset:16256
    ds_read_b64_tr_b16 v[102:103], v18 offset:13056
    v_mfma_f32_32x32x16_bf16 v[20:35], v[88:91], v[72:75], v[20:35]
    s_waitcnt lgkmcnt(8)
    v_lshlrev_b32 v230, 16, v176
    v_and_b32 v231, 0xffff0000, v176
    s_waitcnt lgkmcnt(7)
    v_lshlrev_b32 v232, 16, v180
    v_and_b32 v233, 0xffff0000, v180
    buffer_load_dwordx4 v4, s[8:11], s73 offen offset:2048 lds
    s_waitcnt lgkmcnt(6)
    v_lshlrev_b32 v234, 16, v184
    v_and_b32 v235, 0xffff0000, v184
    v_mul_f32 v244, v214, v242
    v_mul_f32 v245, v215, v243
    v_mul_f32 v246, v216, v242
    v_mul_f32 v247, v217, v243
    v_mul_f32 v248, v218, v242
    v_mul_f32 v249, v219, v243
    v_mul_f32 v250, v220, v242
    v_mul_f32 v251, v221, v243
    v_fmac_f32 v244, v216, v240
    v_fmac_f32 v245, v217, v241
    v_fmac_f32 v246, v218, v240
    ds_read_b128 v[68:71], v11 offset:16384
    ds_read_b64_tr_b16 v[76:77], v17 offset:18432
    ds_read_b64_tr_b16 v[78:79], v17 offset:19200
    s_waitcnt lgkmcnt(7)
    v_mfma_f32_32x32x16_bf16 v[36:51], v[92:95], v[72:75], v[36:51]
    v_fmac_f32 v247, v219, v241
    v_fmac_f32 v248, v220, v240
    v_fmac_f32 v249, v221, v241
    v_fmac_f32 v250, v222, v240
    v_fmac_f32 v251, v223, v241
    v_fmac_f32 v244, v218, v238
    v_fmac_f32 v245, v219, v239
    v_fmac_f32 v246, v220, v238
    v_fmac_f32 v247, v221, v239
    v_fmac_f32 v248, v222, v238
    v_fmac_f32 v249, v223, v239
    v_fmac_f32 v250, v224, v238
    v_fmac_f32 v251, v225, v239
    v_fmac_f32 v244, v220, v236
    v_fmac_f32 v245, v221, v237
    buffer_load_dwordx4 v5, s[8:11], s73 offen offset:3072 lds
    v_fmac_f32 v246, v222, v236
    ds_read_b64_tr_b16 v[80:81], v17 offset:18496
    ds_read_b64_tr_b16 v[82:83], v17 offset:19264
    s_waitcnt lgkmcnt(6)
    v_mfma_f32_32x32x16_bf16 v[52:67], v[96:99], v[72:75], v[52:67]
    v_fmac_f32 v247, v223, v237
    v_fmac_f32 v248, v224, v236
    v_fmac_f32 v249, v225, v237
    v_fmac_f32 v250, v226, v236
    v_fmac_f32 v251, v227, v237
    v_mul_f32 v244, v244, v228
    v_mul_f32 v245, v245, v229
    v_mul_f32 v246, v246, v230
    v_mul_f32 v247, v247, v231
    v_mul_f32 v248, v248, v232
    v_mul_f32 v249, v249, v233
    v_mul_f32 v250, v250, v234
    v_mul_f32 v251, v251, v235
    v_cvt_pk_bf16_f32 v128, v244, v246
    v_cvt_pk_bf16_f32 v129, v248, v250
    v_cvt_pk_bf16_f32 v130, v245, v247
    v_cvt_pk_bf16_f32 v131, v249, v251
    ds_read_b64_tr_b16 v[84:85], v17 offset:18560
    ds_read_b64_tr_b16 v[86:87], v17 offset:19328
    s_waitcnt lgkmcnt(7)
    v_mfma_f32_32x32x16_bf16 a[208:223], a[196:199], v[100:103], a[208:223]
    v_lshlrev_b32 v214, 16, v145
    v_and_b32 v215, 0xffff0000, v145
    v_lshlrev_b32 v216, 16, v149
    v_and_b32 v217, 0xffff0000, v149
    v_lshlrev_b32 v218, 16, v153
    v_and_b32 v219, 0xffff0000, v153
    s_add_u32 s73, s73, 128
    s_add_u32 m0, s76, 0
    s_nop 0
    buffer_load_dwordx4 v6, s[20:23], s74 offen offset:0 lds
    v_lshlrev_b32 v220, 16, v157
    v_and_b32 v221, 0xffff0000, v157
    v_lshlrev_b32 v222, 16, v161
    v_and_b32 v223, 0xffff0000, v161
    v_lshlrev_b32 v224, 16, v165
    v_and_b32 v225, 0xffff0000, v165
    v_lshlrev_b32 v226, 16, v169
    v_and_b32 v227, 0xffff0000, v169
    v_lshlrev_b32 v236, 16, v192
    v_lshlrev_b32 v237, 16, v194
    ds_read_b64_tr_b16 v[104:105], v18 offset:12352
    ds_read_b64_tr_b16 v[106:107], v18 offset:13120
    s_waitcnt lgkmcnt(6)
    v_mfma_f32_32x32x16_bf16 v[20:35], v[76:79], v[68:71], v[20:35]
    v_and_b32 v238, 0xffff0000, v192
    v_and_b32 v239, 0xffff0000, v194
    v_lshlrev_b32 v240, 16, v193
    v_lshlrev_b32 v241, 16, v195
    v_and_b32 v242, 0xffff0000, v193
    v_and_b32 v243, 0xffff0000, v195
    v_lshlrev_b32 v228, 16, v173
    v_and_b32 v229, 0xffff0000, v173
    v_lshlrev_b32 v230, 16, v177
    v_and_b32 v231, 0xffff0000, v177
    v_lshlrev_b32 v232, 16, v181
    v_and_b32 v233, 0xffff0000, v181
    v_lshlrev_b32 v234, 16, v185
    v_and_b32 v235, 0xffff0000, v185
    v_mul_f32 v244, v214, v242
    v_mul_f32 v245, v215, v243
    v_mul_f32 v246, v216, v242
    ds_read_b128 v[72:75], v12 offset:16384
    ds_read_b64_tr_b16 v[88:89], v17 offset:21504
    buffer_load_dwordx4 v7, s[20:23], s74 offen offset:1024 lds
    ds_read_b64_tr_b16 v[90:91], v17 offset:22272
    s_waitcnt lgkmcnt(7)
    v_mfma_f32_32x32x16_bf16 v[36:51], v[80:83], v[68:71], v[36:51]
    v_mul_f32 v247, v217, v243
    v_mul_f32 v248, v218, v242
    v_mul_f32 v249, v219, v243
    v_mul_f32 v250, v220, v242
    v_mul_f32 v251, v221, v243
    v_fmac_f32 v244, v216, v240
    v_fmac_f32 v245, v217, v241
    v_fmac_f32 v246, v218, v240
    v_fmac_f32 v247, v219, v241
    v_fmac_f32 v248, v220, v240
    v_fmac_f32 v249, v221, v241
    v_fmac_f32 v250, v222, v240
    v_fmac_f32 v251, v223, v241
    v_fmac_f32 v244, v218, v238
    v_fmac_f32 v245, v219, v239
    v_fmac_f32 v246, v220, v238
    ds_read_b64_tr_b16 v[92:93], v17 offset:21568
    ds_read_b64_tr_b16 v[94:95], v17 offset:22336
    s_waitcnt lgkmcnt(7)
    v_mfma_f32_32x32x16_bf16 v[52:67], v[84:87], v[68:71], v[52:67]
    v_fmac_f32 v247, v221, v239
    v_fmac_f32 v248, v222, v238
    v_fmac_f32 v249, v223, v239
    v_fmac_f32 v250, v224, v238
    v_fmac_f32 v251, v225, v239
    v_fmac_f32 v244, v220, v236
    v_fmac_f32 v245, v221, v237
    v_fmac_f32 v246, v222, v236
    v_fmac_f32 v247, v223, v237
    v_fmac_f32 v248, v224, v236
    buffer_load_dwordx4 v8, s[20:23], s74 offen offset:2048 lds
    s_add_u32 s74, s74, 196608
    v_fmac_f32 v249, v225, v237
    v_fmac_f32 v250, v226, v236
    v_fmac_f32 v251, v227, v237
    v_mul_f32 v244, v244, v228
    v_mul_f32 v245, v245, v229
    v_mul_f32 v246, v246, v230
    v_mul_f32 v247, v247, v231
    ds_read_b64_tr_b16 v[96:97], v17 offset:21632
    ds_read_b64_tr_b16 v[98:99], v17 offset:22400
    s_waitcnt lgkmcnt(7)
    v_mfma_f32_32x32x16_bf16 a[224:239], a[196:199], v[104:107], a[224:239]
    v_mul_f32 v248, v248, v232
    v_mul_f32 v249, v249, v233
    v_mul_f32 v250, v250, v234
    v_mul_f32 v251, v251, v235
    v_cvt_pk_bf16_f32 v132, v244, v246
    v_cvt_pk_bf16_f32 v133, v248, v250
    v_cvt_pk_bf16_f32 v134, v245, v247
    v_cvt_pk_bf16_f32 v135, v249, v251
    v_lshlrev_b32 v214, 16, v146
    v_and_b32 v215, 0xffff0000, v146
    v_lshlrev_b32 v216, 16, v150
    v_and_b32 v217, 0xffff0000, v150
    v_lshlrev_b32 v218, 16, v154
    v_and_b32 v219, 0xffff0000, v154
    v_lshlrev_b32 v220, 16, v158
    v_and_b32 v221, 0xffff0000, v158
    ds_read_b64_tr_b16 v[108:109], v18 offset:12416
    ds_read_b64_tr_b16 v[110:111], v18 offset:13184
    s_waitcnt lgkmcnt(6)
    v_mfma_f32_32x32x16_bf16 v[20:35], v[88:91], v[72:75], v[20:35]
    s_waitcnt vmcnt(14)
    s_waitcnt lgkmcnt(0)
    s_barrier
    ds_read_b128 v[68:71], v9 offset:32768
    ds_read_b64_tr_b16 v[76:77], v17 offset:24576
    ds_read_b64_tr_b16 v[78:79], v17 offset:25344
    v_mfma_f32_32x32x16_bf16 a[240:255], a[196:199], v[108:111], a[240:255]
    ds_read_b64_tr_b16 v[80:81], v17 offset:24640
    ds_read_b64_tr_b16 v[82:83], v17 offset:25408
    v_mfma_f32_32x32x16_bf16 v[36:51], v[92:95], v[72:75], v[36:51]
    ds_read_b64_tr_b16 v[84:85], v17 offset:24704
    ds_read_b64_tr_b16 v[86:87], v17 offset:25472
    v_mfma_f32_32x32x16_bf16 v[52:67], v[96:99], v[72:75], v[52:67]
    s_waitcnt lgkmcnt(4)
    v_mfma_f32_32x32x16_bf16 v[20:35], v[76:79], v[68:71], v[20:35]
    v_lshlrev_b32 v222, 16, v162
    v_and_b32 v223, 0xffff0000, v162
    v_lshlrev_b32 v224, 16, v166
    s_add_u32 m0, s75, 16384
    s_nop 0
    buffer_load_dwordx4 v2, s[8:11], s73 offen offset:0 lds
    v_and_b32 v225, 0xffff0000, v166
    v_lshlrev_b32 v226, 16, v170
    v_and_b32 v227, 0xffff0000, v170
    v_lshlrev_b32 v236, 16, v196
    v_lshlrev_b32 v237, 16, v198
    v_and_b32 v238, 0xffff0000, v196
    v_and_b32 v239, 0xffff0000, v198
    v_lshlrev_b32 v240, 16, v197
    v_lshlrev_b32 v241, 16, v199
    v_and_b32 v242, 0xffff0000, v197
    v_and_b32 v243, 0xffff0000, v199
    v_lshlrev_b32 v228, 16, v174
    ds_read_b128 v[72:75], v10 offset:32768
    ds_read_b64_tr_b16 v[88:89], v17 offset:27648
    ds_read_b64_tr_b16 v[90:91], v17 offset:28416
    s_waitcnt lgkmcnt(5)
    v_mfma_f32_32x32x16_bf16 v[36:51], v[80:83], v[68:71], v[36:51]
    v_and_b32 v229, 0xffff0000, v174
    v_lshlrev_b32 v230, 16, v178
    v_and_b32 v231, 0xffff0000, v178
    v_lshlrev_b32 v232, 16, v182
    v_and_b32 v233, 0xffff0000, v182
    v_lshlrev_b32 v234, 16, v186
    v_and_b32 v235, 0xffff0000, v186
    v_mul_f32 v244, v214, v242
    v_mul_f32 v245, v215, v243
    v_mul_f32 v246, v216, v242
    v_mul_f32 v247, v217, v243
    v_mul_f32 v248, v218, v242
    buffer_load_dwordx4 v3, s[8:11], s73 offen offset:1024 lds
    v_mul_f32 v249, v219, v243
    v_mul_f32 v250, v220, v242
    ds_read_b64_tr_b16 v[92:93], v17 offset:27712
    ds_read_b64_tr_b16 v[94:95], v17 offset:28480
    ds_read_b64_tr_b16 v[100:101], v18 offset:24576
    s_waitcnt lgkmcnt(6)
    v_mfma_f32_32x32x16_bf16 v[52:67], v[84:87], v[68:71], v[52:67]
    v_mul_f32 v251, v221, v243
    v_fmac_f32 v244, v216, v240
    v_fmac_f32 v245, v217, v241
    v_fmac_f32 v246, v218, v240
    v_fmac_f32 v247, v219, v241
    v_fmac_f32 v248, v220, v240
    v_fmac_f32 v249, v221, v241
    v_fmac_f32 v250, v222, v240
    v_fmac_f32 v251, v223, v241
    v_fmac_f32 v244, v218, v238
    v_fmac_f32 v245, v219, v239
    v_fmac_f32 v246, v220, v238
    v_fmac_f32 v247, v221, v239
    v_fmac_f32 v248, v222, v238
    ds_read_b64_tr_b16 v[96:97], v17 offset:27776
    ds_read_b64_tr_b16 v[98:99], v17 offset:28544
    ds_read_b64_tr_b16 v[102:103], v18 offset:25344
    s_waitcnt lgkmcnt(6)
    v_mfma_f32_32x32x16_bf16 v[20:35], v[88:91], v[72:75], v[20:35]
    v_fmac_f32 v249, v223, v239
    v_fmac_f32 v250, v224, v238
    v_fmac_f32 v251, v225, v239
    buffer_load_dwordx4 v4, s[8:11], s73 offen offset:2048 lds
    v_fmac_f32 v244, v220, v236
    v_fmac_f32 v245, v221, v237
    v_fmac_f32 v246, v222, v236
    v_fmac_f32 v247, v223, v237
    v_fmac_f32 v248, v224, v236
    v_fmac_f32 v249, v225, v237
    v_fmac_f32 v250, v226, v236
    v_fmac_f32 v251, v227, v237
    v_mul_f32 v244, v244, v228
    v_mul_f32 v245, v245, v229
    v_mul_f32 v246, v246, v230
    ds_read_b128 v[68:71], v11 offset:32768
    ds_read_b64_tr_b16 v[76:77], v17 offset:30720
    ds_read_b64_tr_b16 v[78:79], v17 offset:31488
    s_waitcnt lgkmcnt(7)
    v_mfma_f32_32x32x16_bf16 v[36:51], v[92:95], v[72:75], v[36:51]
    v_mul_f32 v247, v247, v231
    v_mul_f32 v248, v248, v232
    v_mul_f32 v249, v249, v233
    v_mul_f32 v250, v250, v234
    v_mul_f32 v251, v251, v235
    v_cvt_pk_bf16_f32 v136, v244, v246
    v_cvt_pk_bf16_f32 v137, v248, v250
    v_cvt_pk_bf16_f32 v138, v245, v247
    v_cvt_pk_bf16_f32 v139, v249, v251
    v_lshlrev_b32 v214, 16, v147
    v_and_b32 v215, 0xffff0000, v147
    v_lshlrev_b32 v216, 16, v151
    v_and_b32 v217, 0xffff0000, v151
    buffer_load_dwordx4 v5, s[8:11], s73 offen offset:3072 lds
    v_lshlrev_b32 v218, 16, v155
    ds_read_b64_tr_b16 v[80:81], v17 offset:30784
    ds_read_b64_tr_b16 v[82:83], v17 offset:31552
    s_waitcnt lgkmcnt(6)
    v_mfma_f32_32x32x16_bf16 v[52:67], v[96:99], v[72:75], v[52:67]
    v_and_b32 v219, 0xffff0000, v155
    v_lshlrev_b32 v220, 16, v159
    v_and_b32 v221, 0xffff0000, v159
    v_lshlrev_b32 v222, 16, v163
    v_and_b32 v223, 0xffff0000, v163
    v_lshlrev_b32 v224, 16, v167
    v_and_b32 v225, 0xffff0000, v167
    v_lshlrev_b32 v226, 16, v171
    v_and_b32 v227, 0xffff0000, v171
    v_lshlrev_b32 v236, 16, v200
    v_lshlrev_b32 v237, 16, v202
    v_and_b32 v238, 0xffff0000, v200
    v_and_b32 v239, 0xffff0000, v202
    v_lshlrev_b32 v240, 16, v201
    v_lshlrev_b32 v241, 16, v203
    ds_read_b64_tr_b16 v[84:85], v17 offset:30848
    ds_read_b64_tr_b16 v[86:87], v17 offset:31616
    s_waitcnt lgkmcnt(7)
    v_mfma_f32_32x32x16_bf16 a[208:223], a[196:199], v[100:103], a[208:223]
    v_and_b32 v242, 0xffff0000, v201
    v_and_b32 v243, 0xffff0000, v203
    v_lshlrev_b32 v228, 16, v175
    v_and_b32 v229, 0xffff0000, v175
    v_lshlrev_b32 v230, 16, v179
    v_and_b32 v231, 0xffff0000, v179
    s_add_u32 s73, s73, 128
    s_add_u32 m0, s76, 12288
    s_nop 0
    buffer_load_dwordx4 v6, s[20:23], s74 offen offset:0 lds
    v_lshlrev_b32 v232, 16, v183
    v_and_b32 v233, 0xffff0000, v183
    v_lshlrev_b32 v234, 16, v187
    v_and_b32 v235, 0xffff0000, v187
    v_mul_f32 v244, v214, v242
    v_mul_f32 v245, v215, v243
    v_mul_f32 v246, v216, v242
    v_mul_f32 v247, v217, v243
    ds_read_b64_tr_b16 v[104:105], v18 offset:24640
    ds_read_b64_tr_b16 v[106:107], v18 offset:25408
    s_waitcnt lgkmcnt(6)
    v_mfma_f32_32x32x16_bf16 v[20:35], v[76:79], v[68:71], v[20:35]
    v_mul_f32 v248, v218, v242
    v_mul_f32 v249, v219, v243
    v_mul_f32 v250, v220, v242
    v_mul_f32 v251, v221, v243
    v_fmac_f32 v244, v216, v240
    v_fmac_f32 v245, v217, v241
    v_fmac_f32 v246, v218, v240
    v_fmac_f32 v247, v219, v241
    v_fmac_f32 v248, v220, v240
    v_fmac_f32 v249, v221, v241
    v_fmac_f32 v250, v222, v240
    v_fmac_f32 v251, v223, v241
    v_fmac_f32 v244, v218, v238
    v_fmac_f32 v245, v219, v239
    ds_read_b128 v[72:75], v12 offset:32768
    ds_read_b64_tr_b16 v[88:89], v17 offset:33792
    ds_read_b64_tr_b16 v[90:91], v17 offset:34560
    buffer_load_dwordx4 v7, s[20:23], s74 offen offset:1024 lds
    s_waitcnt lgkmcnt(7)
    v_mfma_f32_32x32x16_bf16 v[36:51], v[80:83], v[68:71], v[36:51]
    v_fmac_f32 v246, v220, v238
    v_fmac_f32 v247, v221, v239
    v_fmac_f32 v248, v222, v238
    v_fmac_f32 v249, v223, v239
    v_fmac_f32 v250, v224, v238
    v_fmac_f32 v251, v225, v239
    v_fmac_f32 v244, v220, v236
    v_fmac_f32 v245, v221, v237
    v_fmac_f32 v246, v222, v236
    v_fmac_f32 v247, v223, v237
    v_fmac_f32 v248, v224, v236
    v_fmac_f32 v249, v225, v237
    v_fmac_f32 v250, v226, v236
    v_fmac_f32 v251, v227, v237
    ds_read_b64_tr_b16 v[92:93], v17 offset:33856
    ds_read_b64_tr_b16 v[94:95], v17 offset:34624
    s_waitcnt lgkmcnt(7)
    v_mfma_f32_32x32x16_bf16 v[52:67], v[84:87], v[68:71], v[52:67]
    v_mul_f32 v244, v244, v228
    v_mul_f32 v245, v245, v229
    v_mul_f32 v246, v246, v230
    v_mul_f32 v247, v247, v231
    v_mul_f32 v248, v248, v232
    v_mul_f32 v249, v249, v233
    v_mul_f32 v250, v250, v234
    v_mul_f32 v251, v251, v235
    v_cvt_pk_bf16_f32 v140, v244, v246
    buffer_load_dwordx4 v8, s[20:23], s74 offen offset:2048 lds
    s_add_u32 s74, s74, 196608
    v_cvt_pk_bf16_f32 v141, v248, v250
    v_cvt_pk_bf16_f32 v142, v245, v247
    v_cvt_pk_bf16_f32 v143, v249, v251
    v_and_b32 v214, 14, v212
    v_xor_b32 v214, v214, v213
    ds_read_b64_tr_b16 v[96:97], v17 offset:33920
    ds_read_b64_tr_b16 v[98:99], v17 offset:34688
    s_waitcnt lgkmcnt(7)
    v_mfma_f32_32x32x16_bf16 a[224:239], a[196:199], v[104:107], a[224:239]
    v_lshlrev_b32 v214, 3, v214
    v_lshl_add_u32 v214, v212, 10, v214
    v_mov_b32 v215, 12288
    v_cmp_gt_u32 vcc, 160, v0
    s_nop 1
    v_cndmask_b32 v214, v215, v214, vcc
    v_add_u32 v214, 114688, v214
    ds_write_b64 v214, v[128:129] offset:0
    ds_write_b64 v214, v[130:131] offset:128
    ds_write_b64 v214, v[132:133] offset:256
    ds_write_b64 v214, v[134:135] offset:384
    ds_write_b64 v214, v[136:137] offset:512
    ds_write_b64 v214, v[138:139] offset:640
    ds_write_b64 v214, v[140:141] offset:768
    ds_write_b64 v214, v[142:143] offset:896
    ds_read_b64_tr_b16 v[108:109], v18 offset:24704
    ds_read_b64_tr_b16 v[110:111], v18 offset:25472
    s_waitcnt lgkmcnt(14)
    v_mfma_f32_32x32x16_bf16 v[20:35], v[88:91], v[72:75], v[20:35]
    s_waitcnt vmcnt(14)
    s_waitcnt lgkmcnt(0)
    s_barrier
    ds_read_b128 v[68:71], v9 offset:49152
    ds_read_b64_tr_b16 v[76:77], v17 offset:36864
    ds_read_b64_tr_b16 v[78:79], v17 offset:37632
    v_mfma_f32_32x32x16_bf16 a[240:255], a[196:199], v[108:111], a[240:255]
    ds_read_b64_tr_b16 v[80:81], v17 offset:36928
    ds_read_b64_tr_b16 v[82:83], v17 offset:37696
    v_mfma_f32_32x32x16_bf16 v[36:51], v[92:95], v[72:75], v[36:51]
    ds_read_b64_tr_b16 v[84:85], v17 offset:36992
    ds_read_b64_tr_b16 v[86:87], v17 offset:37760
    v_mfma_f32_32x32x16_bf16 v[52:67], v[96:99], v[72:75], v[52:67]
    s_waitcnt lgkmcnt(4)
    v_mfma_f32_32x32x16_bf16 v[20:35], v[76:79], v[68:71], v[20:35]
    v_lshrrev_b32 v214, 3, v0
    s_add_u32 m0, s75, 32768
    s_nop 0
    buffer_load_dwordx4 v2, s[8:11], s73 offen offset:0 lds
    v_and_b32 v215, 7, v0
    v_lshrrev_b32 v216, 6, v0
    v_lshlrev_b32 v218, 1, v215
    v_lshlrev_b32 v219, 7, v214
    v_add_u32 v219, 114688, v219
    v_add_u32 v217, 0, v216
    v_and_b32 v217, 14, v217
    v_xor_b32 v217, v217, v218
    v_lshl_add_u32 v217, v217, 3, v219
    ds_read_b128 v[128:131], v217 offset:0
    v_add_u32 v217, 4, v216
    v_and_b32 v217, 14, v217
    ds_read_b128 v[72:75], v10 offset:49152
    ds_read_b64_tr_b16 v[88:89], v17 offset:39936
    ds_read_b64_tr_b16 v[90:91], v17 offset:40704
    s_waitcnt lgkmcnt(6)
    v_mfma_f32_32x32x16_bf16 v[36:51], v[80:83], v[68:71], v[36:51]
    buffer_load_dwordx4 v3, s[8:11], s73 offen offset:1024 lds
    v_xor_b32 v217, v217, v218
    v_lshl_add_u32 v217, v217, 3, v219
    ds_read_b128 v[132:135], v217 offset:4096
    v_add_u32 v217, 8, v216
    v_and_b32 v217, 14, v217
    v_xor_b32 v217, v217, v218
    v_lshl_add_u32 v217, v217, 3, v219
    ds_read_b128 v[136:139], v217 offset:8192
    s_mul_i32 s80, s71, 327680
    s_lshl_b32 s81, s70, 7
    s_add_u32 s80, s80, s81
    s_add_u32 s80, s80, 1048576
    ds_read_b64_tr_b16 v[92:93], v17 offset:40000
    ds_read_b64_tr_b16 v[94:95], v17 offset:40768
    ds_read_b64_tr_b16 v[100:101], v18 offset:36864
    s_waitcnt lgkmcnt(9)
    v_mfma_f32_32x32x16_bf16 v[52:67], v[84:87], v[68:71], v[52:67]
    buffer_load_dwordx4 v4, s[8:11], s73 offen offset:2048 lds
    v_lshlrev_b32 v220, 12, v214
    v_lshl_add_u32 v220, v215, 4, v220
    v_add_u32 v221, 131072, v220
    v_add_u32 v222, 262144, v220
    v_mov_b32 v223, 2147483648
    v_cmp_gt_u32 vcc, 128, v0
    s_nop 1
    v_cndmask_b32 v222, v223, v222, vcc
    s_waitcnt lgkmcnt(8)
    buffer_store_dwordx4 v[128:131], v220, s[36:39], s80 offen sc1
    ds_read_b64_tr_b16 v[96:97], v17 offset:40064
    ds_read_b64_tr_b16 v[98:99], v17 offset:40832
    ds_read_b64_tr_b16 v[102:103], v18 offset:37632
    s_waitcnt lgkmcnt(8)
    v_mfma_f32_32x32x16_bf16 v[20:35], v[88:91], v[72:75], v[20:35]
    s_waitcnt lgkmcnt(7)
    buffer_store_dwordx4 v[132:135], v221, s[36:39], s80 offen sc1
    ds_read_b128 v[68:71], v11 offset:49152
    buffer_load_dwordx4 v5, s[8:11], s73 offen offset:3072 lds
    ds_read_b64_tr_b16 v[76:77], v17 offset:43008
    ds_read_b64_tr_b16 v[78:79], v17 offset:43776
    s_waitcnt lgkmcnt(7)
    v_mfma_f32_32x32x16_bf16 v[36:51], v[92:95], v[72:75], v[36:51]
    buffer_store_dwordx4 v[136:139], v222, s[36:39], s80 offen sc1
    ds_read_b64_tr_b16 v[80:81], v17 offset:43072
    ds_read_b64_tr_b16 v[82:83], v17 offset:43840
    s_waitcnt lgkmcnt(6)
    v_mfma_f32_32x32x16_bf16 v[52:67], v[96:99], v[72:75], v[52:67]
    buffer_store_dwordx2 v[116:117], v122, s[36:39], 0 offen sc1
    buffer_store_dwordx4 a[0:3], v123, s[36:39], s78 offen offset:0 sc1
    ds_read_b64_tr_b16 v[84:85], v17 offset:43136
    s_add_u32 s73, s73, 128
    s_add_u32 m0, s76, 24576
    s_nop 0
    buffer_load_dwordx4 v6, s[20:23], s74 offen offset:0 lds
    ds_read_b64_tr_b16 v[86:87], v17 offset:43904
    s_waitcnt lgkmcnt(7)
    v_mfma_f32_32x32x16_bf16 a[208:223], a[196:199], v[100:103], a[208:223]
    buffer_store_dwordx4 a[4:7], v123, s[36:39], s78 offen offset:1024 sc1
    ds_read_b64_tr_b16 v[104:105], v18 offset:36928
    ds_read_b64_tr_b16 v[106:107], v18 offset:37696
    s_waitcnt lgkmcnt(6)
    v_mfma_f32_32x32x16_bf16 v[20:35], v[76:79], v[68:71], v[20:35]
    buffer_store_dwordx4 a[8:11], v123, s[36:39], s78 offen offset:2048 sc1
    ds_read_b128 v[72:75], v12 offset:49152
    ds_read_b64_tr_b16 v[88:89], v17 offset:46080
    buffer_load_dwordx4 v7, s[20:23], s74 offen offset:1024 lds
    ds_read_b64_tr_b16 v[90:91], v17 offset:46848
    s_waitcnt lgkmcnt(7)
    v_mfma_f32_32x32x16_bf16 v[36:51], v[80:83], v[68:71], v[36:51]
    buffer_store_dwordx4 a[12:15], v123, s[36:39], s78 offen offset:3072 sc1
    ds_read_b64_tr_b16 v[92:93], v17 offset:46144
    ds_read_b64_tr_b16 v[94:95], v17 offset:46912
    s_waitcnt lgkmcnt(7)
    v_mfma_f32_32x32x16_bf16 v[52:67], v[84:87], v[68:71], v[52:67]
    s_add_u32 s78, s78, 4096
    ds_read_b64_tr_b16 v[96:97], v17 offset:46208
    ds_read_b64_tr_b16 v[98:99], v17 offset:46976
    buffer_load_dwordx4 v8, s[20:23], s74 offen offset:2048 lds
    s_add_u32 s74, s74, 196608
    s_waitcnt lgkmcnt(7)
    v_mfma_f32_32x32x16_bf16 a[224:239], a[196:199], v[104:107], a[224:239]
    buffer_store_dwordx4 a[16:19], v123, s[36:39], s78 offen sc1
    ds_read_b64_tr_b16 v[108:109], v18 offset:36992
    ds_read_b64_tr_b16 v[110:111], v18 offset:37760
    s_waitcnt lgkmcnt(6)
    v_mfma_f32_32x32x16_bf16 v[20:35], v[88:91], v[72:75], v[20:35]
    s_waitcnt vmcnt(23)
    s_waitcnt lgkmcnt(0)
    s_barrier
    ds_read_b128 v[68:71], v9 offset:0
    ds_read_b64_tr_b16 v[76:77], v17 offset:0
    ds_read_b64_tr_b16 v[78:79], v17 offset:768
    v_mfma_f32_32x32x16_bf16 a[240:255], a[196:199], v[108:111], a[240:255]
    ds_read_b64_tr_b16 v[80:81], v17 offset:64
    ds_read_b64_tr_b16 v[82:83], v17 offset:832
    v_mfma_f32_32x32x16_bf16 v[36:51], v[92:95], v[72:75], v[36:51]
    ds_read_b64_tr_b16 v[84:85], v17 offset:128
    ds_read_b64_tr_b16 v[86:87], v17 offset:896
    v_mfma_f32_32x32x16_bf16 v[52:67], v[96:99], v[72:75], v[52:67]
    s_waitcnt lgkmcnt(4)
    v_mfma_f32_32x32x16_bf16 v[20:35], v[76:79], v[68:71], v[20:35]
    s_add_u32 m0, s75, 49152
    s_nop 0
    buffer_load_dwordx4 v2, s[8:11], s73 offen offset:0 lds
    s_waitcnt vmcnt(1)
    ds_read_b128 v[72:75], v10 offset:0
    ds_read_b64_tr_b16 v[88:89], v17 offset:3072
    ds_read_b64_tr_b16 v[90:91], v17 offset:3840
    s_waitcnt lgkmcnt(5)
    v_mfma_f32_32x32x16_bf16 v[36:51], v[80:83], v[68:71], v[36:51]
    ds_read_b64_tr_b16 v[92:93], v17 offset:3136
    ds_read_b64_tr_b16 v[94:95], v17 offset:3904
    ds_read_b64_tr_b16 v[100:101], v18 offset:0
    buffer_load_dwordx4 v3, s[8:11], s73 offen offset:1024 lds
    s_waitcnt lgkmcnt(6)
    v_mfma_f32_32x32x16_bf16 v[52:67], v[84:87], v[68:71], v[52:67]
    ds_read_b64_tr_b16 v[96:97], v17 offset:3200
    ds_read_b64_tr_b16 v[98:99], v17 offset:3968
    ds_read_b64_tr_b16 v[102:103], v18 offset:768
    s_waitcnt lgkmcnt(6)
    v_mfma_f32_32x32x16_bf16 v[20:35], v[88:91], v[72:75], v[20:35]
    ds_read_b128 v[68:71], v11 offset:0
    ds_read_b64_tr_b16 v[76:77], v17 offset:6144
    ds_read_b64_tr_b16 v[78:79], v17 offset:6912
    buffer_load_dwordx4 v4, s[8:11], s73 offen offset:2048 lds
    s_waitcnt lgkmcnt(7)
    v_mfma_f32_32x32x16_bf16 v[36:51], v[92:95], v[72:75], v[36:51]
    ds_read_b64_tr_b16 v[80:81], v17 offset:6208
    ds_read_b64_tr_b16 v[82:83], v17 offset:6976
    s_waitcnt lgkmcnt(6)
    v_mfma_f32_32x32x16_bf16 v[52:67], v[96:99], v[72:75], v[52:67]
    buffer_load_dwordx4 v5, s[8:11], s73 offen offset:3072 lds
    ds_read_b64_tr_b16 v[84:85], v17 offset:6272
    ds_read_b64_tr_b16 v[86:87], v17 offset:7040
    s_waitcnt lgkmcnt(7)
    v_mfma_f32_32x32x16_bf16 a[208:223], a[196:199], v[100:103], a[208:223]
    ds_read_b64_tr_b16 v[104:105], v18 offset:64
    ds_read_b64_tr_b16 v[106:107], v18 offset:832
    s_add_u32 s73, s73, 128
    s_add_u32 m0, s76, 36864
    s_nop 0
    buffer_load_dwordx4 v6, s[20:23], s74 offen offset:0 lds
    s_waitcnt lgkmcnt(6)
    v_mfma_f32_32x32x16_bf16 v[20:35], v[76:79], v[68:71], v[20:35]
    ds_read_b128 v[72:75], v12 offset:0
    ds_read_b64_tr_b16 v[88:89], v17 offset:9216
    ds_read_b64_tr_b16 v[90:91], v17 offset:9984
    s_waitcnt lgkmcnt(7)
    v_mfma_f32_32x32x16_bf16 v[36:51], v[80:83], v[68:71], v[36:51]
    ds_read_b64_tr_b16 v[92:93], v17 offset:9280
    ds_read_b64_tr_b16 v[94:95], v17 offset:10048
    buffer_load_dwordx4 v7, s[20:23], s74 offen offset:1024 lds
    s_waitcnt lgkmcnt(7)
    v_mfma_f32_32x32x16_bf16 v[52:67], v[84:87], v[68:71], v[52:67]
    ds_read_b64_tr_b16 v[96:97], v17 offset:9344
    ds_read_b64_tr_b16 v[98:99], v17 offset:10112
    s_waitcnt lgkmcnt(7)
    v_mfma_f32_32x32x16_bf16 a[224:239], a[196:199], v[104:107], a[224:239]
    buffer_load_dwordx4 v8, s[20:23], s74 offen offset:2048 lds
    s_add_u32 s74, s74, 196608
    ds_read_b64_tr_b16 v[108:109], v18 offset:128
    ds_read_b64_tr_b16 v[110:111], v18 offset:896
    s_waitcnt lgkmcnt(6)
    v_mfma_f32_32x32x16_bf16 v[20:35], v[88:91], v[72:75], v[20:35]
    s_waitcnt lgkmcnt(0)
    s_barrier
    ds_read_b128 v[68:71], v9 offset:16384
    ds_read_b64_tr_b16 v[76:77], v17 offset:12288
    ds_read_b64_tr_b16 v[78:79], v17 offset:13056
    v_mfma_f32_32x32x16_bf16 a[240:255], a[196:199], v[108:111], a[240:255]
    ds_read_b64_tr_b16 v[80:81], v17 offset:12352
    ds_read_b64_tr_b16 v[82:83], v17 offset:13120
    v_mfma_f32_32x32x16_bf16 v[36:51], v[92:95], v[72:75], v[36:51]
    ds_read_b64_tr_b16 v[84:85], v17 offset:12416
    ds_read_b64_tr_b16 v[86:87], v17 offset:13184
    v_mfma_f32_32x32x16_bf16 v[52:67], v[96:99], v[72:75], v[52:67]
    s_waitcnt lgkmcnt(4)
    v_mfma_f32_32x32x16_bf16 v[20:35], v[76:79], v[68:71], v[20:35]
    s_add_u32 m0, s75, 0
    s_nop 0
    buffer_load_dwordx4 v2, s[8:11], s73 offen offset:0 lds
    s_mov_b32 s80, s2
    s_lshl_b32 s80, s80, 6
    s_add_u32 s80, s80, 4096
    ds_read_b128 v[72:75], v10 offset:16384
    ds_read_b64_tr_b16 v[88:89], v17 offset:15360
    ds_read_b64_tr_b16 v[90:91], v17 offset:16128
    s_waitcnt lgkmcnt(5)
    v_mfma_f32_32x32x16_bf16 v[36:51], v[80:83], v[68:71], v[36:51]
    v_mov_b32 v124, s80
    v_mov_b32 v125, 2147483648
    ds_read_b64_tr_b16 v[92:93], v17 offset:15424
    ds_read_b64_tr_b16 v[94:95], v17 offset:16192
    ds_read_b64_tr_b16 v[100:101], v18 offset:12288
    buffer_load_dwordx4 v3, s[8:11], s73 offen offset:1024 lds
    s_waitcnt lgkmcnt(6)
    v_mfma_f32_32x32x16_bf16 v[52:67], v[84:87], v[68:71], v[52:67]
    v_cmp_eq_u32 vcc, 0, v0
    s_nop 1
    v_cndmask_b32 v124, v125, v124, vcc
    v_mov_b32 v125, s5
    ds_read_b64_tr_b16 v[96:97], v17 offset:15488
    ds_read_b64_tr_b16 v[98:99], v17 offset:16256
    ds_read_b64_tr_b16 v[102:103], v18 offset:13056
    s_waitcnt lgkmcnt(6)
    v_mfma_f32_32x32x16_bf16 v[20:35], v[88:91], v[72:75], v[20:35]
    buffer_store_dword v125, v124, s[36:39], 0 offen sc1
    ds_read_b128 v[68:71], v11 offset:16384
    ds_read_b64_tr_b16 v[76:77], v17 offset:18432
    buffer_load_dwordx4 v4, s[8:11], s73 offen offset:2048 lds
    ds_read_b64_tr_b16 v[78:79], v17 offset:19200
    s_waitcnt lgkmcnt(7)
    v_mfma_f32_32x32x16_bf16 v[36:51], v[92:95], v[72:75], v[36:51]
    s_mul_i32 s80, s69, 192
    ds_read_b64_tr_b16 v[80:81], v17 offset:18496
    ds_read_b64_tr_b16 v[82:83], v17 offset:19264
    s_waitcnt lgkmcnt(6)
    v_mfma_f32_32x32x16_bf16 v[52:67], v[96:99], v[72:75], v[52:67]
    buffer_load_dwordx4 v5, s[8:11], s73 offen offset:3072 lds
    v_and_b32 v121, 31, v1
    v_lshl_add_u32 v121, v121, 1, s80
    ds_read_b64_tr_b16 v[84:85], v17 offset:18560
    ds_read_b64_tr_b16 v[86:87], v17 offset:19328
    s_waitcnt lgkmcnt(7)
    v_mfma_f32_32x32x16_bf16 a[208:223], a[196:199], v[100:103], a[208:223]
    global_load_ushort v118, v121, s[56:57]
    ds_read_b64_tr_b16 v[104:105], v18 offset:12352
    ds_read_b64_tr_b16 v[106:107], v18 offset:13120
    s_add_u32 s73, s73, 128
    s_add_u32 m0, s76, 0
    s_nop 0
    buffer_load_dwordx4 v6, s[20:23], s74 offen offset:0 lds
    s_waitcnt lgkmcnt(6)
    v_mfma_f32_32x32x16_bf16 v[20:35], v[76:79], v[68:71], v[20:35]
    global_load_ushort v119, v121, s[56:57] offset:64
    ds_read_b128 v[72:75], v12 offset:16384
    ds_read_b64_tr_b16 v[88:89], v17 offset:21504
    ds_read_b64_tr_b16 v[90:91], v17 offset:22272
    s_waitcnt lgkmcnt(7)
    v_mfma_f32_32x32x16_bf16 v[36:51], v[80:83], v[68:71], v[36:51]
    ds_read_b64_tr_b16 v[92:93], v17 offset:21568
    ds_read_b64_tr_b16 v[94:95], v17 offset:22336
    buffer_load_dwordx4 v7, s[20:23], s74 offen offset:1024 lds
    s_waitcnt lgkmcnt(7)
    v_mfma_f32_32x32x16_bf16 v[52:67], v[84:87], v[68:71], v[52:67]
    global_load_ushort v120, v121, s[56:57] offset:128
    ds_read_b64_tr_b16 v[96:97], v17 offset:21632
    ds_read_b64_tr_b16 v[98:99], v17 offset:22400
    s_waitcnt lgkmcnt(7)
    v_mfma_f32_32x32x16_bf16 a[224:239], a[196:199], v[104:107], a[224:239]
    buffer_load_dwordx4 v8, s[20:23], s74 offen offset:2048 lds
    s_add_u32 s74, s74, 196608
    ds_read_b64_tr_b16 v[108:109], v18 offset:12416
    ds_read_b64_tr_b16 v[110:111], v18 offset:13184
    s_waitcnt lgkmcnt(6)
    v_mfma_f32_32x32x16_bf16 v[20:35], v[88:91], v[72:75], v[20:35]
    s_waitcnt lgkmcnt(0)
    s_barrier
    ds_read_b128 v[68:71], v9 offset:32768
    ds_read_b64_tr_b16 v[76:77], v17 offset:24576
    ds_read_b64_tr_b16 v[78:79], v17 offset:25344
    v_mfma_f32_32x32x16_bf16 a[240:255], a[196:199], v[108:111], a[240:255]
    ds_read_b64_tr_b16 v[80:81], v17 offset:24640
    ds_read_b64_tr_b16 v[82:83], v17 offset:25408
    v_mfma_f32_32x32x16_bf16 v[36:51], v[92:95], v[72:75], v[36:51]
    ds_read_b64_tr_b16 v[84:85], v17 offset:24704
    ds_read_b64_tr_b16 v[86:87], v17 offset:25472
    v_mfma_f32_32x32x16_bf16 v[52:67], v[96:99], v[72:75], v[52:67]
    s_waitcnt lgkmcnt(4)
    v_mfma_f32_32x32x16_bf16 v[20:35], v[76:79], v[68:71], v[20:35]
    s_add_u32 m0, s75, 16384
    s_nop 0
    buffer_load_dwordx4 v2, s[8:11], s73 offen offset:0 lds
    ds_read_b128 v[72:75], v10 offset:32768
    ds_read_b64_tr_b16 v[88:89], v17 offset:27648
    ds_read_b64_tr_b16 v[90:91], v17 offset:28416
    s_waitcnt lgkmcnt(5)
    v_mfma_f32_32x32x16_bf16 v[36:51], v[80:83], v[68:71], v[36:51]
    ds_read_b64_tr_b16 v[92:93], v17 offset:27712
    ds_read_b64_tr_b16 v[94:95], v17 offset:28480
    ds_read_b64_tr_b16 v[100:101], v18 offset:24576
    buffer_load_dwordx4 v3, s[8:11], s73 offen offset:1024 lds
    s_waitcnt lgkmcnt(6)
    v_mfma_f32_32x32x16_bf16 v[52:67], v[84:87], v[68:71], v[52:67]
    ds_read_b64_tr_b16 v[96:97], v17 offset:27776
    ds_read_b64_tr_b16 v[98:99], v17 offset:28544
    ds_read_b64_tr_b16 v[102:103], v18 offset:25344
    s_waitcnt lgkmcnt(6)
    v_mfma_f32_32x32x16_bf16 v[20:35], v[88:91], v[72:75], v[20:35]
    ds_read_b128 v[68:71], v11 offset:32768
    ds_read_b64_tr_b16 v[76:77], v17 offset:30720
    ds_read_b64_tr_b16 v[78:79], v17 offset:31488
    buffer_load_dwordx4 v4, s[8:11], s73 offen offset:2048 lds
    s_waitcnt lgkmcnt(7)
    v_mfma_f32_32x32x16_bf16 v[36:51], v[92:95], v[72:75], v[36:51]
    ds_read_b64_tr_b16 v[80:81], v17 offset:30784
    ds_read_b64_tr_b16 v[82:83], v17 offset:31552
    s_waitcnt lgkmcnt(6)
    v_mfma_f32_32x32x16_bf16 v[52:67], v[96:99], v[72:75], v[52:67]
    buffer_load_dwordx4 v5, s[8:11], s73 offen offset:3072 lds
    ds_read_b64_tr_b16 v[84:85], v17 offset:30848
    ds_read_b64_tr_b16 v[86:87], v17 offset:31616
    s_waitcnt lgkmcnt(7)
    v_mfma_f32_32x32x16_bf16 a[208:223], a[196:199], v[100:103], a[208:223]
    ds_read_b64_tr_b16 v[104:105], v18 offset:24640
    ds_read_b64_tr_b16 v[106:107], v18 offset:25408
    s_add_u32 s73, s73, 128
    s_add_u32 m0, s76, 12288
    s_nop 0
    buffer_load_dwordx4 v6, s[20:23], s74 offen offset:0 lds
    s_waitcnt lgkmcnt(6)
    v_mfma_f32_32x32x16_bf16 v[20:35], v[76:79], v[68:71], v[20:35]
    ds_read_b128 v[72:75], v12 offset:32768
    ds_read_b64_tr_b16 v[88:89], v17 offset:33792
    ds_read_b64_tr_b16 v[90:91], v17 offset:34560
    s_waitcnt lgkmcnt(7)
    v_mfma_f32_32x32x16_bf16 v[36:51], v[80:83], v[68:71], v[36:51]
    ds_read_b64_tr_b16 v[92:93], v17 offset:33856
    ds_read_b64_tr_b16 v[94:95], v17 offset:34624
    buffer_load_dwordx4 v7, s[20:23], s74 offen offset:1024 lds
    s_waitcnt lgkmcnt(7)
    v_mfma_f32_32x32x16_bf16 v[52:67], v[84:87], v[68:71], v[52:67]
    ds_read_b64_tr_b16 v[96:97], v17 offset:33920
    ds_read_b64_tr_b16 v[98:99], v17 offset:34688
    s_waitcnt lgkmcnt(7)
    v_mfma_f32_32x32x16_bf16 a[224:239], a[196:199], v[104:107], a[224:239]
    buffer_load_dwordx4 v8, s[20:23], s74 offen offset:2048 lds
    s_add_u32 s74, s74, 196608
    ds_read_b64_tr_b16 v[108:109], v18 offset:24704
    ds_read_b64_tr_b16 v[110:111], v18 offset:25472
    s_waitcnt lgkmcnt(6)
    v_mfma_f32_32x32x16_bf16 v[20:35], v[88:91], v[72:75], v[20:35]
    s_waitcnt vmcnt(18)
    s_waitcnt lgkmcnt(0)
    s_barrier
    ds_read_b128 v[68:71], v9 offset:49152
    ds_read_b64_tr_b16 v[76:77], v17 offset:36864
    ds_read_b64_tr_b16 v[78:79], v17 offset:37632
    v_mfma_f32_32x32x16_bf16 a[240:255], a[196:199], v[108:111], a[240:255]
    ds_read_b64_tr_b16 v[80:81], v17 offset:36928
    ds_read_b64_tr_b16 v[82:83], v17 offset:37696
    v_mfma_f32_32x32x16_bf16 v[36:51], v[92:95], v[72:75], v[36:51]
    ds_read_b64_tr_b16 v[84:85], v17 offset:36992
    ds_read_b64_tr_b16 v[86:87], v17 offset:37760
    v_mfma_f32_32x32x16_bf16 v[52:67], v[96:99], v[72:75], v[52:67]
    s_waitcnt lgkmcnt(4)
    v_mfma_f32_32x32x16_bf16 v[20:35], v[76:79], v[68:71], v[20:35]
    s_mul_i32 s80, s71, 12
    s_mul_i32 s81, s4, 3
    s_add_u32 s80, s80, s81
    ds_read_b128 v[72:75], v10 offset:49152
    ds_read_b64_tr_b16 v[88:89], v17 offset:39936
    ds_read_b64_tr_b16 v[90:91], v17 offset:40704
    s_waitcnt lgkmcnt(5)
    v_mfma_f32_32x32x16_bf16 v[36:51], v[80:83], v[68:71], v[36:51]
    s_add_u32 s80, s80, 160
    v_min_u32 v126, 2, v1
    ds_read_b64_tr_b16 v[92:93], v17 offset:40000
    ds_read_b64_tr_b16 v[94:95], v17 offset:40768
    ds_read_b64_tr_b16 v[100:101], v18 offset:36864
    s_waitcnt lgkmcnt(6)
    v_mfma_f32_32x32x16_bf16 v[52:67], v[84:87], v[68:71], v[52:67]
    v_add_u32 v126, s80, v126
    s_lshl_b32 s80, s68, 7
    ds_read_b64_tr_b16 v[96:97], v17 offset:40064
    ds_read_b64_tr_b16 v[98:99], v17 offset:40832
    ds_read_b64_tr_b16 v[102:103], v18 offset:37632
    s_waitcnt lgkmcnt(6)
    v_mfma_f32_32x32x16_bf16 v[20:35], v[88:91], v[72:75], v[20:35]
    s_lshl_b32 s81, s4, 5
    s_add_u32 s80, s80, s81
    ds_read_b128 v[68:71], v11 offset:49152
    ds_read_b64_tr_b16 v[76:77], v17 offset:43008
    ds_read_b64_tr_b16 v[78:79], v17 offset:43776
    s_waitcnt lgkmcnt(7)
    v_mfma_f32_32x32x16_bf16 v[36:51], v[92:95], v[72:75], v[36:51]
    s_and_b32 s81, s80, 0xf8
    s_lshr_b32 s80, s80, 8
    ds_read_b64_tr_b16 v[80:81], v17 offset:43072
    ds_read_b64_tr_b16 v[82:83], v17 offset:43840
    s_waitcnt lgkmcnt(6)
    v_mfma_f32_32x32x16_bf16 v[52:67], v[96:99], v[72:75], v[52:67]
    s_add_u32 s80, s80, s81
    v_and_b32 v127, 3, v1
    v_lshlrev_b32 v127, 3, v127
    ds_read_b64_tr_b16 v[84:85], v17 offset:43136
    ds_read_b64_tr_b16 v[86:87], v17 offset:43904
    s_waitcnt lgkmcnt(7)
    v_mfma_f32_32x32x16_bf16 a[208:223], a[196:199], v[100:103], a[208:223]
    v_add_u32 v127, s80, v127
    v_lshrrev_b32 v125, 2, v1
    ds_read_b64_tr_b16 v[104:105], v18 offset:36928
    ds_read_b64_tr_b16 v[106:107], v18 offset:37696
    s_waitcnt lgkmcnt(6)
    v_mfma_f32_32x32x16_bf16 v[20:35], v[76:79], v[68:71], v[20:35]
    v_cmp_eq_u32 vcc, 1, v125
    s_nop 1
    v_cndmask_b32 v126, v126, v127, vcc
    ds_read_b128 v[72:75], v12 offset:49152
    ds_read_b64_tr_b16 v[88:89], v17 offset:46080
    ds_read_b64_tr_b16 v[90:91], v17 offset:46848
    s_waitcnt lgkmcnt(7)
    v_mfma_f32_32x32x16_bf16 v[36:51], v[80:83], v[68:71], v[36:51]
    v_lshlrev_b32 v126, 6, v126
    v_add_u32 v126, 4096, v126
    ds_read_b64_tr_b16 v[92:93], v17 offset:46144
    ds_read_b64_tr_b16 v[94:95], v17 offset:46912
    s_waitcnt lgkmcnt(7)
    v_mfma_f32_32x32x16_bf16 v[52:67], v[84:87], v[68:71], v[52:67]
    buffer_load_dword v127, v126, s[36:39], 0 offen sc1
    ds_read_b64_tr_b16 v[96:97], v17 offset:46208
    ds_read_b64_tr_b16 v[98:99], v17 offset:46976
    s_waitcnt lgkmcnt(7)
    v_mfma_f32_32x32x16_bf16 a[224:239], a[196:199], v[104:107], a[224:239]
    ds_read_b64_tr_b16 v[108:109], v18 offset:36992
    ds_read_b64_tr_b16 v[110:111], v18 offset:37760
    s_waitcnt lgkmcnt(6)
    v_mfma_f32_32x32x16_bf16 v[20:35], v[88:91], v[72:75], v[20:35]
    s_waitcnt vmcnt(8)
    s_waitcnt lgkmcnt(0)
    s_barrier
    ds_read_b128 v[68:71], v9 offset:0
    ds_read_b64_tr_b16 v[76:77], v17 offset:0
    ds_read_b64_tr_b16 v[78:79], v17 offset:768
    v_mfma_f32_32x32x16_bf16 a[240:255], a[196:199], v[108:111], a[240:255]
    ds_read_b64_tr_b16 v[80:81], v17 offset:64
    ds_read_b64_tr_b16 v[82:83], v17 offset:832
    v_mfma_f32_32x32x16_bf16 v[36:51], v[92:95], v[72:75], v[36:51]
    ds_read_b64_tr_b16 v[84:85], v17 offset:128
    ds_read_b64_tr_b16 v[86:87], v17 offset:896
    v_mfma_f32_32x32x16_bf16 v[52:67], v[96:99], v[72:75], v[52:67]
    s_waitcnt lgkmcnt(4)
    v_mfma_f32_32x32x16_bf16 v[20:35], v[76:79], v[68:71], v[20:35]
    s_waitcnt vmcnt(0)
    v_cmp_ne_u32 vcc, s5, v127
    s_nop 0
    s_cbranch_vccnz LB_slowp1
LB_backp2:
    ds_read_b128 v[72:75], v10 offset:0
    ds_read_b64_tr_b16 v[88:89], v17 offset:3072
    ds_read_b64_tr_b16 v[90:91], v17 offset:3840
    s_waitcnt lgkmcnt(5)
    v_mfma_f32_32x32x16_bf16 v[36:51], v[80:83], v[68:71], v[36:51]
    s_mul_i32 s78, s71, 245760
    s_mul_i32 s80, s4, 61440
    ds_read_b64_tr_b16 v[92:93], v17 offset:3136
    ds_read_b64_tr_b16 v[94:95], v17 offset:3904
    ds_read_b64_tr_b16 v[100:101], v18 offset:0
    s_waitcnt lgkmcnt(6)
    v_mfma_f32_32x32x16_bf16 v[52:67], v[84:87], v[68:71], v[52:67]
    s_add_u32 s78, s78, s80
    ds_read_b64_tr_b16 v[96:97], v17 offset:3200
    ds_read_b64_tr_b16 v[98:99], v17 offset:3968
    ds_read_b64_tr_b16 v[102:103], v18 offset:768
    s_waitcnt lgkmcnt(6)
    v_mfma_f32_32x32x16_bf16 v[20:35], v[88:91], v[72:75], v[20:35]
    s_add_u32 s78, s78, 16777216
    v_lshlrev_b32 v139, 4, v1
    ds_read_b128 v[68:71], v11 offset:0
    ds_read_b64_tr_b16 v[76:77], v17 offset:6144
    ds_read_b64_tr_b16 v[78:79], v17 offset:6912
    s_waitcnt lgkmcnt(7)
    v_mfma_f32_32x32x16_bf16 v[36:51], v[92:95], v[72:75], v[36:51]
    s_lshl_b32 s80, s68, 7
    s_lshl_b32 s81, s4, 5
    ds_read_b64_tr_b16 v[80:81], v17 offset:6208
    ds_read_b64_tr_b16 v[82:83], v17 offset:6976
    s_waitcnt lgkmcnt(6)
    v_mfma_f32_32x32x16_bf16 v[52:67], v[96:99], v[72:75], v[52:67]
    s_add_u32 s80, s80, s81
    ds_read_b64_tr_b16 v[84:85], v17 offset:6272
    ds_read_b64_tr_b16 v[86:87], v17 offset:7040
    s_waitcnt lgkmcnt(7)
    v_mfma_f32_32x32x16_bf16 a[208:223], a[196:199], v[100:103], a[208:223]
    v_and_b32 v126, 31, v1
    v_add_u32 v126, s80, v126
    ds_read_b64_tr_b16 v[104:105], v18 offset:64
    ds_read_b64_tr_b16 v[106:107], v18 offset:832
    s_waitcnt lgkmcnt(6)
    v_mfma_f32_32x32x16_bf16 v[20:35], v[76:79], v[68:71], v[20:35]
    v_lshlrev_b32 v126, 3, v126
    v_add_u32 v126, 65536, v126
    ds_read_b128 v[72:75], v12 offset:0
    ds_read_b64_tr_b16 v[88:89], v17 offset:9216
    ds_read_b64_tr_b16 v[90:91], v17 offset:9984
    s_waitcnt lgkmcnt(7)
    v_mfma_f32_32x32x16_bf16 v[36:51], v[80:83], v[68:71], v[36:51]
    buffer_load_dwordx2 v[116:117], v126, s[36:39], 0 offen sc1
    ds_read_b64_tr_b16 v[92:93], v17 offset:9280
    ds_read_b64_tr_b16 v[94:95], v17 offset:10048
    s_waitcnt lgkmcnt(7)
    v_mfma_f32_32x32x16_bf16 v[52:67], v[84:87], v[68:71], v[52:67]
    ds_read_b64_tr_b16 v[96:97], v17 offset:9344
    ds_read_b64_tr_b16 v[98:99], v17 offset:10112
    s_waitcnt lgkmcnt(7)
    v_mfma_f32_32x32x16_bf16 a[224:239], a[196:199], v[104:107], a[224:239]
    ds_read_b64_tr_b16 v[108:109], v18 offset:128
    ds_read_b64_tr_b16 v[110:111], v18 offset:896
    s_waitcnt lgkmcnt(6)
    v_mfma_f32_32x32x16_bf16 v[20:35], v[88:91], v[72:75], v[20:35]
    s_waitcnt lgkmcnt(0)
    s_barrier
    ds_read_b128 v[68:71], v9 offset:16384
    ds_read_b64_tr_b16 v[76:77], v17 offset:12288
    ds_read_b64_tr_b16 v[78:79], v17 offset:13056
    v_mfma_f32_32x32x16_bf16 a[240:255], a[196:199], v[108:111], a[240:255]
    ds_read_b64_tr_b16 v[80:81], v17 offset:12352
    ds_read_b64_tr_b16 v[82:83], v17 offset:13120
    v_mfma_f32_32x32x16_bf16 v[36:51], v[92:95], v[72:75], v[36:51]
    ds_read_b64_tr_b16 v[84:85], v17 offset:12416
    ds_read_b64_tr_b16 v[86:87], v17 offset:13184
    v_mfma_f32_32x32x16_bf16 v[52:67], v[96:99], v[72:75], v[52:67]
    s_waitcnt lgkmcnt(4)
    v_mfma_f32_32x32x16_bf16 v[20:35], v[76:79], v[68:71], v[20:35]
    ds_read_b128 v[72:75], v10 offset:16384
    buffer_load_dwordx4 a[0:3], v139, s[36:39], s78 offen offset:0 sc1
    ds_read_b64_tr_b16 v[88:89], v17 offset:15360
    ds_read_b64_tr_b16 v[90:91], v17 offset:16128
    s_waitcnt lgkmcnt(5)
    v_mfma_f32_32x32x16_bf16 v[36:51], v[80:83], v[68:71], v[36:51]
    ds_read_b64_tr_b16 v[92:93], v17 offset:15424
    ds_read_b64_tr_b16 v[94:95], v17 offset:16192
    ds_read_b64_tr_b16 v[100:101], v18 offset:12288
    s_waitcnt lgkmcnt(6)
    v_mfma_f32_32x32x16_bf16 v[52:67], v[84:87], v[68:71], v[52:67]
    ds_read_b64_tr_b16 v[96:97], v17 offset:15488
    buffer_load_dwordx4 a[4:7], v139, s[36:39], s78 offen offset:1024 sc1
    ds_read_b64_tr_b16 v[98:99], v17 offset:16256
    ds_read_b64_tr_b16 v[102:103], v18 offset:13056
    s_waitcnt lgkmcnt(6)
    v_mfma_f32_32x32x16_bf16 v[20:35], v[88:91], v[72:75], v[20:35]
    ds_read_b128 v[68:71], v11 offset:16384
    ds_read_b64_tr_b16 v[76:77], v17 offset:18432
    ds_read_b64_tr_b16 v[78:79], v17 offset:19200
    s_waitcnt lgkmcnt(7)
    v_mfma_f32_32x32x16_bf16 v[36:51], v[92:95], v[72:75], v[36:51]
    ds_read_b64_tr_b16 v[80:81], v17 offset:18496
    ds_read_b64_tr_b16 v[82:83], v17 offset:19264
    buffer_load_dwordx4 a[8:11], v139, s[36:39], s78 offen offset:2048 sc1
    s_waitcnt lgkmcnt(6)
    v_mfma_f32_32x32x16_bf16 v[52:67], v[96:99], v[72:75], v[52:67]
    ds_read_b64_tr_b16 v[84:85], v17 offset:18560
    ds_read_b64_tr_b16 v[86:87], v17 offset:19328
    s_waitcnt lgkmcnt(7)
    v_mfma_f32_32x32x16_bf16 a[208:223], a[196:199], v[100:103], a[208:223]
    ds_read_b64_tr_b16 v[104:105], v18 offset:12352
    ds_read_b64_tr_b16 v[106:107], v18 offset:13120
    buffer_load_dwordx4 a[12:15], v139, s[36:39], s78 offen offset:3072 sc1
    s_waitcnt lgkmcnt(6)
    v_mfma_f32_32x32x16_bf16 v[20:35], v[76:79], v[68:71], v[20:35]
    ds_read_b128 v[72:75], v12 offset:16384
    ds_read_b64_tr_b16 v[88:89], v17 offset:21504
    ds_read_b64_tr_b16 v[90:91], v17 offset:22272
    s_waitcnt lgkmcnt(7)
    v_mfma_f32_32x32x16_bf16 v[36:51], v[80:83], v[68:71], v[36:51]
    ds_read_b64_tr_b16 v[92:93], v17 offset:21568
    ds_read_b64_tr_b16 v[94:95], v17 offset:22336
    s_add_u32 s78, s78, 4096
    buffer_load_dwordx4 a[16:19], v139, s[36:39], s78 offen offset:0 sc1
    s_waitcnt lgkmcnt(7)
    v_mfma_f32_32x32x16_bf16 v[52:67], v[84:87], v[68:71], v[52:67]
    ds_read_b64_tr_b16 v[96:97], v17 offset:21632
    ds_read_b64_tr_b16 v[98:99], v17 offset:22400
    s_waitcnt lgkmcnt(7)
    v_mfma_f32_32x32x16_bf16 a[224:239], a[196:199], v[104:107], a[224:239]
    ds_read_b64_tr_b16 v[108:109], v18 offset:12416
    ds_read_b64_tr_b16 v[110:111], v18 offset:13184
    buffer_load_dwordx4 a[20:23], v139, s[36:39], s78 offen offset:1024 sc1
    s_waitcnt lgkmcnt(6)
    v_mfma_f32_32x32x16_bf16 v[20:35], v[88:91], v[72:75], v[20:35]
    s_waitcnt lgkmcnt(0)
    v_mfma_f32_32x32x16_bf16 a[240:255], a[196:199], v[108:111], a[240:255]
    buffer_load_dwordx4 a[24:27], v139, s[36:39], s78 offen offset:2048 sc1
    v_mfma_f32_32x32x16_bf16 v[36:51], v[92:95], v[72:75], v[36:51]
    v_mfma_f32_32x32x16_bf16 v[52:67], v[96:99], v[72:75], v[52:67]
    v_and_b32 v94, 31, v1
    v_lshlrev_b32 v94, 2, v94
    v_add_u32 v94, 160768, v94
    s_mul_i32 s80, s4, 384
    v_add_u32 v95, s80, v94
    v_accvgpr_read_b32 v112, a208
    v_accvgpr_read_b32 v113, a224
    s_nop 1
    v_accvgpr_read_b32 v114, a240
    ds_write_b32 v95, v112 offset:0
    ds_write_b32 v95, v113 offset:128
    ds_write_b32 v95, v114 offset:256
    s_waitcnt lgkmcnt(0)
    s_barrier
    ds_read_b32 v100, v94 offset:0
    ds_read_b32 v101, v94 offset:128
    ds_read_b32 v102, v94 offset:256
    ds_read_b32 v103, v94 offset:384
    ds_read_b32 v104, v94 offset:512
    ds_read_b32 v105, v94 offset:640
    ds_read_b32 v106, v94 offset:768
    ds_read_b32 v107, v94 offset:896
    ds_read_b32 v108, v94 offset:1024
    ds_read_b32 v109, v94 offset:1152
    ds_read_b32 v110, v94 offset:1280
    ds_read_b32 v111, v94 offset:1408
    v_cmp_gt_u32 vcc, 32, v1
    s_waitcnt vmcnt(7)
    v_rcp_f32 v92, v117
    v_xor_b32 v88, 0x80000000, v116
    v_lshrrev_b32 v89, 16, v88
    v_or_b32 v88, v88, v89
    v_lshrrev_b32 v89, 16, v117
    v_mov_b32 v90, 0
    v_mov_b32 v91, 0
    s_waitcnt lgkmcnt(8)
    v_add_f32 v112, v100, v103
    s_waitcnt lgkmcnt(2)
    v_add_f32 v76, v106, v109
    v_add_f32 v112, v112, v76
    v_cvt_pk_bf16_f32 v76, v112, v112
    v_lshlrev_b32 v77, 16, v76
    v_sub_f32 v77, v112, v77
    v_cvt_pk_bf16_f32 v76, v112, v77
    v_cndmask_b32 v76, 0, v76, vcc
    v_cndmask_b32 v77, 0, v118, vcc
    v_mov_b32 v78, 0
    v_mov_b32 v79, 0
    s_nop 1
    v_mfma_f32_32x32x16_bf16 v[20:35], v[76:79], v[88:91], v[20:35]
    v_add_f32 v113, v101, v104
    s_waitcnt lgkmcnt(1)
    v_add_f32 v80, v107, v110
    v_add_f32 v113, v113, v80
    v_cvt_pk_bf16_f32 v80, v113, v113
    v_lshlrev_b32 v81, 16, v80
    v_sub_f32 v81, v113, v81
    v_cvt_pk_bf16_f32 v80, v113, v81
    v_cndmask_b32 v80, 0, v80, vcc
    v_cndmask_b32 v81, 0, v119, vcc
    v_mov_b32 v82, 0
    v_mov_b32 v83, 0
    s_nop 1
    v_mfma_f32_32x32x16_bf16 v[36:51], v[80:83], v[88:91], v[36:51]
    v_add_f32 v114, v102, v105
    s_waitcnt lgkmcnt(0)
    v_add_f32 v84, v108, v111
    v_add_f32 v114, v114, v84
    v_cvt_pk_bf16_f32 v84, v114, v114
    v_lshlrev_b32 v85, 16, v84
    v_sub_f32 v85, v114, v85
    v_cvt_pk_bf16_f32 v84, v114, v85
    v_cndmask_b32 v84, 0, v84, vcc
    v_cndmask_b32 v85, 0, v120, vcc
    v_mov_b32 v86, 0
    v_mov_b32 v87, 0
    s_nop 1
    v_mfma_f32_32x32x16_bf16 v[52:67], v[84:87], v[88:91], v[52:67]
    s_lshl_b32 s80, s68, 3
    s_lshl_b32 s81, s4, 1
    s_add_u32 s80, s80, s81
    s_mul_i32 s80, s80, 49152
    s_mul_i32 s81, s69, 3072
    s_add_u32 s80, s80, s81
    s_add_u32 s84, s80, 8388608
    v_bfe_u32 v94, v1, 4, 1
    v_mul_u32_u24 v94, 49152, v94
    v_lshrrev_b32 v95, 5, v1
    v_lshl_add_u32 v94, v95, 8, v94
    v_and_b32 v95, 15, v1
    v_lshl_add_u32 v94, v95, 4, v94
    buffer_load_dwordx4 a[28:31], v139, s[36:39], s78 offen offset:3072 sc1
    v_max_f32 v20, 0, v20
    v_max_f32 v21, 0, v21
    v_pk_mul_f32 v[20:21], v[20:21], v[92:93] op_sel_hi:[1,0]
    v_pk_mul_f32 v[20:21], v[20:21], v[20:21]
    v_max_f32 v22, 0, v22
    v_max_f32 v23, 0, v23
    v_pk_mul_f32 v[22:23], v[22:23], v[92:93] op_sel_hi:[1,0]
    v_pk_mul_f32 v[22:23], v[22:23], v[22:23]
    v_max_f32 v24, 0, v24
    v_max_f32 v25, 0, v25
    v_pk_mul_f32 v[24:25], v[24:25], v[92:93] op_sel_hi:[1,0]
    v_pk_mul_f32 v[24:25], v[24:25], v[24:25]
    v_max_f32 v26, 0, v26
    v_max_f32 v27, 0, v27
    v_pk_mul_f32 v[26:27], v[26:27], v[92:93] op_sel_hi:[1,0]
    v_pk_mul_f32 v[26:27], v[26:27], v[26:27]
    v_cvt_pk_bf16_f32 v20, v20, v21
    v_cvt_pk_bf16_f32 v21, v22, v23
    v_cvt_pk_bf16_f32 v22, v24, v25
    v_cvt_pk_bf16_f32 v23, v26, v27
    buffer_store_dwordx4 v[20:23], v94, s[36:39], s84 offen offset:0 sc1
    s_add_u32 s78, s78, 4096
    buffer_load_dwordx4 a[32:35], v139, s[36:39], s78 offen offset:0 sc1
    v_max_f32 v28, 0, v28
    v_max_f32 v29, 0, v29
    v_pk_mul_f32 v[28:29], v[28:29], v[92:93] op_sel_hi:[1,0]
    v_pk_mul_f32 v[28:29], v[28:29], v[28:29]
    v_max_f32 v30, 0, v30
    v_max_f32 v31, 0, v31
    v_pk_mul_f32 v[30:31], v[30:31], v[92:93] op_sel_hi:[1,0]
    v_pk_mul_f32 v[30:31], v[30:31], v[30:31]
    v_max_f32 v32, 0, v32
    v_max_f32 v33, 0, v33
    v_pk_mul_f32 v[32:33], v[32:33], v[92:93] op_sel_hi:[1,0]
    v_pk_mul_f32 v[32:33], v[32:33], v[32:33]
    v_max_f32 v34, 0, v34
    v_max_f32 v35, 0, v35
    v_pk_mul_f32 v[34:35], v[34:35], v[92:93] op_sel_hi:[1,0]
    v_pk_mul_f32 v[34:35], v[34:35], v[34:35]
    v_cvt_pk_bf16_f32 v28, v28, v29
    v_cvt_pk_bf16_f32 v29, v30, v31
    v_cvt_pk_bf16_f32 v30, v32, v33
    v_cvt_pk_bf16_f32 v31, v34, v35
    buffer_store_dwordx4 v[28:31], v94, s[36:39], s84 offen offset:512 sc1
    buffer_load_dwordx4 a[36:39], v139, s[36:39], s78 offen offset:1024 sc1
    v_max_f32 v36, 0, v36
    v_max_f32 v37, 0, v37
    v_pk_mul_f32 v[36:37], v[36:37], v[92:93] op_sel_hi:[1,0]
    v_pk_mul_f32 v[36:37], v[36:37], v[36:37]
    v_max_f32 v38, 0, v38
    v_max_f32 v39, 0, v39
    v_pk_mul_f32 v[38:39], v[38:39], v[92:93] op_sel_hi:[1,0]
    v_pk_mul_f32 v[38:39], v[38:39], v[38:39]
    v_max_f32 v40, 0, v40
    v_max_f32 v41, 0, v41
    v_pk_mul_f32 v[40:41], v[40:41], v[92:93] op_sel_hi:[1,0]
    v_pk_mul_f32 v[40:41], v[40:41], v[40:41]
    v_max_f32 v42, 0, v42
    v_max_f32 v43, 0, v43
    v_pk_mul_f32 v[42:43], v[42:43], v[92:93] op_sel_hi:[1,0]
    v_pk_mul_f32 v[42:43], v[42:43], v[42:43]
    v_cvt_pk_bf16_f32 v36, v36, v37
    v_cvt_pk_bf16_f32 v37, v38, v39
    v_cvt_pk_bf16_f32 v38, v40, v41
    v_cvt_pk_bf16_f32 v39, v42, v43
    buffer_store_dwordx4 v[36:39], v94, s[36:39], s84 offen offset:1024 sc1
    buffer_load_dwordx4 a[40:43], v139, s[36:39], s78 offen offset:2048 sc1
    v_max_f32 v44, 0, v44
    v_max_f32 v45, 0, v45
    v_pk_mul_f32 v[44:45], v[44:45], v[92:93] op_sel_hi:[1,0]
    v_pk_mul_f32 v[44:45], v[44:45], v[44:45]
    v_max_f32 v46, 0, v46
    v_max_f32 v47, 0, v47
    v_pk_mul_f32 v[46:47], v[46:47], v[92:93] op_sel_hi:[1,0]
    v_pk_mul_f32 v[46:47], v[46:47], v[46:47]
    v_max_f32 v48, 0, v48
    v_max_f32 v49, 0, v49
    v_pk_mul_f32 v[48:49], v[48:49], v[92:93] op_sel_hi:[1,0]
    v_pk_mul_f32 v[48:49], v[48:49], v[48:49]
    v_max_f32 v50, 0, v50
    v_max_f32 v51, 0, v51
    v_pk_mul_f32 v[50:51], v[50:51], v[92:93] op_sel_hi:[1,0]
    v_pk_mul_f32 v[50:51], v[50:51], v[50:51]
    v_cvt_pk_bf16_f32 v44, v44, v45
    v_cvt_pk_bf16_f32 v45, v46, v47
    v_cvt_pk_bf16_f32 v46, v48, v49
    v_cvt_pk_bf16_f32 v47, v50, v51
    buffer_store_dwordx4 v[44:47], v94, s[36:39], s84 offen offset:1536 sc1
    buffer_load_dwordx4 a[44:47], v139, s[36:39], s78 offen offset:3072 sc1
    v_max_f32 v52, 0, v52
    v_max_f32 v53, 0, v53
    v_pk_mul_f32 v[52:53], v[52:53], v[92:93] op_sel_hi:[1,0]
    v_pk_mul_f32 v[52:53], v[52:53], v[52:53]
    v_max_f32 v54, 0, v54
    v_max_f32 v55, 0, v55
    v_pk_mul_f32 v[54:55], v[54:55], v[92:93] op_sel_hi:[1,0]
    v_pk_mul_f32 v[54:55], v[54:55], v[54:55]
    v_max_f32 v56, 0, v56
    v_max_f32 v57, 0, v57
    v_pk_mul_f32 v[56:57], v[56:57], v[92:93] op_sel_hi:[1,0]
    v_pk_mul_f32 v[56:57], v[56:57], v[56:57]
    v_max_f32 v58, 0, v58
    v_max_f32 v59, 0, v59
    v_pk_mul_f32 v[58:59], v[58:59], v[92:93] op_sel_hi:[1,0]
    v_pk_mul_f32 v[58:59], v[58:59], v[58:59]
    v_cvt_pk_bf16_f32 v52, v52, v53
    v_cvt_pk_bf16_f32 v53, v54, v55
    v_cvt_pk_bf16_f32 v54, v56, v57
    v_cvt_pk_bf16_f32 v55, v58, v59
    buffer_store_dwordx4 v[52:55], v94, s[36:39], s84 offen offset:2048 sc1
    s_add_u32 s78, s78, 4096
    buffer_load_dwordx4 a[48:51], v139, s[36:39], s78 offen offset:0 sc1
    v_max_f32 v60, 0, v60
    v_max_f32 v61, 0, v61
    v_pk_mul_f32 v[60:61], v[60:61], v[92:93] op_sel_hi:[1,0]
    v_pk_mul_f32 v[60:61], v[60:61], v[60:61]
    v_max_f32 v62, 0, v62
    v_max_f32 v63, 0, v63
    v_pk_mul_f32 v[62:63], v[62:63], v[92:93] op_sel_hi:[1,0]
    v_pk_mul_f32 v[62:63], v[62:63], v[62:63]
    v_max_f32 v64, 0, v64
    v_max_f32 v65, 0, v65
    v_pk_mul_f32 v[64:65], v[64:65], v[92:93] op_sel_hi:[1,0]
    v_pk_mul_f32 v[64:65], v[64:65], v[64:65]
    v_max_f32 v66, 0, v66
    v_max_f32 v67, 0, v67
    v_pk_mul_f32 v[66:67], v[66:67], v[92:93] op_sel_hi:[1,0]
    v_pk_mul_f32 v[66:67], v[66:67], v[66:67]
    v_cvt_pk_bf16_f32 v60, v60, v61
    v_cvt_pk_bf16_f32 v61, v62, v63
    v_cvt_pk_bf16_f32 v62, v64, v65
    v_cvt_pk_bf16_f32 v63, v66, v67
    buffer_store_dwordx4 v[60:63], v94, s[36:39], s84 offen offset:2560 sc1
    v_lshlrev_b32 v8, 4, v1
    v_add_u32 v2, 0, v8
    v_add_u32 v3, 4096, v8
    v_add_u32 v4, 8192, v8
    s_mul_i32 s80, s4, 12288
    s_add_u32 s80, s80, 8388608
    s_lshl_b32 s81, s70, 2
    s_add_u32 s82, s4, 1
    s_and_b32 s82, s82, 3
    s_add_u32 s83, s81, s82
    s_mul_i32 s83, s83, 49152
    s_add_u32 s92, s83, s80
    s_mul_i32 s82, s82, 15360
    s_add_u32 s82, s82, 0
    v_add_u32 v5, s82, v8
    s_add_u32 s82, s4, 2
    s_and_b32 s82, s82, 3
    s_add_u32 s83, s81, s82
    s_mul_i32 s83, s83, 49152
    s_add_u32 s93, s83, s80
    s_mul_i32 s82, s82, 15360
    s_add_u32 s82, s82, 5120
    v_add_u32 v6, s82, v8
    s_add_u32 s82, s4, 3
    s_and_b32 s82, s82, 3
    s_add_u32 s83, s81, s82
    s_mul_i32 s83, s83, 49152
    s_add_u32 s94, s83, s80
    s_mul_i32 s82, s82, 15360
    s_add_u32 s82, s82, 10240
    v_add_u32 v7, s82, v8
    s_add_u32 s82, s4, 4
    s_and_b32 s82, s82, 3
    s_add_u32 s83, s81, s82
    s_mul_i32 s83, s83, 49152
    s_add_u32 s95, s83, s80
    s_mul_i32 s82, s4, 15360
    v_add_u32 v8, s82, v8
    s_waitcnt vmcnt(0)
    s_barrier
    s_lshl_b32 s80, s68, 4
    s_add_u32 s80, s80, s69
    s_lshl_b32 s80, s80, 6
    s_add_u32 s80, s80, 20480
    v_mov_b32 v16, s80
    v_mov_b32 v17, 2147483648
    v_cmp_eq_u32 vcc, 0, v0
    s_nop 1
    v_cndmask_b32 v16, v17, v16, vcc
    v_mov_b32 v17, s5
    buffer_store_dword v17, v16, s[36:39], 0 offen sc1
    buffer_load_dwordx4 a[52:55], v139, s[36:39], s78 offen offset:1024 sc1
    buffer_load_dwordx4 a[56:59], v139, s[36:39], s78 offen offset:2048 sc1
    buffer_load_dwordx4 a[60:63], v139, s[36:39], s78 offen offset:3072 sc1
    s_add_u32 s78, s78, 4096
    buffer_load_dwordx4 a[64:67], v139, s[36:39], s78 offen offset:0 sc1
    buffer_load_dwordx4 a[68:71], v139, s[36:39], s78 offen offset:1024 sc1
    buffer_load_dwordx4 a[72:75], v139, s[36:39], s78 offen offset:2048 sc1
    buffer_load_dwordx4 a[76:79], v139, s[36:39], s78 offen offset:3072 sc1
    s_add_u32 s78, s78, 4096
    buffer_load_dwordx4 a[80:83], v139, s[36:39], s78 offen offset:0 sc1
    buffer_load_dwordx4 a[84:87], v139, s[36:39], s78 offen offset:1024 sc1
    buffer_load_dwordx4 a[88:91], v139, s[36:39], s78 offen offset:2048 sc1
    buffer_load_dwordx4 a[92:95], v139, s[36:39], s78 offen offset:3072 sc1
    s_add_u32 s78, s78, 4096
    buffer_load_dwordx4 a[96:99], v139, s[36:39], s78 offen offset:0 sc1
    buffer_load_dwordx4 a[100:103], v139, s[36:39], s78 offen offset:1024 sc1
    buffer_load_dwordx4 a[104:107], v139, s[36:39], s78 offen offset:2048 sc1
    buffer_load_dwordx4 a[108:111], v139, s[36:39], s78 offen offset:3072 sc1
    s_add_u32 s78, s78, 4096
    buffer_load_dwordx4 a[112:115], v139, s[36:39], s78 offen offset:0 sc1
    buffer_load_dwordx4 a[116:119], v139, s[36:39], s78 offen offset:1024 sc1
    buffer_load_dwordx4 a[120:123], v139, s[36:39], s78 offen offset:2048 sc1
    buffer_load_dwordx4 a[124:127], v139, s[36:39], s78 offen offset:3072 sc1
    s_add_u32 s78, s78, 4096
    buffer_load_dwordx4 a[128:131], v139, s[36:39], s78 offen offset:0 sc1
    buffer_load_dwordx4 a[132:135], v139, s[36:39], s78 offen offset:1024 sc1
    buffer_load_dwordx4 a[136:139], v139, s[36:39], s78 offen offset:2048 sc1
    buffer_load_dwordx4 a[140:143], v139, s[36:39], s78 offen offset:3072 sc1
    s_add_u32 s78, s78, 4096
    buffer_load_dwordx4 a[144:147], v139, s[36:39], s78 offen offset:0 sc1
    buffer_load_dwordx4 a[148:151], v139, s[36:39], s78 offen offset:1024 sc1
    buffer_load_dwordx4 a[152:155], v139, s[36:39], s78 offen offset:2048 sc1
    buffer_load_dwordx4 a[156:159], v139, s[36:39], s78 offen offset:3072 sc1
    s_add_u32 s78, s78, 4096
    buffer_load_dwordx4 a[160:163], v139, s[36:39], s78 offen offset:0 sc1
    buffer_load_dwordx4 a[164:167], v139, s[36:39], s78 offen offset:1024 sc1
    buffer_load_dwordx4 a[168:171], v139, s[36:39], s78 offen offset:2048 sc1
    buffer_load_dwordx4 a[172:175], v139, s[36:39], s78 offen offset:3072 sc1
    s_add_u32 s78, s78, 4096
    buffer_load_dwordx4 a[176:179], v139, s[36:39], s78 offen offset:0 sc1
    buffer_load_dwordx4 a[180:183], v139, s[36:39], s78 offen offset:1024 sc1
    buffer_load_dwordx4 a[184:187], v139, s[36:39], s78 offen offset:2048 sc1
    buffer_load_dwordx4 a[188:191], v139, s[36:39], s78 offen offset:3072 sc1
    s_add_u32 s78, s78, 4096
    buffer_load_dwordx4 a[192:195], v139, s[36:39], s78 offen offset:0 sc1
    buffer_load_dwordx4 a[196:199], v139, s[36:39], s78 offen offset:1024 sc1
    buffer_load_dwordx4 a[200:203], v139, s[36:39], s78 offen offset:2048 sc1
    buffer_load_dwordx4 a[204:207], v139, s[36:39], s78 offen offset:3072 sc1
    s_add_u32 s78, s78, 4096
    buffer_load_dwordx4 a[208:211], v139, s[36:39], s78 offen offset:0 sc1
    buffer_load_dwordx4 a[212:215], v139, s[36:39], s78 offen offset:1024 sc1
    buffer_load_dwordx4 a[216:219], v139, s[36:39], s78 offen offset:2048 sc1
    buffer_load_dwordx4 a[220:223], v139, s[36:39], s78 offen offset:3072 sc1
    s_add_u32 s78, s78, 4096
    buffer_load_dwordx4 a[224:227], v139, s[36:39], s78 offen offset:0 sc1
    buffer_load_dwordx4 a[228:231], v139, s[36:39], s78 offen offset:1024 sc1
    buffer_load_dwordx4 a[232:235], v139, s[36:39], s78 offen offset:2048 sc1
    buffer_load_dwordx4 a[236:239], v139, s[36:39], s78 offen offset:3072 sc1
    s_add_u32 s78, s78, 4096
    s_lshr_b32 s80, s70, 1
    s_lshl_b32 s80, s80, 4
    s_lshl_b32 s81, s4, 2
    s_add_u32 s80, s80, s81
    v_and_b32 v13, 3, v1
    v_add_u32 v13, s80, v13
    v_lshlrev_b32 v13, 6, v13
    v_add_u32 v13, 20480, v13
    buffer_load_dword v14, v13, s[36:39], 0 offen sc1
    s_waitcnt vmcnt(0)
    v_cmp_ne_u32 vcc, s5, v14
    s_nop 0
    s_cbranch_vccnz LB_slowg13
LB_backg14:
    buffer_load_dwordx4 v[148:151], v2, s[36:39], s92 offen offset:0 sc1
    buffer_load_dwordx4 v[152:155], v2, s[36:39], s92 offen offset:1024 sc1
    buffer_load_dwordx4 v[156:159], v2, s[36:39], s92 offen offset:2048 sc1
    buffer_load_dwordx4 v[160:163], v2, s[36:39], s92 offen offset:3072 sc1
    buffer_load_dwordx4 v[164:167], v3, s[36:39], s92 offen offset:0 sc1
    buffer_load_dwordx4 v[168:171], v3, s[36:39], s92 offen offset:1024 sc1
    buffer_load_dwordx4 v[172:175], v3, s[36:39], s92 offen offset:2048 sc1
    buffer_load_dwordx4 v[176:179], v3, s[36:39], s92 offen offset:3072 sc1
    buffer_load_dwordx4 v[180:183], v4, s[36:39], s92 offen offset:0 sc1
    buffer_load_dwordx4 v[184:187], v4, s[36:39], s92 offen offset:1024 sc1
    buffer_load_dwordx4 v[188:191], v4, s[36:39], s92 offen offset:2048 sc1
    buffer_load_dwordx4 v[192:195], v4, s[36:39], s92 offen offset:3072 sc1
    buffer_load_dwordx4 v[196:199], v2, s[36:39], s93 offen offset:0 sc1
    buffer_load_dwordx4 v[200:203], v2, s[36:39], s93 offen offset:1024 sc1
    buffer_load_dwordx4 v[204:207], v2, s[36:39], s93 offen offset:2048 sc1
    buffer_load_dwordx4 v[208:211], v2, s[36:39], s93 offen offset:3072 sc1
    buffer_load_dwordx4 v[212:215], v3, s[36:39], s93 offen offset:0 sc1
    buffer_load_dwordx4 v[216:219], v3, s[36:39], s93 offen offset:1024 sc1
    buffer_load_dwordx4 v[220:223], v3, s[36:39], s93 offen offset:2048 sc1
    buffer_load_dwordx4 v[224:227], v3, s[36:39], s93 offen offset:3072 sc1
    buffer_load_dwordx4 v[228:231], v4, s[36:39], s93 offen offset:0 sc1
    buffer_load_dwordx4 v[232:235], v4, s[36:39], s93 offen offset:1024 sc1
    buffer_load_dwordx4 v[236:239], v4, s[36:39], s93 offen offset:2048 sc1
    buffer_load_dwordx4 v[240:243], v4, s[36:39], s93 offen offset:3072 sc1
    buffer_load_dwordx4 v[244:247], v2, s[36:39], s94 offen offset:0 sc1
    buffer_load_dwordx4 v[248:251], v2, s[36:39], s94 offen offset:1024 sc1
    buffer_load_dwordx4 v[252:255], v2, s[36:39], s94 offen offset:2048 sc1
    buffer_load_dwordx4 v[104:107], v2, s[36:39], s94 offen offset:3072 sc1
    buffer_load_dwordx4 v[108:111], v3, s[36:39], s94 offen offset:0 sc1
    buffer_load_dwordx4 v[112:115], v3, s[36:39], s94 offen offset:1024 sc1
    buffer_load_dwordx4 v[116:119], v3, s[36:39], s94 offen offset:2048 sc1
    buffer_load_dwordx4 v[120:123], v3, s[36:39], s94 offen offset:3072 sc1
    buffer_load_dwordx4 v[124:127], v4, s[36:39], s94 offen offset:0 sc1
    buffer_load_dwordx4 v[128:131], v4, s[36:39], s94 offen offset:1024 sc1
    buffer_load_dwordx4 v[132:135], v4, s[36:39], s94 offen offset:2048 sc1
    buffer_load_dwordx4 v[136:139], v4, s[36:39], s94 offen offset:3072 sc1
    buffer_load_dwordx4 v[140:143], v2, s[36:39], s95 offen offset:0 sc1
    buffer_load_dwordx4 v[144:147], v2, s[36:39], s95 offen offset:1024 sc1
    s_waitcnt vmcnt(37)
    v_mfma_f32_16x16x32_bf16 v[20:23], a[0:3], v[148:151], 0
    v_mfma_f32_16x16x32_bf16 v[24:27], a[4:7], v[148:151], 0
    v_mfma_f32_16x16x32_bf16 v[28:31], a[8:11], v[148:151], 0
    v_mfma_f32_16x16x32_bf16 v[32:35], a[12:15], v[148:151], 0
    v_mfma_f32_16x16x32_bf16 v[36:39], a[16:19], v[148:151], 0
    s_waitcnt vmcnt(36)
    v_mfma_f32_16x16x32_bf16 v[20:23], a[20:23], v[152:155], v[20:23]
    buffer_load_dwordx4 v[148:151], v2, s[36:39], s95 offen offset:2048 sc1
    v_mfma_f32_16x16x32_bf16 v[24:27], a[24:27], v[152:155], v[24:27]
    v_mfma_f32_16x16x32_bf16 v[28:31], a[28:31], v[152:155], v[28:31]
    v_mfma_f32_16x16x32_bf16 v[32:35], a[32:35], v[152:155], v[32:35]
    v_mfma_f32_16x16x32_bf16 v[36:39], a[36:39], v[152:155], v[36:39]
    s_waitcnt vmcnt(36)
    v_mfma_f32_16x16x32_bf16 v[20:23], a[40:43], v[156:159], v[20:23]
    buffer_load_dwordx4 v[152:155], v2, s[36:39], s95 offen offset:3072 sc1
    v_mfma_f32_16x16x32_bf16 v[24:27], a[44:47], v[156:159], v[24:27]
    v_mfma_f32_16x16x32_bf16 v[28:31], a[48:51], v[156:159], v[28:31]
    v_mfma_f32_16x16x32_bf16 v[32:35], a[52:55], v[156:159], v[32:35]
    v_mfma_f32_16x16x32_bf16 v[36:39], a[56:59], v[156:159], v[36:39]
    s_waitcnt vmcnt(36)
    v_mfma_f32_16x16x32_bf16 v[20:23], a[60:63], v[160:163], v[20:23]
    buffer_load_dwordx4 v[156:159], v3, s[36:39], s95 offen offset:0 sc1
    v_mfma_f32_16x16x32_bf16 v[24:27], a[64:67], v[160:163], v[24:27]
    v_mfma_f32_16x16x32_bf16 v[28:31], a[68:71], v[160:163], v[28:31]
    s_lshl_b32 s80, s70, 6
    s_lshl_b32 s81, s4, 4
    s_add_u32 s80, s80, s81
    v_and_b32 v9, 15, v1
    v_mfma_f32_16x16x32_bf16 v[32:35], a[72:75], v[160:163], v[32:35]
    v_add_u32 v9, s80, v9
    v_lshrrev_b32 v10, 4, v1
    s_mul_i32 s82, s71, 160
    v_lshl_add_u32 v10, v10, 3, s82
    v_mul_u32_u24 v11, 1280, v9
    v_mfma_f32_16x16x32_bf16 v[36:39], a[76:79], v[160:163], v[36:39]
    v_add_u32 v11, v11, v10
    buffer_load_dwordx2 v[60:61], v11, s[8:11], 0 offen offset:0
    s_waitcnt vmcnt(37)
    v_mfma_f32_16x16x32_bf16 v[20:23], a[80:83], v[164:167], v[20:23]
    buffer_load_dwordx4 v[160:163], v3, s[36:39], s95 offen offset:1024 sc1
    v_mfma_f32_16x16x32_bf16 v[24:27], a[84:87], v[164:167], v[24:27]
    v_mfma_f32_16x16x32_bf16 v[28:31], a[88:91], v[164:167], v[28:31]
    v_mfma_f32_16x16x32_bf16 v[32:35], a[92:95], v[164:167], v[32:35]
    v_mfma_f32_16x16x32_bf16 v[36:39], a[96:99], v[164:167], v[36:39]
    s_waitcnt vmcnt(37)
    v_mfma_f32_16x16x32_bf16 v[20:23], a[100:103], v[168:171], v[20:23]
    buffer_load_dwordx4 v[164:167], v3, s[36:39], s95 offen offset:2048 sc1
    v_mfma_f32_16x16x32_bf16 v[24:27], a[104:107], v[168:171], v[24:27]
    v_mfma_f32_16x16x32_bf16 v[28:31], a[108:111], v[168:171], v[28:31]
    v_mfma_f32_16x16x32_bf16 v[32:35], a[112:115], v[168:171], v[32:35]
    buffer_load_dwordx2 v[62:63], v11, s[8:11], 0 offen offset:32
    v_mfma_f32_16x16x32_bf16 v[36:39], a[116:119], v[168:171], v[36:39]
    s_waitcnt vmcnt(38)
    v_mfma_f32_16x16x32_bf16 v[20:23], a[120:123], v[172:175], v[20:23]
    buffer_load_dwordx4 v[168:171], v3, s[36:39], s95 offen offset:3072 sc1
    v_mfma_f32_16x16x32_bf16 v[24:27], a[124:127], v[172:175], v[24:27]
    v_mfma_f32_16x16x32_bf16 v[28:31], a[128:131], v[172:175], v[28:31]
    v_mfma_f32_16x16x32_bf16 v[32:35], a[132:135], v[172:175], v[32:35]
    v_mfma_f32_16x16x32_bf16 v[36:39], a[136:139], v[172:175], v[36:39]
    s_waitcnt vmcnt(38)
    v_mfma_f32_16x16x32_bf16 v[20:23], a[140:143], v[176:179], v[20:23]
    buffer_load_dwordx4 v[172:175], v4, s[36:39], s95 offen offset:0 sc1
    v_mfma_f32_16x16x32_bf16 v[24:27], a[144:147], v[176:179], v[24:27]
    v_mfma_f32_16x16x32_bf16 v[28:31], a[148:151], v[176:179], v[28:31]
    v_mfma_f32_16x16x32_bf16 v[32:35], a[152:155], v[176:179], v[32:35]
    buffer_load_dwordx2 v[64:65], v11, s[8:11], 0 offen offset:64
    v_mfma_f32_16x16x32_bf16 v[36:39], a[156:159], v[176:179], v[36:39]
    s_waitcnt vmcnt(39)
    v_mfma_f32_16x16x32_bf16 v[20:23], a[160:163], v[180:183], v[20:23]
    buffer_load_dwordx4 v[176:179], v4, s[36:39], s95 offen offset:1024 sc1
    v_mfma_f32_16x16x32_bf16 v[24:27], a[164:167], v[180:183], v[24:27]
    v_mfma_f32_16x16x32_bf16 v[28:31], a[168:171], v[180:183], v[28:31]
    v_mfma_f32_16x16x32_bf16 v[32:35], a[172:175], v[180:183], v[32:35]
    v_mfma_f32_16x16x32_bf16 v[36:39], a[176:179], v[180:183], v[36:39]
    s_waitcnt vmcnt(39)
    v_mfma_f32_16x16x32_bf16 v[20:23], a[180:183], v[184:187], v[20:23]
    buffer_load_dwordx4 v[180:183], v4, s[36:39], s95 offen offset:2048 sc1
    v_mfma_f32_16x16x32_bf16 v[24:27], a[184:187], v[184:187], v[24:27]
    v_mfma_f32_16x16x32_bf16 v[28:31], a[188:191], v[184:187], v[28:31]
    v_mfma_f32_16x16x32_bf16 v[32:35], a[192:195], v[184:187], v[32:35]
    buffer_load_dwordx2 v[66:67], v11, s[8:11], 0 offen offset:96
    v_mfma_f32_16x16x32_bf16 v[36:39], a[196:199], v[184:187], v[36:39]
    s_waitcnt vmcnt(40)
    v_mfma_f32_16x16x32_bf16 v[20:23], a[200:203], v[188:191], v[20:23]
    buffer_load_dwordx4 v[184:187], v4, s[36:39], s95 offen offset:3072 sc1
    v_mfma_f32_16x16x32_bf16 v[24:27], a[204:207], v[188:191], v[24:27]
    v_mfma_f32_16x16x32_bf16 v[28:31], a[208:211], v[188:191], v[28:31]
    v_mfma_f32_16x16x32_bf16 v[32:35], a[212:215], v[188:191], v[32:35]
    v_mfma_f32_16x16x32_bf16 v[36:39], a[216:219], v[188:191], v[36:39]
    s_barrier
    s_waitcnt vmcnt(40)
    v_mfma_f32_16x16x32_bf16 v[20:23], a[220:223], v[192:195], v[20:23]
    buffer_load_dwordx2 v[68:69], v11, s[8:11], 0 offen offset:128
    v_mfma_f32_16x16x32_bf16 v[24:27], a[224:227], v[192:195], v[24:27]
    v_mfma_f32_16x16x32_bf16 v[28:31], a[228:231], v[192:195], v[28:31]
    v_mfma_f32_16x16x32_bf16 v[32:35], a[232:235], v[192:195], v[32:35]
    v_mfma_f32_16x16x32_bf16 v[36:39], a[236:239], v[192:195], v[36:39]
    s_waitcnt vmcnt(40)
    v_mfma_f32_16x16x32_bf16 v[40:43], a[0:3], v[196:199], 0
    v_mfma_f32_16x16x32_bf16 v[44:47], a[4:7], v[196:199], 0
    v_mfma_f32_16x16x32_bf16 v[48:51], a[8:11], v[196:199], 0
    v_mfma_f32_16x16x32_bf16 v[52:55], a[12:15], v[196:199], 0
    v_mfma_f32_16x16x32_bf16 v[56:59], a[16:19], v[196:199], 0
    s_waitcnt vmcnt(39)
    v_mfma_f32_16x16x32_bf16 v[40:43], a[20:23], v[200:203], v[40:43]
    global_load_dwordx2 v[70:71], v10, s[60:61] offset:0
    v_mfma_f32_16x16x32_bf16 v[44:47], a[24:27], v[200:203], v[44:47]
    v_mfma_f32_16x16x32_bf16 v[48:51], a[28:31], v[200:203], v[48:51]
    ds_write_b128 v5, v[20:23] offset:0
    ds_write_b128 v5, v[24:27] offset:1024
    v_mfma_f32_16x16x32_bf16 v[52:55], a[32:35], v[200:203], v[52:55]
    ds_write_b128 v5, v[28:31] offset:2048
    ds_write_b128 v5, v[32:35] offset:3072
    v_mfma_f32_16x16x32_bf16 v[56:59], a[36:39], v[200:203], v[56:59]
    ds_write_b128 v5, v[36:39] offset:4096
    s_waitcnt vmcnt(39)
    v_mfma_f32_16x16x32_bf16 v[40:43], a[40:43], v[204:207], v[40:43]
    v_mfma_f32_16x16x32_bf16 v[44:47], a[44:47], v[204:207], v[44:47]
    v_mfma_f32_16x16x32_bf16 v[48:51], a[48:51], v[204:207], v[48:51]
    v_mfma_f32_16x16x32_bf16 v[52:55], a[52:55], v[204:207], v[52:55]
    v_mfma_f32_16x16x32_bf16 v[56:59], a[56:59], v[204:207], v[56:59]
    s_waitcnt vmcnt(38)
    v_mfma_f32_16x16x32_bf16 v[40:43], a[60:63], v[208:211], v[40:43]
    global_load_dwordx2 v[72:73], v10, s[60:61] offset:32
    v_mfma_f32_16x16x32_bf16 v[44:47], a[64:67], v[208:211], v[44:47]
    v_mfma_f32_16x16x32_bf16 v[48:51], a[68:71], v[208:211], v[48:51]
    v_mfma_f32_16x16x32_bf16 v[52:55], a[72:75], v[208:211], v[52:55]
    v_mfma_f32_16x16x32_bf16 v[56:59], a[76:79], v[208:211], v[56:59]
    s_waitcnt vmcnt(38)
    v_mfma_f32_16x16x32_bf16 v[40:43], a[80:83], v[212:215], v[40:43]
    s_cmp_eq_u32 s2, 0
    s_cselect_b32 s84, s5, 0
    s_cselect_b32 s85, 0, 2147483648
    v_mfma_f32_16x16x32_bf16 v[44:47], a[84:87], v[212:215], v[44:47]
    s_lshl_b32 s80, s4, 6
    v_add_u32 v15, s80, v1
    v_mfma_f32_16x16x32_bf16 v[48:51], a[88:91], v[212:215], v[48:51]
    v_lshlrev_b32 v15, 6, v15
    v_add_u32 v15, 4096, v15
    v_or_b32 v15, s85, v15
    v_mfma_f32_16x16x32_bf16 v[52:55], a[92:95], v[212:215], v[52:55]
    buffer_load_dword v18, v15, s[36:39], 0 offen sc1
    v_mfma_f32_16x16x32_bf16 v[56:59], a[96:99], v[212:215], v[56:59]
    s_waitcnt vmcnt(38)
    v_mfma_f32_16x16x32_bf16 v[40:43], a[100:103], v[216:219], v[40:43]
    global_load_dwordx2 v[74:75], v10, s[60:61] offset:64
    v_mfma_f32_16x16x32_bf16 v[44:47], a[104:107], v[216:219], v[44:47]
    v_mfma_f32_16x16x32_bf16 v[48:51], a[108:111], v[216:219], v[48:51]
    v_mfma_f32_16x16x32_bf16 v[52:55], a[112:115], v[216:219], v[52:55]
    v_mfma_f32_16x16x32_bf16 v[56:59], a[116:119], v[216:219], v[56:59]
    s_waitcnt vmcnt(38)
    v_mfma_f32_16x16x32_bf16 v[40:43], a[120:123], v[220:223], v[40:43]
    v_mfma_f32_16x16x32_bf16 v[44:47], a[124:127], v[220:223], v[44:47]
    v_mfma_f32_16x16x32_bf16 v[48:51], a[128:131], v[220:223], v[48:51]
    v_mfma_f32_16x16x32_bf16 v[52:55], a[132:135], v[220:223], v[52:55]
    v_mfma_f32_16x16x32_bf16 v[56:59], a[136:139], v[220:223], v[56:59]
    s_waitcnt vmcnt(37)
    v_mfma_f32_16x16x32_bf16 v[40:43], a[140:143], v[224:227], v[40:43]
    global_load_dwordx2 v[76:77], v10, s[60:61] offset:96
    v_mfma_f32_16x16x32_bf16 v[44:47], a[144:147], v[224:227], v[44:47]
    v_mfma_f32_16x16x32_bf16 v[48:51], a[148:151], v[224:227], v[48:51]
    v_mfma_f32_16x16x32_bf16 v[52:55], a[152:155], v[224:227], v[52:55]
    v_mfma_f32_16x16x32_bf16 v[56:59], a[156:159], v[224:227], v[56:59]
    s_waitcnt vmcnt(37)
    v_mfma_f32_16x16x32_bf16 v[40:43], a[160:163], v[228:231], v[40:43]
    v_mfma_f32_16x16x32_bf16 v[44:47], a[164:167], v[228:231], v[44:47]
    v_mfma_f32_16x16x32_bf16 v[48:51], a[168:171], v[228:231], v[48:51]
    v_mfma_f32_16x16x32_bf16 v[52:55], a[172:175], v[228:231], v[52:55]
    v_mfma_f32_16x16x32_bf16 v[56:59], a[176:179], v[228:231], v[56:59]
    s_waitcnt vmcnt(36)
    v_mfma_f32_16x16x32_bf16 v[40:43], a[180:183], v[232:235], v[40:43]
    global_load_dwordx2 v[78:79], v10, s[60:61] offset:128
    v_mfma_f32_16x16x32_bf16 v[44:47], a[184:187], v[232:235], v[44:47]
    v_mfma_f32_16x16x32_bf16 v[48:51], a[188:191], v[232:235], v[48:51]
    v_mfma_f32_16x16x32_bf16 v[52:55], a[192:195], v[232:235], v[52:55]
    v_mfma_f32_16x16x32_bf16 v[56:59], a[196:199], v[232:235], v[56:59]
    s_waitcnt vmcnt(36)
    v_mfma_f32_16x16x32_bf16 v[40:43], a[200:203], v[236:239], v[40:43]
    s_mul_i32 s80, s71, 20
    v_min_u32 v13, 19, v1
    v_mfma_f32_16x16x32_bf16 v[44:47], a[204:207], v[236:239], v[44:47]
    v_add_u32 v13, s80, v13
    v_lshlrev_b32 v13, 6, v13
    v_mfma_f32_16x16x32_bf16 v[48:51], a[208:211], v[236:239], v[48:51]
    v_add_u32 v13, 36864, v13
    buffer_load_dword v14, v13, s[36:39], 0 offen sc1
    v_mfma_f32_16x16x32_bf16 v[52:55], a[212:215], v[236:239], v[52:55]
    v_mfma_f32_16x16x32_bf16 v[56:59], a[216:219], v[236:239], v[56:59]
    s_waitcnt vmcnt(36)
    v_mfma_f32_16x16x32_bf16 v[40:43], a[220:223], v[240:243], v[40:43]
    v_lshlrev_b32 v12, 3, v9
    v_add_u32 v12, 65536, v12
    v_mfma_f32_16x16x32_bf16 v[44:47], a[224:227], v[240:243], v[44:47]
    buffer_load_dwordx2 v[80:81], v12, s[36:39], 0 offen sc1
    v_mfma_f32_16x16x32_bf16 v[48:51], a[228:231], v[240:243], v[48:51]
    v_mfma_f32_16x16x32_bf16 v[52:55], a[232:235], v[240:243], v[52:55]
    v_mfma_f32_16x16x32_bf16 v[56:59], a[236:239], v[240:243], v[56:59]
    s_waitcnt vmcnt(36)
    v_mfma_f32_16x16x32_bf16 v[20:23], a[0:3], v[244:247], 0
    s_waitcnt vmcnt(5)
    v_cmp_ne_u32 vcc, s84, v18
    v_mfma_f32_16x16x32_bf16 v[24:27], a[4:7], v[244:247], 0
    v_mfma_f32_16x16x32_bf16 v[28:31], a[8:11], v[244:247], 0
    s_cbranch_vccnz LB_slowtk5
LB_backtk6:
    v_mfma_f32_16x16x32_bf16 v[32:35], a[12:15], v[244:247], 0
    v_mfma_f32_16x16x32_bf16 v[36:39], a[16:19], v[244:247], 0
    v_mfma_f32_16x16x32_bf16 v[20:23], a[20:23], v[248:251], v[20:23]
    ds_write_b128 v6, v[40:43] offset:0
    v_mfma_f32_16x16x32_bf16 v[24:27], a[24:27], v[248:251], v[24:27]
    ds_write_b128 v6, v[44:47] offset:1024
    v_mfma_f32_16x16x32_bf16 v[28:31], a[28:31], v[248:251], v[28:31]
    ds_write_b128 v6, v[48:51] offset:2048
    v_mfma_f32_16x16x32_bf16 v[32:35], a[32:35], v[248:251], v[32:35]
    ds_write_b128 v6, v[52:55] offset:3072
    v_mfma_f32_16x16x32_bf16 v[36:39], a[36:39], v[248:251], v[36:39]
    ds_write_b128 v6, v[56:59] offset:4096
    v_mfma_f32_16x16x32_bf16 v[20:23], a[40:43], v[252:255], v[20:23]
    v_mfma_f32_16x16x32_bf16 v[24:27], a[44:47], v[252:255], v[24:27]
    v_mfma_f32_16x16x32_bf16 v[28:31], a[48:51], v[252:255], v[28:31]
    v_mfma_f32_16x16x32_bf16 v[32:35], a[52:55], v[252:255], v[32:35]
    v_mfma_f32_16x16x32_bf16 v[36:39], a[56:59], v[252:255], v[36:39]
    v_mfma_f32_16x16x32_bf16 v[20:23], a[60:63], v[104:107], v[20:23]
    v_mfma_f32_16x16x32_bf16 v[24:27], a[64:67], v[104:107], v[24:27]
    v_mfma_f32_16x16x32_bf16 v[28:31], a[68:71], v[104:107], v[28:31]
    v_mfma_f32_16x16x32_bf16 v[32:35], a[72:75], v[104:107], v[32:35]
    v_mfma_f32_16x16x32_bf16 v[36:39], a[76:79], v[104:107], v[36:39]
    v_mfma_f32_16x16x32_bf16 v[20:23], a[80:83], v[108:111], v[20:23]
    v_mfma_f32_16x16x32_bf16 v[24:27], a[84:87], v[108:111], v[24:27]
    v_mfma_f32_16x16x32_bf16 v[28:31], a[88:91], v[108:111], v[28:31]
    v_mfma_f32_16x16x32_bf16 v[32:35], a[92:95], v[108:111], v[32:35]
    v_mfma_f32_16x16x32_bf16 v[36:39], a[96:99], v[108:111], v[36:39]
    v_mfma_f32_16x16x32_bf16 v[20:23], a[100:103], v[112:115], v[20:23]
    s_waitcnt vmcnt(1)
    v_cmp_ne_u32 vcc, s5, v14
    s_nop 0
    s_cbranch_vccnz LB_slowy7
LB_backy8:
    v_lshlrev_b32 v12, 11, v10
    v_lshl_add_u32 v12, v9, 1, v12
    v_mfma_f32_16x16x32_bf16 v[24:27], a[104:107], v[112:115], v[24:27]
    v_add_u32 v12, 4194304, v12
    s_mov_b32 s80, 0
    buffer_load_ushort v82, v12, s[36:39], s80 offen sc1
    v_mfma_f32_16x16x32_bf16 v[28:31], a[108:111], v[112:115], v[28:31]
    s_mov_b32 s80, 4096
    buffer_load_ushort v83, v12, s[36:39], s80 offen sc1
    v_mfma_f32_16x16x32_bf16 v[32:35], a[112:115], v[112:115], v[32:35]
    s_mov_b32 s80, 8192
    v_mfma_f32_16x16x32_bf16 v[36:39], a[116:119], v[112:115], v[36:39]
    buffer_load_ushort v84, v12, s[36:39], s80 offen sc1
    v_mfma_f32_16x16x32_bf16 v[20:23], a[120:123], v[116:119], v[20:23]
    s_mov_b32 s80, 12288
    buffer_load_ushort v85, v12, s[36:39], s80 offen sc1
    v_mfma_f32_16x16x32_bf16 v[24:27], a[124:127], v[116:119], v[24:27]
    s_mov_b32 s80, 65536
    buffer_load_ushort v86, v12, s[36:39], s80 offen sc1
    v_mfma_f32_16x16x32_bf16 v[28:31], a[128:131], v[116:119], v[28:31]
    v_mfma_f32_16x16x32_bf16 v[32:35], a[132:135], v[116:119], v[32:35]
    s_mov_b32 s80, 69632
    buffer_load_ushort v87, v12, s[36:39], s80 offen sc1
    v_mfma_f32_16x16x32_bf16 v[36:39], a[136:139], v[116:119], v[36:39]
    s_mov_b32 s80, 73728
    v_mfma_f32_16x16x32_bf16 v[20:23], a[140:143], v[120:123], v[20:23]
    buffer_load_ushort v88, v12, s[36:39], s80 offen sc1
    v_mfma_f32_16x16x32_bf16 v[24:27], a[144:147], v[120:123], v[24:27]
    s_mov_b32 s80, 77824
    buffer_load_ushort v89, v12, s[36:39], s80 offen sc1
    v_mfma_f32_16x16x32_bf16 v[28:31], a[148:151], v[120:123], v[28:31]
    s_mov_b32 s80, 131072
    buffer_load_ushort v90, v12, s[36:39], s80 offen sc1
    v_mfma_f32_16x16x32_bf16 v[32:35], a[152:155], v[120:123], v[32:35]
    s_mov_b32 s80, 135168
    buffer_load_ushort v91, v12, s[36:39], s80 offen sc1
    v_mfma_f32_16x16x32_bf16 v[36:39], a[156:159], v[120:123], v[36:39]
    v_mfma_f32_16x16x32_bf16 v[20:23], a[160:163], v[124:127], v[20:23]
    s_mov_b32 s80, 139264
    buffer_load_ushort v92, v12, s[36:39], s80 offen sc1
    v_mfma_f32_16x16x32_bf16 v[24:27], a[164:167], v[124:127], v[24:27]
    s_mov_b32 s80, 143360
    buffer_load_ushort v93, v12, s[36:39], s80 offen sc1
    v_mfma_f32_16x16x32_bf16 v[28:31], a[168:171], v[124:127], v[28:31]
    v_mfma_f32_16x16x32_bf16 v[32:35], a[172:175], v[124:127], v[32:35]
    s_mov_b32 s80, 196608
    buffer_load_ushort v94, v12, s[36:39], s80 offen sc1
    v_mfma_f32_16x16x32_bf16 v[36:39], a[176:179], v[124:127], v[36:39]
    s_mov_b32 s80, 200704
    v_mfma_f32_16x16x32_bf16 v[20:23], a[180:183], v[128:131], v[20:23]
    buffer_load_ushort v95, v12, s[36:39], s80 offen sc1
    v_mfma_f32_16x16x32_bf16 v[24:27], a[184:187], v[128:131], v[24:27]
    s_mov_b32 s80, 204800
    buffer_load_ushort v96, v12, s[36:39], s80 offen sc1
    v_mfma_f32_16x16x32_bf16 v[28:31], a[188:191], v[128:131], v[28:31]
    s_mov_b32 s80, 208896
    buffer_load_ushort v97, v12, s[36:39], s80 offen sc1
    v_mfma_f32_16x16x32_bf16 v[32:35], a[192:195], v[128:131], v[32:35]
    s_mov_b32 s80, 262144
    buffer_load_ushort v98, v12, s[36:39], s80 offen sc1
    v_mfma_f32_16x16x32_bf16 v[36:39], a[196:199], v[128:131], v[36:39]
    v_mfma_f32_16x16x32_bf16 v[20:23], a[200:203], v[132:135], v[20:23]
    s_mov_b32 s80, 266240
    buffer_load_ushort v99, v12, s[36:39], s80 offen sc1
    v_mfma_f32_16x16x32_bf16 v[24:27], a[204:207], v[132:135], v[24:27]
    s_mov_b32 s80, 270336
    v_mfma_f32_16x16x32_bf16 v[28:31], a[208:211], v[132:135], v[28:31]
    buffer_load_ushort v100, v12, s[36:39], s80 offen sc1
    v_mfma_f32_16x16x32_bf16 v[32:35], a[212:215], v[132:135], v[32:35]
    s_mov_b32 s80, 274432
    buffer_load_ushort v101, v12, s[36:39], s80 offen sc1
    v_mfma_f32_16x16x32_bf16 v[36:39], a[216:219], v[132:135], v[36:39]
    v_mfma_f32_16x16x32_bf16 v[20:23], a[220:223], v[136:139], v[20:23]
    v_mfma_f32_16x16x32_bf16 v[24:27], a[224:227], v[136:139], v[24:27]
    v_mfma_f32_16x16x32_bf16 v[28:31], a[228:231], v[136:139], v[28:31]
    v_mfma_f32_16x16x32_bf16 v[32:35], a[232:235], v[136:139], v[32:35]
    v_mfma_f32_16x16x32_bf16 v[36:39], a[236:239], v[136:139], v[36:39]
    v_mfma_f32_16x16x32_bf16 v[40:43], a[0:3], v[140:143], 0
    s_nop 2
    ds_write_b128 v7, v[20:23] offset:0
    ds_write_b128 v7, v[24:27] offset:1024
    v_mfma_f32_16x16x32_bf16 v[40:43], a[20:23], v[144:147], v[40:43]
    ds_write_b128 v7, v[28:31] offset:2048
    v_mfma_f32_16x16x32_bf16 v[40:43], a[40:43], v[148:151], v[40:43]
    ds_write_b128 v7, v[32:35] offset:3072
    v_mfma_f32_16x16x32_bf16 v[40:43], a[60:63], v[152:155], v[40:43]
    ds_write_b128 v7, v[36:39] offset:4096
    s_waitcnt lgkmcnt(0)
    s_barrier
    v_mfma_f32_16x16x32_bf16 v[40:43], a[80:83], v[156:159], v[40:43]
    ds_read_b128 v[188:191], v8 offset:0
    v_mfma_f32_16x16x32_bf16 v[40:43], a[100:103], v[160:163], v[40:43]
    ds_read_b128 v[192:195], v8 offset:1024
    v_mfma_f32_16x16x32_bf16 v[40:43], a[120:123], v[164:167], v[40:43]
    ds_read_b128 v[208:211], v8 offset:5120
    ds_read_b128 v[212:215], v8 offset:6144
    v_mfma_f32_16x16x32_bf16 v[40:43], a[140:143], v[168:171], v[40:43]
    ds_read_b128 v[228:231], v8 offset:10240
    v_mfma_f32_16x16x32_bf16 v[40:43], a[160:163], v[172:175], v[40:43]
    ds_read_b128 v[232:235], v8 offset:11264
    v_mfma_f32_16x16x32_bf16 v[40:43], a[180:183], v[176:179], v[40:43]
    s_waitcnt vmcnt(20)
    v_rcp_f32 v124, v81
    s_nop 0
    v_mul_f32 v125, v80, v124
    v_mfma_f32_16x16x32_bf16 v[40:43], a[200:203], v[180:183], v[40:43]
    v_xor_b32 v125, 0x80000000, v125
    v_mfma_f32_16x16x32_bf16 v[40:43], a[220:223], v[184:187], v[40:43]
    s_mov_b32 s80, 0xbfb8aa3b
    v_mfma_f32_16x16x32_bf16 v[44:47], a[4:7], v[140:143], 0
    ds_read_b128 v[196:199], v8 offset:2048
    ds_read_b128 v[216:219], v8 offset:7168
    ds_read_b128 v[236:239], v8 offset:12288
    v_lshlrev_b32 v128, 16, v70
    v_and_b32 v129, 0xffff0000, v70
    s_waitcnt lgkmcnt(6)
    v_add_f32 v188, v188, v208
    v_mfma_f32_16x16x32_bf16 v[44:47], a[24:27], v[144:147], v[44:47]
    v_add_f32 v189, v189, v209
    s_waitcnt lgkmcnt(4)
    v_add_f32 v128, v128, v228
    v_add_f32 v129, v129, v229
    v_add_f32 v188, v188, v128
    v_add_f32 v189, v189, v129
    v_lshlrev_b32 v128, 16, v71
    v_mfma_f32_16x16x32_bf16 v[44:47], a[44:47], v[148:151], v[44:47]
    v_and_b32 v129, 0xffff0000, v71
    v_add_f32 v190, v190, v210
    v_add_f32 v191, v191, v211
    v_add_f32 v128, v128, v230
    v_add_f32 v129, v129, v231
    v_add_f32 v190, v190, v128
    v_mfma_f32_16x16x32_bf16 v[44:47], a[64:67], v[152:155], v[44:47]
    v_add_f32 v191, v191, v129
    v_lshlrev_b32 v104, 16, v60
    v_and_b32 v105, 0xffff0000, v60
    s_waitcnt vmcnt(19)
    v_lshlrev_b32 v82, 16, v82
    s_waitcnt vmcnt(18)
    v_lshlrev_b32 v83, 16, v83
    v_mfma_f32_16x16x32_bf16 v[44:47], a[84:87], v[156:159], v[44:47]
    v_fma_f32 v126, v104, v124, v125
    v_fma_f32 v127, v105, v124, v125
    v_mul_f32 v82, v82, v126
    v_mul_f32 v83, v83, v127
    v_lshlrev_b32 v106, 16, v61
    v_and_b32 v107, 0xffff0000, v61
    v_mfma_f32_16x16x32_bf16 v[44:47], a[104:107], v[160:163], v[44:47]
    s_waitcnt vmcnt(17)
    v_lshlrev_b32 v84, 16, v84
    s_waitcnt vmcnt(16)
    v_lshlrev_b32 v85, 16, v85
    v_fma_f32 v126, v106, v124, v125
    v_fma_f32 v127, v107, v124, v125
    v_mul_f32 v84, v84, v126
    v_mul_f32 v85, v85, v127
    v_mfma_f32_16x16x32_bf16 v[44:47], a[124:127], v[164:167], v[44:47]
    v_add_f32 v40, v40, v188
    v_add_f32 v41, v41, v189
    v_mul_f32 v130, s80, v40
    v_mul_f32 v131, s80, v41
    v_exp_f32 v130, v130
    v_exp_f32 v131, v131
    v_mfma_f32_16x16x32_bf16 v[44:47], a[144:147], v[168:171], v[44:47]
    v_add_f32 v130, 1.0, v130
    v_add_f32 v131, 1.0, v131
    v_rcp_f32 v130, v130
    v_rcp_f32 v131, v131
    v_mul_f32 v130, v130, v40
    v_mfma_f32_16x16x32_bf16 v[44:47], a[164:167], v[172:175], v[44:47]
    v_mul_f32 v131, v131, v41
    v_fma_f32 v130, v130, v82, v104
    v_fma_f32 v131, v131, v83, v105
    v_cvt_pk_bf16_f32 v60, v130, v131
    v_add_f32 v42, v42, v190
    v_add_f32 v43, v43, v191
    v_mfma_f32_16x16x32_bf16 v[44:47], a[184:187], v[176:179], v[44:47]
    v_mul_f32 v132, s80, v42
    v_mul_f32 v133, s80, v43
    v_exp_f32 v132, v132
    v_exp_f32 v133, v133
    v_add_f32 v132, 1.0, v132
    v_add_f32 v133, 1.0, v133
    v_mfma_f32_16x16x32_bf16 v[44:47], a[204:207], v[180:183], v[44:47]
    v_rcp_f32 v132, v132
    v_rcp_f32 v133, v133
    v_mul_f32 v132, v132, v42
    v_mul_f32 v133, v133, v43
    v_fma_f32 v132, v132, v84, v106
    v_fma_f32 v133, v133, v85, v107
    v_mfma_f32_16x16x32_bf16 v[44:47], a[224:227], v[184:187], v[44:47]
    v_cvt_pk_bf16_f32 v61, v132, v133
    buffer_store_dwordx2 v[60:61], v11, s[32:35], 0 offen offset:0
    v_mfma_f32_16x16x32_bf16 v[48:51], a[8:11], v[140:143], 0
    ds_read_b128 v[200:203], v8 offset:3072
    ds_read_b128 v[220:223], v8 offset:8192
    ds_read_b128 v[240:243], v8 offset:13312
    v_lshlrev_b32 v128, 16, v72
    v_and_b32 v129, 0xffff0000, v72
    v_add_f32 v192, v192, v212
    v_mfma_f32_16x16x32_bf16 v[48:51], a[28:31], v[144:147], v[48:51]
    v_add_f32 v193, v193, v213
    s_waitcnt lgkmcnt(6)
    v_add_f32 v128, v128, v232
    v_add_f32 v129, v129, v233
    v_add_f32 v192, v192, v128
    v_add_f32 v193, v193, v129
    v_lshlrev_b32 v128, 16, v73
    v_mfma_f32_16x16x32_bf16 v[48:51], a[48:51], v[148:151], v[48:51]
    v_and_b32 v129, 0xffff0000, v73
    v_add_f32 v194, v194, v214
    v_add_f32 v195, v195, v215
    v_add_f32 v128, v128, v234
    v_add_f32 v129, v129, v235
    v_add_f32 v194, v194, v128
    v_mfma_f32_16x16x32_bf16 v[48:51], a[68:71], v[152:155], v[48:51]
    v_add_f32 v195, v195, v129
    v_lshlrev_b32 v108, 16, v62
    v_and_b32 v109, 0xffff0000, v62
    s_waitcnt vmcnt(16)
    v_lshlrev_b32 v86, 16, v86
    s_waitcnt vmcnt(15)
    v_lshlrev_b32 v87, 16, v87
    v_mfma_f32_16x16x32_bf16 v[48:51], a[88:91], v[156:159], v[48:51]
    v_fma_f32 v126, v108, v124, v125
    v_fma_f32 v127, v109, v124, v125
    v_mul_f32 v86, v86, v126
    v_mul_f32 v87, v87, v127
    v_lshlrev_b32 v110, 16, v63
    v_and_b32 v111, 0xffff0000, v63
    v_mfma_f32_16x16x32_bf16 v[48:51], a[108:111], v[160:163], v[48:51]
    s_waitcnt vmcnt(14)
    v_lshlrev_b32 v88, 16, v88
    s_waitcnt vmcnt(13)
    v_lshlrev_b32 v89, 16, v89
    v_fma_f32 v126, v110, v124, v125
    v_fma_f32 v127, v111, v124, v125
    v_mul_f32 v88, v88, v126
    v_mul_f32 v89, v89, v127
    v_mfma_f32_16x16x32_bf16 v[48:51], a[128:131], v[164:167], v[48:51]
    v_add_f32 v44, v44, v192
    v_add_f32 v45, v45, v193
    v_mul_f32 v130, s80, v44
    v_mul_f32 v131, s80, v45
    v_exp_f32 v130, v130
    v_exp_f32 v131, v131
    v_mfma_f32_16x16x32_bf16 v[48:51], a[148:151], v[168:171], v[48:51]
    v_add_f32 v130, 1.0, v130
    v_add_f32 v131, 1.0, v131
    v_rcp_f32 v130, v130
    v_rcp_f32 v131, v131
    v_mul_f32 v130, v130, v44
    v_mfma_f32_16x16x32_bf16 v[48:51], a[168:171], v[172:175], v[48:51]
    v_mul_f32 v131, v131, v45
    v_fma_f32 v130, v130, v86, v108
    v_fma_f32 v131, v131, v87, v109
    v_cvt_pk_bf16_f32 v62, v130, v131
    v_add_f32 v46, v46, v194
    v_add_f32 v47, v47, v195
    v_mfma_f32_16x16x32_bf16 v[48:51], a[188:191], v[176:179], v[48:51]
    v_mul_f32 v132, s80, v46
    v_mul_f32 v133, s80, v47
    v_exp_f32 v132, v132
    v_exp_f32 v133, v133
    v_add_f32 v132, 1.0, v132
    v_add_f32 v133, 1.0, v133
    v_mfma_f32_16x16x32_bf16 v[48:51], a[208:211], v[180:183], v[48:51]
    v_rcp_f32 v132, v132
    v_rcp_f32 v133, v133
    v_mul_f32 v132, v132, v46
    v_mul_f32 v133, v133, v47
    v_fma_f32 v132, v132, v88, v110
    v_fma_f32 v133, v133, v89, v111
    v_mfma_f32_16x16x32_bf16 v[48:51], a[228:231], v[184:187], v[48:51]
    v_cvt_pk_bf16_f32 v63, v132, v133
    buffer_store_dwordx2 v[62:63], v11, s[32:35], 0 offen offset:32
    v_mfma_f32_16x16x32_bf16 v[52:55], a[12:15], v[140:143], 0
    ds_read_b128 v[204:207], v8 offset:4096
    ds_read_b128 v[224:227], v8 offset:9216
    ds_read_b128 v[244:247], v8 offset:14336
    v_lshlrev_b32 v128, 16, v74
    v_and_b32 v129, 0xffff0000, v74
    s_waitcnt lgkmcnt(7)
    v_add_f32 v196, v196, v216
    v_mfma_f32_16x16x32_bf16 v[52:55], a[32:35], v[144:147], v[52:55]
    v_add_f32 v197, v197, v217
    s_waitcnt lgkmcnt(6)
    v_add_f32 v128, v128, v236
    v_add_f32 v129, v129, v237
    v_add_f32 v196, v196, v128
    v_add_f32 v197, v197, v129
    v_lshlrev_b32 v128, 16, v75
    v_mfma_f32_16x16x32_bf16 v[52:55], a[52:55], v[148:151], v[52:55]
    v_and_b32 v129, 0xffff0000, v75
    v_add_f32 v198, v198, v218
    v_add_f32 v199, v199, v219
    v_add_f32 v128, v128, v238
    v_add_f32 v129, v129, v239
    v_add_f32 v198, v198, v128
    v_mfma_f32_16x16x32_bf16 v[52:55], a[72:75], v[152:155], v[52:55]
    v_add_f32 v199, v199, v129
    v_lshlrev_b32 v112, 16, v64
    v_and_b32 v113, 0xffff0000, v64
    s_waitcnt vmcnt(13)
    v_lshlrev_b32 v90, 16, v90
    s_waitcnt vmcnt(12)
    v_lshlrev_b32 v91, 16, v91
    v_mfma_f32_16x16x32_bf16 v[52:55], a[92:95], v[156:159], v[52:55]
    v_fma_f32 v126, v112, v124, v125
    v_fma_f32 v127, v113, v124, v125
    v_mul_f32 v90, v90, v126
    v_mul_f32 v91, v91, v127
    v_lshlrev_b32 v114, 16, v65
    v_and_b32 v115, 0xffff0000, v65
    v_mfma_f32_16x16x32_bf16 v[52:55], a[112:115], v[160:163], v[52:55]
    s_waitcnt vmcnt(11)
    v_lshlrev_b32 v92, 16, v92
    s_waitcnt vmcnt(10)
    v_lshlrev_b32 v93, 16, v93
    v_fma_f32 v126, v114, v124, v125
    v_fma_f32 v127, v115, v124, v125
    v_mul_f32 v92, v92, v126
    v_mul_f32 v93, v93, v127
    v_mfma_f32_16x16x32_bf16 v[52:55], a[132:135], v[164:167], v[52:55]
    v_add_f32 v48, v48, v196
    v_add_f32 v49, v49, v197
    v_mul_f32 v130, s80, v48
    v_mul_f32 v131, s80, v49
    v_exp_f32 v130, v130
    v_exp_f32 v131, v131
    v_mfma_f32_16x16x32_bf16 v[52:55], a[152:155], v[168:171], v[52:55]
    v_add_f32 v130, 1.0, v130
    v_add_f32 v131, 1.0, v131
    v_rcp_f32 v130, v130
    v_rcp_f32 v131, v131
    v_mul_f32 v130, v130, v48
    v_mfma_f32_16x16x32_bf16 v[52:55], a[172:175], v[172:175], v[52:55]
    v_mul_f32 v131, v131, v49
    v_fma_f32 v130, v130, v90, v112
    v_fma_f32 v131, v131, v91, v113
    v_cvt_pk_bf16_f32 v64, v130, v131
    v_add_f32 v50, v50, v198
    v_add_f32 v51, v51, v199
    v_mfma_f32_16x16x32_bf16 v[52:55], a[192:195], v[176:179], v[52:55]
    v_mul_f32 v132, s80, v50
    v_mul_f32 v133, s80, v51
    v_exp_f32 v132, v132
    v_exp_f32 v133, v133
    v_add_f32 v132, 1.0, v132
    v_add_f32 v133, 1.0, v133
    v_mfma_f32_16x16x32_bf16 v[52:55], a[212:215], v[180:183], v[52:55]
    v_rcp_f32 v132, v132
    v_rcp_f32 v133, v133
    v_mul_f32 v132, v132, v50
    v_mul_f32 v133, v133, v51
    v_fma_f32 v132, v132, v92, v114
    v_fma_f32 v133, v133, v93, v115
    v_mfma_f32_16x16x32_bf16 v[52:55], a[232:235], v[184:187], v[52:55]
    v_cvt_pk_bf16_f32 v65, v132, v133
    buffer_store_dwordx2 v[64:65], v11, s[32:35], 0 offen offset:64
    v_mfma_f32_16x16x32_bf16 v[56:59], a[16:19], v[140:143], 0
    v_lshlrev_b32 v128, 16, v76
    v_and_b32 v129, 0xffff0000, v76
    s_waitcnt lgkmcnt(4)
    v_add_f32 v200, v200, v220
    v_add_f32 v201, v201, v221
    s_waitcnt lgkmcnt(3)
    v_add_f32 v128, v128, v240
    v_add_f32 v129, v129, v241
    v_mfma_f32_16x16x32_bf16 v[56:59], a[36:39], v[144:147], v[56:59]
    v_add_f32 v200, v200, v128
    v_add_f32 v201, v201, v129
    v_lshlrev_b32 v128, 16, v77
    v_and_b32 v129, 0xffff0000, v77
    v_add_f32 v202, v202, v222
    v_mfma_f32_16x16x32_bf16 v[56:59], a[56:59], v[148:151], v[56:59]
    v_add_f32 v203, v203, v223
    v_add_f32 v128, v128, v242
    v_add_f32 v129, v129, v243
    v_add_f32 v202, v202, v128
    v_add_f32 v203, v203, v129
    v_lshlrev_b32 v116, 16, v66
    v_mfma_f32_16x16x32_bf16 v[56:59], a[76:79], v[152:155], v[56:59]
    v_and_b32 v117, 0xffff0000, v66
    s_waitcnt vmcnt(10)
    v_lshlrev_b32 v94, 16, v94
    s_waitcnt vmcnt(9)
    v_lshlrev_b32 v95, 16, v95
    v_fma_f32 v126, v116, v124, v125
    v_fma_f32 v127, v117, v124, v125
    v_mfma_f32_16x16x32_bf16 v[56:59], a[96:99], v[156:159], v[56:59]
    v_mul_f32 v94, v94, v126
    v_mul_f32 v95, v95, v127
    v_lshlrev_b32 v118, 16, v67
    v_and_b32 v119, 0xffff0000, v67
    s_waitcnt vmcnt(8)
    v_lshlrev_b32 v96, 16, v96
    s_waitcnt vmcnt(7)
    v_lshlrev_b32 v97, 16, v97
    v_mfma_f32_16x16x32_bf16 v[56:59], a[116:119], v[160:163], v[56:59]
    v_fma_f32 v126, v118, v124, v125
    v_fma_f32 v127, v119, v124, v125
    v_mul_f32 v96, v96, v126
    v_mul_f32 v97, v97, v127
    v_add_f32 v52, v52, v200
    v_mfma_f32_16x16x32_bf16 v[56:59], a[136:139], v[164:167], v[56:59]
    v_add_f32 v53, v53, v201
    v_mul_f32 v130, s80, v52
    v_mul_f32 v131, s80, v53
    v_exp_f32 v130, v130
    v_exp_f32 v131, v131
    v_add_f32 v130, 1.0, v130
    v_mfma_f32_16x16x32_bf16 v[56:59], a[156:159], v[168:171], v[56:59]
    v_add_f32 v131, 1.0, v131
    v_rcp_f32 v130, v130
    v_rcp_f32 v131, v131
    v_mul_f32 v130, v130, v52
    v_mul_f32 v131, v131, v53
    v_mfma_f32_16x16x32_bf16 v[56:59], a[176:179], v[172:175], v[56:59]
    v_fma_f32 v130, v130, v94, v116
    v_fma_f32 v131, v131, v95, v117
    v_cvt_pk_bf16_f32 v66, v130, v131
    v_add_f32 v54, v54, v202
    v_add_f32 v55, v55, v203
    v_mul_f32 v132, s80, v54
    v_mfma_f32_16x16x32_bf16 v[56:59], a[196:199], v[176:179], v[56:59]
    v_mul_f32 v133, s80, v55
    v_exp_f32 v132, v132
    v_exp_f32 v133, v133
    v_add_f32 v132, 1.0, v132
    v_add_f32 v133, 1.0, v133
    v_mfma_f32_16x16x32_bf16 v[56:59], a[216:219], v[180:183], v[56:59]
    v_rcp_f32 v132, v132
    v_rcp_f32 v133, v133
    v_mul_f32 v132, v132, v54
    v_mul_f32 v133, v133, v55
    v_fma_f32 v132, v132, v96, v118
    v_fma_f32 v133, v133, v97, v119
    v_mfma_f32_16x16x32_bf16 v[56:59], a[236:239], v[184:187], v[56:59]
    v_cvt_pk_bf16_f32 v67, v132, v133
    buffer_store_dwordx2 v[66:67], v11, s[32:35], 0 offen offset:96
    v_lshlrev_b32 v128, 16, v78
    v_and_b32 v129, 0xffff0000, v78
    s_waitcnt lgkmcnt(1)
    v_add_f32 v204, v204, v224
    v_add_f32 v205, v205, v225
    s_waitcnt lgkmcnt(0)
    v_add_f32 v128, v128, v244
    v_add_f32 v129, v129, v245
    v_add_f32 v204, v204, v128
    v_add_f32 v205, v205, v129
    v_lshlrev_b32 v128, 16, v79
    v_and_b32 v129, 0xffff0000, v79
    v_add_f32 v206, v206, v226
    v_add_f32 v207, v207, v227
    v_add_f32 v128, v128, v246
    v_add_f32 v129, v129, v247
    v_add_f32 v206, v206, v128
    v_add_f32 v207, v207, v129
    v_lshlrev_b32 v120, 16, v68
    v_and_b32 v121, 0xffff0000, v68
    s_waitcnt vmcnt(7)
    v_lshlrev_b32 v98, 16, v98
    s_waitcnt vmcnt(6)
    v_lshlrev_b32 v99, 16, v99
    v_fma_f32 v126, v120, v124, v125
    v_fma_f32 v127, v121, v124, v125
    v_mul_f32 v98, v98, v126
    v_mul_f32 v99, v99, v127
    v_lshlrev_b32 v122, 16, v69
    v_and_b32 v123, 0xffff0000, v69
    s_waitcnt vmcnt(5)
    v_lshlrev_b32 v100, 16, v100
    s_waitcnt vmcnt(4)
    v_lshlrev_b32 v101, 16, v101
    v_fma_f32 v126, v122, v124, v125
    v_fma_f32 v127, v123, v124, v125
    v_mul_f32 v100, v100, v126
    v_mul_f32 v101, v101, v127
    v_add_f32 v56, v56, v204
    v_add_f32 v57, v57, v205
    v_mul_f32 v130, s80, v56
    v_mul_f32 v131, s80, v57
    v_exp_f32 v130, v130
    v_exp_f32 v131, v131
    v_add_f32 v130, 1.0, v130
    v_add_f32 v131, 1.0, v131
    v_rcp_f32 v130, v130
    v_rcp_f32 v131, v131
    v_mul_f32 v130, v130, v56
    v_mul_f32 v131, v131, v57
    v_fma_f32 v130, v130, v98, v120
    v_fma_f32 v131, v131, v99, v121
    v_cvt_pk_bf16_f32 v68, v130, v131
    v_add_f32 v58, v58, v206
    v_add_f32 v59, v59, v207
    v_mul_f32 v132, s80, v58
    v_mul_f32 v133, s80, v59
    v_exp_f32 v132, v132
    v_exp_f32 v133, v133
    v_add_f32 v132, 1.0, v132
    v_add_f32 v133, 1.0, v133
    v_rcp_f32 v132, v132
    v_rcp_f32 v133, v133
    v_mul_f32 v132, v132, v58
    v_mul_f32 v133, v133, v59
    v_fma_f32 v132, v132, v100, v122
    v_fma_f32 v133, v133, v101, v123
    v_cvt_pk_bf16_f32 v69, v132, v133
    buffer_store_dwordx2 v[68:69], v11, s[32:35], 0 offen offset:128
    v_mov_b32 v18, 2147483648
    v_mov_b32 v15, s85
    v_cmp_eq_u32 vcc, 0, v0
    s_nop 1
    v_cndmask_b32 v15, v18, v15, vcc
    v_mov_b32 v18, s5
    buffer_store_dword v18, v15, s[36:39], 0 offen sc1
    s_endpgm
LB_slowp1:
    s_mov_b32 s79, 0
LB_slowp1_l:
    s_sleep 1
    buffer_load_dword v127, v126, s[36:39], 0 offen sc1
    s_add_u32 s79, s79, 1
    s_cmp_gt_u32 s79, 0x8000
    s_cbranch_scc1 LB_slowp1_x
    s_waitcnt vmcnt(0)
    v_cmp_ne_u32 vcc, s5, v127
    s_nop 4
    s_cbranch_vccnz LB_slowp1_l
LB_slowp1_x:
    s_waitcnt vmcnt(0)
    s_nop 7
    s_branch LB_backp2
LB_slowg13:
    s_mov_b32 s79, 0
LB_slowg13_l:
    s_sleep 1
    buffer_load_dword v14, v13, s[36:39], 0 offen sc1
    s_add_u32 s79, s79, 1
    s_cmp_gt_u32 s79, 0x8000
    s_cbranch_scc1 LB_slowg13_x
    s_waitcnt vmcnt(0)
    v_cmp_ne_u32 vcc, s5, v14
    s_nop 4
    s_cbranch_vccnz LB_slowg13_l
LB_slowg13_x:
    s_waitcnt vmcnt(0)
    s_nop 7
    s_branch LB_backg14
LB_slowtk5:
    s_mov_b32 s79, 0
LB_slowtk5_l:
    s_sleep 1
    buffer_load_dword v18, v15, s[36:39], 0 offen sc1
    s_add_u32 s79, s79, 1
    s_cmp_gt_u32 s79, 0x8000
    s_cbranch_scc1 LB_slowtk5_x
    s_waitcnt vmcnt(0)
    v_cmp_ne_u32 vcc, s84, v18
    s_nop 4
    s_cbranch_vccnz LB_slowtk5_l
LB_slowtk5_x:
    s_waitcnt vmcnt(0)
    s_nop 7
    s_branch LB_backtk6
LB_slowy7:
    s_mov_b32 s79, 0
LB_slowy7_l:
    s_sleep 1
    buffer_load_dword v14, v13, s[36:39], 0 offen sc1
    s_add_u32 s79, s79, 1
    s_cmp_gt_u32 s79, 0x8000
    s_cbranch_scc1 LB_slowy7_x
    s_waitcnt vmcnt(0)
    v_cmp_ne_u32 vcc, s5, v14
    s_nop 4
    s_cbranch_vccnz LB_slowy7_l
LB_slowy7_x:
    s_waitcnt vmcnt(0)
    s_nop 7
    s_branch LB_backy8
Lend_B:
    s_endpgm

.section .rodata,"a"
.p2align 6
.amdhsa_kernel recurrent_scan__ssm_conv_h3__dense_activation_squared_relu__prompt_kernel
  .amdhsa_next_free_vgpr 512
  .amdhsa_next_free_sgpr 102
  .amdhsa_accum_offset 256
  .amdhsa_group_segment_fixed_size 0
  .amdhsa_kernarg_size 112
  .amdhsa_user_sgpr_count 2
  .amdhsa_user_sgpr_kernarg_segment_ptr 1
  .amdhsa_system_sgpr_workgroup_id_x 1
.end_amdhsa_kernel
```
